```python
import torch

def _softmax(x, axis=-1):
    return torch.softmax(x, dim=axis)

def _gelu(x):
    return torch.nn.functional.gelu(x, approximate='tanh')

def _silu(x):
    return torch.nn.functional.silu(x)

def _sigmoid(x):
    return torch.sigmoid(x)

def _layernorm(x, axis=-1, eps=1e-05):
    m = x.mean(dim=axis, keepdim=True)
    v = x.var(dim=axis, keepdim=True, unbiased=False)
    return (x - m) / torch.sqrt(v + eps)

def _scatter_add(tgt, idx, src, axis=0):
    return tgt.clone().index_add_(axis, idx, src)

def _segment_sum(src, seg, n):
    out = torch.zeros((n,) + src.shape[1:], dtype=src.dtype)
    return out.index_add_(0, seg, src)

def _pad(x, pw):
    flat = tuple((v for pair in reversed(pw) for v in pair))
    return torch.nn.functional.pad(x, flat)
kernel_name = 'standalone__window_attn_cswin__vision'

def setup_inputs():

    _w = lambda a: (lambda t: t.to(torch.bfloat16) if t.is_floating_point() else t)(torch.as_tensor(a))
    sw = 8
    H = W = 224 // sw * sw
    C = 96 // 2 * 2
    return {'x': _w((lambda *s: torch.randn(*s, dtype=torch.bfloat16) * 0.4)(1, H, W, C)), 'wqkv': _w((lambda *s: torch.randn(*s, dtype=torch.bfloat16) * 0.4)(C, 3 * C)), 'wo': _w((lambda *s: torch.randn(*s, dtype=torch.bfloat16) * 0.05)(C, C))}

def reference(x, wqkv, wo):
    B, H, W, C = x.shape
    sw = 8
    C2 = C // 2
    nh, nw = (H // sw, W // sw)
    qkv = torch.einsum('bhwc,cd->bhwd', x, wqkv)
    q, k, v = (qkv[..., :C].clone(), qkv[..., C:2 * C].clone(), qkv[..., 2 * C:].clone())
    scale = C2 ** (-0.5)
    qh = q[..., :C2].reshape(B * nh, sw * W, C2)
    kh = k[..., :C2].reshape(B * nh, sw * W, C2)
    vh = v[..., :C2].reshape(B * nh, sw * W, C2)
    ah = _softmax(torch.einsum('bqc,bkc->bqk', qh, kh) * scale, axis=-1)
    oh = torch.einsum('bqk,bkc->bqc', ah, vh).reshape(B, H, W, C2)
    qv = (lambda x, *d: x.permute(*d))(q[..., C2:].reshape(B, H, nw, sw, C2), 0, 2, 1, 3, 4).reshape(B * nw, H * sw, C2)
    kv = (lambda x, *d: x.permute(*d))(k[..., C2:].reshape(B, H, nw, sw, C2), 0, 2, 1, 3, 4).reshape(B * nw, H * sw, C2)
    vv = (lambda x, *d: x.permute(*d))(v[..., C2:].reshape(B, H, nw, sw, C2), 0, 2, 1, 3, 4).reshape(B * nw, H * sw, C2)
    av = _softmax(torch.einsum('bqc,bkc->bqk', qv, kv) * scale, axis=-1)
    ov = torch.einsum('bqk,bkc->bqc', av, vv).reshape(B, nw, H, sw, C2)
    ov = (lambda x, *d: x.permute(*d))(ov, 0, 2, 1, 3, 4).reshape(B, H, W, C2)
    o = _pad(oh, ((0, 0), (0, 0), (0, 0), (0, C2))) + _pad(ov, ((0, 0), (0, 0), (0, 0), (C2, 0)))
    return torch.einsum('bhwc,cd->bhwd', o, wo)
```

```asm
; @launch grid=(256,1,1) block=(256,1,1) lds=163840
.amdgcn_target "amdgcn-amd-amdhsa--gfx950"
.text
.globl standalone__window_attn_cswin__vision_kernel
.p2align 8
.type standalone__window_attn_cswin__vision_kernel,@function
standalone__window_attn_cswin__vision_kernel:
  s_load_dwordx4 s[4:7], s[0:1], 0
  s_load_dwordx4 s[60:63], s[0:1], 16
  s_load_dwordx4 s[64:67], s[0:1], 32
  v_lshrrev_b32 v16, 6, v0
  v_and_b32 v17, 63, v0
  v_lshlrev_b32 v1, 4, v17
  v_readfirstlane_b32 s30, v16
  s_cmp_ge_u32 s2, 256
  s_cbranch_scc1 L_exit
  s_and_b32 s36, s2, 7
  s_lshr_b32 s37, s2, 3
  s_cmp_lt_u32 s36, 4
  s_cselect_b32 s38, 12, 16
  s_cmp_lt_u32 s37, s38
  s_cbranch_scc1 L_roleH
  s_sub_u32 s37, s37, s38
  s_cmp_lt_u32 s36, 4
  s_cselect_b32 s38, 20, 15
  s_cmp_ge_u32 s37, s38
  s_cbranch_scc1 L_exit
  s_mul_i32 s39, s37, 52
  s_lshr_b32 s39, s39, 8
  s_mul_i32 s33, s39, 5
  s_sub_u32 s33, s37, s33
  s_lshl_b32 s39, s39, 3
  s_add_u32 s35, s36, s39
  s_mov_b32 s32, s35
  s_mul_i32 s34, s33, 11
  s_min_u32 s39, s33, 1
  s_add_u32 s34, s34, s39
  s_lshl_b32 s3, s39, 1
  s_mov_b32 s31, 0
  s_branch L_roledone
L_roleH:
  s_lshr_b32 s39, s37, 2
  s_and_b32 s33, s37, 3
  s_cmp_lt_u32 s36, 4
  s_cbranch_scc1 L_roleH_lo
  s_sub_u32 s36, s36, 4
  s_lshl_b32 s36, s36, 2
  s_add_u32 s35, s36, s39
  s_branch L_roleH_c
L_roleH_lo:
  s_mul_i32 s36, s36, 3
  s_add_u32 s36, s36, 16
  s_add_u32 s35, s36, s39
L_roleH_c:
  s_add_u32 s32, s35, 28
  s_mul_i32 s34, s33, 14
  s_mov_b32 s31, 1
  s_mov_b32 s3, 1
L_roledone:
  s_lshl_b32 s36, s30, 6
  v_add_u32 v16, s36, v17
  v_mul_u32_u24 v18, 10923, v16
  v_lshrrev_b32 v18, 16, v18
  v_mul_u32_u24 v19, 6, v18
  v_sub_u32 v19, v16, v19
  v_mul_u32_u24 v18, 576, v18
  v_lshlrev_b32 v19, 4, v19
  v_add_u32 v20, v18, v19
  s_xor_b32 s101, s31, 1
  s_mul_i32 s101, s101, 96
  s_lshl_b32 s100, s30, 10
  s_add_u32 s100, s100, 86016
  v_add_u32 v16, 0, v17
  v_mul_u32_u24 v18, 5462, v16
  v_lshrrev_b32 v18, 16, v18
  v_mul_u32_u24 v19, 12, v18
  v_sub_u32 v19, v16, v19
  v_lshrrev_b32 v21, 3, v18
  v_and_b32 v18, 7, v18
  v_mul_u32_u24 v21, 43008, v21
  v_mul_u32_u24 v18, 192, v18
  v_lshlrev_b32 v19, 4, v19
  v_add3_u32 v6, v21, v18, v19
  v_add_u32 v16, 64, v17
  v_mul_u32_u24 v18, 5462, v16
  v_lshrrev_b32 v18, 16, v18
  v_mul_u32_u24 v19, 12, v18
  v_sub_u32 v19, v16, v19
  v_lshrrev_b32 v21, 3, v18
  v_and_b32 v18, 7, v18
  v_mul_u32_u24 v21, 43008, v21
  v_mul_u32_u24 v18, 192, v18
  v_lshlrev_b32 v19, 4, v19
  v_add3_u32 v7, v21, v18, v19
  v_add_u32 v16, 128, v17
  v_mul_u32_u24 v18, 5462, v16
  v_lshrrev_b32 v18, 16, v18
  v_mul_u32_u24 v19, 12, v18
  v_sub_u32 v19, v16, v19
  v_lshrrev_b32 v21, 3, v18
  v_and_b32 v18, 7, v18
  v_mul_u32_u24 v21, 43008, v21
  v_mul_u32_u24 v18, 192, v18
  v_lshlrev_b32 v19, 4, v19
  v_add3_u32 v8, v21, v18, v19
  s_mul_i32 s99, s30, 12288
  s_add_u32 s99, s99, 114688
  s_mul_i32 s36, s30, 3
  s_add_u32 s36, s36, 0
  s_lshr_b32 s37, s36, 2
  s_mul_i32 s37, s37, 28672
  s_and_b32 s38, s36, 3
  s_mul_i32 s38, s38, 7168
  s_add_u32 s84, s37, s38
  s_add_u32 s36, s36, s34
  s_cmp_ge_u32 s36, 56
  s_cselect_b32 s37, 56, 0
  s_sub_u32 s72, s36, s37
  s_and_b32 s36, s72, 1
  s_lshl_b32 s37, s35, 1
  s_add_u32 s36, s36, s37
  s_lshr_b32 s37, s72, 1
  s_cmp_eq_u32 s31, 0
  s_cselect_b32 s36, s72, s36
  s_cselect_b32 s37, s35, s37
  s_mul_i32 s38, s36, 172032
  s_mul_i32 s68, s37, 1536
  s_add_u32 s68, s68, s38
  s_mul_i32 s36, s36, 28
  s_add_u32 s36, s36, s37
  s_mul_i32 s36, s36, 3072
  s_add_u32 s88, s36, 23068672
  s_mul_i32 s36, s30, 3
  s_add_u32 s36, s36, 1
  s_lshr_b32 s37, s36, 2
  s_mul_i32 s37, s37, 28672
  s_and_b32 s38, s36, 3
  s_mul_i32 s38, s38, 7168
  s_add_u32 s85, s37, s38
  s_add_u32 s36, s36, s34
  s_cmp_ge_u32 s36, 56
  s_cselect_b32 s37, 56, 0
  s_sub_u32 s73, s36, s37
  s_and_b32 s36, s73, 1
  s_lshl_b32 s37, s35, 1
  s_add_u32 s36, s36, s37
  s_lshr_b32 s37, s73, 1
  s_cmp_eq_u32 s31, 0
  s_cselect_b32 s36, s73, s36
  s_cselect_b32 s37, s35, s37
  s_mul_i32 s38, s36, 172032
  s_mul_i32 s69, s37, 1536
  s_add_u32 s69, s69, s38
  s_mul_i32 s36, s36, 28
  s_add_u32 s36, s36, s37
  s_mul_i32 s36, s36, 3072
  s_add_u32 s89, s36, 23068672
  s_waitcnt lgkmcnt(0)
  s_mov_b32 s48, s6
  s_and_b32 s49, s7, 0xffff
  s_mov_b32 s50, 55296
  s_mov_b32 s51, 0x20000
  s_mov_b32 s16, s4
  s_and_b32 s17, s5, 0xffff
  s_mov_b32 s18, 9633792
  s_mov_b32 s19, 0x20000
  s_cmp_eq_u32 s30, 3
  s_cbranch_scc1 L_nowdma
  s_add_u32 m0, s100, 0
  s_add_u32 s38, s101, 0
  buffer_load_dwordx4 v20, s[48:51], s38 offen lds
  s_add_u32 m0, s100, 3072
  s_add_u32 s38, s101, 18432
  buffer_load_dwordx4 v20, s[48:51], s38 offen lds
  s_add_u32 m0, s100, 6144
  s_add_u32 s38, s101, 36864
  buffer_load_dwordx4 v20, s[48:51], s38 offen lds
  s_add_u32 m0, s100, 9216
  s_add_u32 s38, s101, 192
  buffer_load_dwordx4 v20, s[48:51], s38 offen lds
  s_add_u32 m0, s100, 12288
  s_add_u32 s38, s101, 18624
  buffer_load_dwordx4 v20, s[48:51], s38 offen lds
  s_add_u32 m0, s100, 15360
  s_add_u32 s38, s101, 37056
  buffer_load_dwordx4 v20, s[48:51], s38 offen lds
  s_add_u32 m0, s100, 18432
  s_add_u32 s38, s101, 384
  buffer_load_dwordx4 v20, s[48:51], s38 offen lds
  s_add_u32 m0, s100, 21504
  s_add_u32 s38, s101, 18816
  buffer_load_dwordx4 v20, s[48:51], s38 offen lds
  s_add_u32 m0, s100, 24576
  s_add_u32 s38, s101, 37248
  buffer_load_dwordx4 v20, s[48:51], s38 offen lds
L_nowdma:
  s_add_u32 m0, s99, 0
  s_nop 0
  buffer_load_dwordx4 v6, s[16:19], s68 offen lds
  s_add_u32 m0, s99, 1024
  s_nop 0
  buffer_load_dwordx4 v7, s[16:19], s68 offen lds
  s_add_u32 m0, s99, 2048
  s_nop 0
  buffer_load_dwordx4 v8, s[16:19], s68 offen lds
  s_add_u32 m0, s99, 3072
  s_add_u32 s39, s68, 86016
  buffer_load_dwordx4 v6, s[16:19], s39 offen lds
  s_add_u32 m0, s99, 4096
  s_nop 0
  buffer_load_dwordx4 v7, s[16:19], s39 offen lds
  s_add_u32 m0, s99, 5120
  s_nop 0
  buffer_load_dwordx4 v8, s[16:19], s39 offen lds
  s_add_u32 m0, s99, 6144
  s_nop 0
  buffer_load_dwordx4 v6, s[16:19], s69 offen lds
  s_add_u32 m0, s99, 7168
  s_nop 0
  buffer_load_dwordx4 v7, s[16:19], s69 offen lds
  s_add_u32 m0, s99, 8192
  s_nop 0
  buffer_load_dwordx4 v8, s[16:19], s69 offen lds
  s_add_u32 m0, s99, 9216
  s_add_u32 s39, s69, 86016
  buffer_load_dwordx4 v6, s[16:19], s39 offen lds
  s_add_u32 m0, s99, 10240
  s_nop 0
  buffer_load_dwordx4 v7, s[16:19], s39 offen lds
  s_add_u32 m0, s99, 11264
  s_nop 0
  buffer_load_dwordx4 v8, s[16:19], s39 offen lds
  s_getpc_b64 s[4:5]
L_cpf_here:
  s_sub_u32 s4, s4, L_cpf_here-standalone__window_attn_cswin__vision_kernel
  s_subb_u32 s5, s5, 0
  s_lshr_b32 s36, s2, 3
  s_lshl_b32 s36, s36, 11
  s_and_b32 s37, s30, 1
  s_lshl_b32 s37, s37, 10
  s_add_u32 s36, s36, s37
  v_add_u32 v16, s36, v1
  s_cmp_lt_u32 s36, L_code_end-standalone__window_attn_cswin__vision_kernel-1024
  s_cbranch_scc0 L_nocpf
  s_cmp_lt_u32 s30, 2
  s_cbranch_scc0 L_nocpf
  global_load_dwordx4 v[108:111], v16, s[4:5]
L_nocpf:
  s_mul_i32 s36, s30, 3
  s_add_u32 s36, s36, 2
  s_lshr_b32 s37, s36, 2
  s_mul_i32 s37, s37, 28672
  s_and_b32 s38, s36, 3
  s_mul_i32 s38, s38, 7168
  s_add_u32 s86, s37, s38
  s_add_u32 s36, s36, s34
  s_cmp_ge_u32 s36, 56
  s_cselect_b32 s37, 56, 0
  s_sub_u32 s74, s36, s37
  s_and_b32 s36, s74, 1
  s_lshl_b32 s37, s35, 1
  s_add_u32 s36, s36, s37
  s_lshr_b32 s37, s74, 1
  s_cmp_eq_u32 s31, 0
  s_cselect_b32 s36, s74, s36
  s_cselect_b32 s37, s35, s37
  s_mul_i32 s38, s36, 172032
  s_mul_i32 s70, s37, 1536
  s_add_u32 s70, s70, s38
  s_mul_i32 s36, s36, 28
  s_add_u32 s36, s36, s37
  s_mul_i32 s36, s36, 3072
  s_add_u32 s90, s36, 23068672
  s_lshr_b32 s36, s30, 1
  s_add_u32 s36, s36, 12
  s_cmp_eq_u32 s31, 0
  s_cselect_b32 s36, 5, s36
  s_add_u32 s36, s36, s34
  s_cmp_ge_u32 s36, 56
  s_cselect_b32 s37, 56, 0
  s_sub_u32 s75, s36, s37
  s_and_b32 s36, s75, 1
  s_lshl_b32 s37, s35, 1
  s_add_u32 s36, s36, s37
  s_lshr_b32 s37, s75, 1
  s_cmp_eq_u32 s31, 0
  s_cselect_b32 s36, s75, s36
  s_cselect_b32 s37, s35, s37
  s_mul_i32 s38, s36, 172032
  s_mul_i32 s71, s37, 1536
  s_add_u32 s71, s71, s38
  s_mul_i32 s36, s36, 28
  s_add_u32 s36, s36, s37
  s_mul_i32 s36, s36, 3072
  s_add_u32 s91, s36, 23068672
  s_mov_b32 s52, s60
  s_and_b32 s53, s61, 0xffff
  s_mov_b32 s54, 18432
  s_mov_b32 s55, 0x20000
  s_mov_b32 s40, s62
  s_and_b32 s41, s63, 0xffff
  s_mov_b32 s42, 9633792
  s_mov_b32 s43, 0x20000
  s_mov_b32 s44, s64
  s_mov_b32 s45, s65
  s_mov_b32 s8, s66
  s_and_b32 s9, s67, 0xffff
  s_mov_b32 s10, 31457280
  s_mov_b32 s11, 0x20000
  s_mov_b32 s12, s66
  s_and_b32 s13, s67, 0xffff
  s_mov_b32 s14, 22478848
  s_mov_b32 s15, 0x20000
  s_mov_b32 s46, 0x3e553b95
  s_mov_b32 s47, 0x3e553b95
  s_sub_u32 s29, 5, s31
  s_mul_i32 s98, s32, 401408
  s_getreg_b32 s36, hwreg(HW_REG_XCC_ID, 0, 4)
  s_mul_i32 s37, s36, s36
  s_lshl_b32 s37, s37, 10
  s_lshl_b32 s36, s36, 3
  s_add_u32 s36, s36, s37
  s_add_u32 s36, s36, 1
  s_mul_i32 s95, s36, s29
  s_lshl_b32 s36, s36, 8
  s_lshl_b32 s37, s32, 2
  v_mov_b32 v13, s37
  v_mov_b32 v10, s36
  s_cmp_eq_u32 s30, 0
  s_cbranch_scc0 L_noarr
  s_mov_b64 s[92:93], exec
  s_mov_b64 exec, 1
  global_atomic_add v13, v10, s[44:45] sc1
  s_mov_b64 exec, s[92:93]
L_noarr:
  s_mul_i32 s37, s72, 7168
  s_add_u32 s76, s37, s98
  s_add_u32 s80, s76, 4096
  s_mul_i32 s37, s73, 7168
  s_add_u32 s77, s37, s98
  s_add_u32 s81, s77, 4096
  s_mul_i32 s37, s74, 7168
  s_add_u32 s78, s37, s98
  s_add_u32 s82, s78, 4096
  s_mul_i32 s37, s75, 7168
  s_add_u32 s79, s37, s98
  s_add_u32 s83, s79, 4096
  s_add_u32 s21, s98, 401408
  s_add_u32 s37, s34, s30
  s_add_u32 s37, s37, 8
  s_cmp_ge_u32 s37, 56
  s_cselect_b32 s38, 56, 0
  s_sub_u32 s37, s37, s38
  s_mul_i32 s37, s37, 7168
  s_add_u32 s20, s98, s37
  s_mul_i32 s22, s30, 7168
  s_add_u32 s22, s22, 57344
  s_and_b32 s36, s30, 1
  s_cmp_eq_u32 s3, 2
  s_cselect_b32 s36, s30, s36
  s_cmp_eq_u32 s3, 0
  s_cselect_b32 s36, 0, s36
  s_add_u32 s37, s36, 0
  s_and_b32 s37, s37, 3
  s_mul_i32 s37, s37, 7168
  v_add_u32 v2, s37, v1
  s_add_u32 s37, s36, 1
  s_and_b32 s37, s37, 3
  s_mul_i32 s37, s37, 7168
  v_add_u32 v3, s37, v1
  s_add_u32 s37, s36, 2
  s_and_b32 s37, s37, 3
  s_mul_i32 s37, s37, 7168
  v_add_u32 v4, s37, v1
  s_add_u32 s37, s36, 3
  s_and_b32 s37, s37, 3
  s_mul_i32 s37, s37, 7168
  v_add_u32 v5, s37, v1
  s_mov_b32 s23, 57344
  s_mov_b32 s24, 0
  v_lshrrev_b32 v18, 5, v17
  v_lshlrev_b32 v18, 3, v18
  v_and_b32 v16, 15, v17
  v_lshrrev_b32 v16, 2, v16
  v_add_u32 v18, v18, v16
  v_mul_u32_u24 v104, 96, v18
  v_lshrrev_b32 v18, 4, v17
  v_and_b32 v18, 1, v18
  v_lshlrev_b32 v16, 5, v18
  v_add_u32 v104, v104, v16
  v_and_b32 v16, 3, v17
  v_lshlrev_b32 v16, 3, v16
  v_add_u32 v104, v104, v16
  v_add_u32 v104, 86016, v104
  v_mul_u32_u24 v18, 9120, v18
  v_add_u32 v105, v104, v18
  v_lshrrev_b32 v18, 4, v17
  v_and_b32 v18, 1, v18
  v_lshlrev_b32 v18, 17, v18
  v_add_u32 v103, v104, v18
  v_and_b32 v16, 31, v17
  v_mul_u32_u24 v16, 192, v16
  v_lshrrev_b32 v18, 5, v17
  v_lshlrev_b32 v18, 4, v18
  v_add3_u32 v106, v16, v18, s99
  v_and_b32 v16, 27, v17
  v_cmp_eq_u32 vcc, 16, v16
  v_mov_b32 v18, 0
  v_mov_b32 v16, 1.0
  v_cndmask_b32 v176, v18, v16, vcc
  v_and_b32 v16, 16, v17
  v_cmp_eq_u32 s[92:93], 0, v16
  v_mov_b32 v177, v176
  v_mov_b32 v178, v176
  v_mov_b32 v179, v176
  v_mov_b32 v180, v176
  v_mov_b32 v181, v176
  v_mov_b32 v182, v176
  v_mov_b32 v183, v176
  v_mov_b32 v184, v176
  v_mov_b32 v185, v176
  v_mov_b32 v186, v176
  v_mov_b32 v187, v176
  v_mov_b32 v188, v176
  v_mov_b32 v189, v176
  v_mov_b32 v190, v176
  v_mov_b32 v191, v176
  s_mul_i32 s36, s30, 13312
  s_add_u32 s36, s36, 0
  v_and_b32 v16, 31, v17
  v_mul_u32_u24 v16, 208, v16
  v_lshrrev_b32 v18, 5, v17
  v_lshlrev_b32 v18, 3, v18
  v_add3_u32 v16, v16, v18, s36
  v_accvgpr_write_b32 a250, v16
  v_add_u32 v16, 0, v17
  v_mul_u32_u24 v18, 5462, v16
  v_lshrrev_b32 v18, 16, v18
  v_mul_u32_u24 v19, 12, v18
  v_sub_u32 v19, v16, v19
  v_mul_u32_u24 v18, 208, v18
  v_lshlrev_b32 v19, 4, v19
  v_add3_u32 v18, v18, v19, s36
  v_accvgpr_write_b32 a251, v18
  v_add_u32 v16, 64, v17
  v_mul_u32_u24 v18, 5462, v16
  v_lshrrev_b32 v18, 16, v18
  v_mul_u32_u24 v19, 12, v18
  v_sub_u32 v19, v16, v19
  v_mul_u32_u24 v18, 208, v18
  v_lshlrev_b32 v19, 4, v19
  v_add3_u32 v18, v18, v19, s36
  v_accvgpr_write_b32 a252, v18
  v_add_u32 v16, 128, v17
  v_mul_u32_u24 v18, 5462, v16
  v_lshrrev_b32 v18, 16, v18
  v_mul_u32_u24 v19, 12, v18
  v_sub_u32 v19, v16, v19
  v_mul_u32_u24 v18, 208, v18
  v_lshlrev_b32 v19, 4, v19
  v_add3_u32 v18, v18, v19, s36
  v_accvgpr_write_b32 a253, v18
  s_waitcnt vmcnt(12)
  s_barrier
  ds_read_b64_tr_b16 a[32:33], v104 offset:0
  ds_read_b64_tr_b16 a[34:35], v104 offset:384
  ds_read_b64_tr_b16 a[36:37], v104 offset:1536
  ds_read_b64_tr_b16 a[38:39], v104 offset:1920
  ds_read_b64_tr_b16 a[40:41], v104 offset:3072
  ds_read_b64_tr_b16 a[42:43], v104 offset:3456
  ds_read_b64_tr_b16 a[44:45], v104 offset:4608
  ds_read_b64_tr_b16 a[46:47], v104 offset:4992
  ds_read_b64_tr_b16 a[48:49], v104 offset:6144
  ds_read_b64_tr_b16 a[50:51], v104 offset:6528
  ds_read_b64_tr_b16 a[52:53], v104 offset:7680
  ds_read_b64_tr_b16 a[54:55], v104 offset:8064
  s_waitcnt vmcnt(6)
  ds_read_b128 a[152:155], v106 offset:0
  ds_read_b128 a[156:159], v106 offset:32
  ds_read_b128 a[160:163], v106 offset:64
  ds_read_b128 a[164:167], v106 offset:96
  ds_read_b128 a[168:171], v106 offset:128
  ds_read_b128 a[172:175], v106 offset:160
  ds_read_b64_tr_b16 a[56:57], v105 offset:64
  ds_read_b64_tr_b16 a[58:59], v105 offset:448
  ds_read_b64_tr_b16 a[60:61], v105 offset:1600
  ds_read_b64_tr_b16 a[62:63], v105 offset:1984
  ds_read_b64_tr_b16 a[64:65], v105 offset:3136
  ds_read_b64_tr_b16 a[66:67], v105 offset:3520
  ds_read_b64_tr_b16 a[68:69], v105 offset:4672
  ds_read_b64_tr_b16 a[70:71], v105 offset:5056
  ds_read_b64_tr_b16 a[72:73], v105 offset:6208
  ds_read_b64_tr_b16 a[74:75], v105 offset:6592
  ds_read_b64_tr_b16 a[76:77], v105 offset:7744
  ds_read_b64_tr_b16 a[78:79], v105 offset:8128
  s_waitcnt lgkmcnt(12)
  v_mfma_f32_32x32x16_bf16 v[16:31], a[32:35], a[152:155], 0
  s_add_u32 m0, s99, 0
  s_nop 0
  buffer_load_dwordx4 v6, s[16:19], s70 offen lds
  s_add_u32 m0, s99, 1024
  v_mfma_f32_32x32x16_bf16 v[16:31], a[36:39], a[156:159], v[16:31]
  s_nop 0
  buffer_load_dwordx4 v7, s[16:19], s70 offen lds
  s_add_u32 m0, s99, 2048
  s_nop 0
  v_mfma_f32_32x32x16_bf16 v[16:31], a[40:43], a[160:163], v[16:31]
  buffer_load_dwordx4 v8, s[16:19], s70 offen lds
  s_add_u32 m0, s99, 3072
  s_add_u32 s39, s70, 86016
  v_mfma_f32_32x32x16_bf16 v[16:31], a[44:47], a[164:167], v[16:31]
  buffer_load_dwordx4 v6, s[16:19], s39 offen lds
  s_add_u32 m0, s99, 4096
  s_nop 0
  v_mfma_f32_32x32x16_bf16 v[16:31], a[48:51], a[168:171], v[16:31]
  buffer_load_dwordx4 v7, s[16:19], s39 offen lds
  s_add_u32 m0, s99, 5120
  s_nop 0
  v_mfma_f32_32x32x16_bf16 v[16:31], a[52:55], a[172:175], v[16:31]
  buffer_load_dwordx4 v8, s[16:19], s39 offen lds
  ds_read_b64_tr_b16 a[80:81], v104 offset:9248
  ds_read_b64_tr_b16 a[82:83], v104 offset:9632
  ds_read_b64_tr_b16 a[84:85], v104 offset:10784
  ds_read_b64_tr_b16 a[86:87], v104 offset:11168
  ds_read_b64_tr_b16 a[88:89], v104 offset:12320
  ds_read_b64_tr_b16 a[90:91], v104 offset:12704
  ds_read_b64_tr_b16 a[92:93], v104 offset:13856
  ds_read_b64_tr_b16 a[94:95], v104 offset:14240
  ds_read_b64_tr_b16 a[96:97], v104 offset:15392
  ds_read_b64_tr_b16 a[98:99], v104 offset:15776
  ds_read_b64_tr_b16 a[100:101], v104 offset:16928
  ds_read_b64_tr_b16 a[102:103], v104 offset:17312
  s_waitcnt lgkmcnt(0)
  v_mfma_f32_32x32x16_bf16 v[32:47], a[56:59], a[152:155], 0
  ds_read_b64_tr_b16 a[104:105], v104 offset:18432
  ds_read_b64_tr_b16 a[106:107], v104 offset:18816
  ds_read_b64_tr_b16 a[108:109], v104 offset:19968
  ds_read_b64_tr_b16 a[110:111], v104 offset:20352
  v_mfma_f32_32x32x16_bf16 v[32:47], a[60:63], a[156:159], v[32:47]
  ds_read_b64_tr_b16 a[112:113], v104 offset:21504
  ds_read_b64_tr_b16 a[114:115], v104 offset:21888
  ds_read_b64_tr_b16 a[116:117], v104 offset:23040
  ds_read_b64_tr_b16 a[118:119], v104 offset:23424
  v_mfma_f32_32x32x16_bf16 v[32:47], a[64:67], a[160:163], v[32:47]
  ds_read_b64_tr_b16 a[120:121], v104 offset:24576
  ds_read_b64_tr_b16 a[122:123], v104 offset:24960
  ds_read_b64_tr_b16 a[124:125], v104 offset:26112
  ds_read_b64_tr_b16 a[126:127], v104 offset:26496
  v_mfma_f32_32x32x16_bf16 v[32:47], a[68:71], a[164:167], v[32:47]
  ds_read_b64_tr_b16 a[128:129], v103 offset:18496
  ds_read_b64_tr_b16 a[130:131], v103 offset:18880
  ds_read_b64_tr_b16 a[132:133], v103 offset:20032
  ds_read_b64_tr_b16 a[134:135], v103 offset:20416
  v_mfma_f32_32x32x16_bf16 v[32:47], a[72:75], a[168:171], v[32:47]
  ds_read_b64_tr_b16 a[136:137], v103 offset:21568
  ds_read_b64_tr_b16 a[138:139], v103 offset:21952
  ds_read_b64_tr_b16 a[140:141], v103 offset:23104
  ds_read_b64_tr_b16 a[142:143], v103 offset:23488
  v_mfma_f32_32x32x16_bf16 v[32:47], a[76:79], a[172:175], v[32:47]
  ds_read_b64_tr_b16 a[144:145], v103 offset:24640
  ds_read_b64_tr_b16 a[146:147], v103 offset:25024
  ds_read_b64_tr_b16 a[148:149], v103 offset:26176
  ds_read_b64_tr_b16 a[150:151], v103 offset:26560
  s_waitcnt lgkmcnt(0)
  v_mfma_f32_32x32x16_bf16 v[48:63], a[80:83], a[152:155], 0
  v_add_u32 v107, s84, v1
  v_pk_mul_f32 v[16:17], v[16:17], s[46:47]
  v_pk_mul_f32 v[18:19], v[18:19], s[46:47]
  v_pk_mul_f32 v[20:21], v[20:21], s[46:47]
  v_pk_mul_f32 v[22:23], v[22:23], s[46:47]
  v_pk_mul_f32 v[24:25], v[24:25], s[46:47]
  v_mfma_f32_32x32x16_bf16 v[48:63], a[84:87], a[156:159], v[48:63]
  v_pk_mul_f32 v[26:27], v[26:27], s[46:47]
  v_pk_mul_f32 v[28:29], v[28:29], s[46:47]
  v_pk_mul_f32 v[30:31], v[30:31], s[46:47]
  v_cvt_pk_bf16_f32 v208, v16, v17
  v_cvt_pk_bf16_f32 v209, v18, v19
  v_cvt_pk_bf16_f32 v210, v20, v21
  v_mfma_f32_32x32x16_bf16 v[48:63], a[88:91], a[160:163], v[48:63]
  v_cvt_pk_bf16_f32 v211, v22, v23
  v_cvt_pk_bf16_f32 v212, v24, v25
  v_cvt_pk_bf16_f32 v213, v26, v27
  v_cvt_pk_bf16_f32 v214, v28, v29
  v_cvt_pk_bf16_f32 v215, v30, v31
  v_mfma_f32_32x32x16_bf16 v[48:63], a[92:95], a[164:167], v[48:63]
  v_mfma_f32_32x32x16_bf16 v[48:63], a[96:99], a[168:171], v[48:63]
  v_mfma_f32_32x32x16_bf16 v[48:63], a[100:103], a[172:175], v[48:63]
  s_waitcnt vmcnt(6)
  v_mfma_f32_32x32x16_bf16 v[64:79], a[152:155], a[104:107], 0
  ds_read_b128 a[176:179], v106 offset:6144
  ds_read_b128 a[180:183], v106 offset:6176
  ds_read_b128 a[184:187], v106 offset:6208
  ds_read_b128 a[188:191], v106 offset:6240
  v_mfma_f32_32x32x16_bf16 v[64:79], a[156:159], a[108:111], v[64:79]
  ds_read_b128 a[192:195], v106 offset:6272
  ds_read_b128 a[196:199], v106 offset:6304
  v_pk_mul_f32 v[32:33], v[32:33], s[46:47]
  v_pk_mul_f32 v[34:35], v[34:35], s[46:47]
  v_pk_mul_f32 v[36:37], v[36:37], s[46:47]
  v_mfma_f32_32x32x16_bf16 v[64:79], a[160:163], a[112:115], v[64:79]
  v_pk_mul_f32 v[38:39], v[38:39], s[46:47]
  v_cvt_pk_bf16_f32 v216, v32, v33
  v_cvt_pk_bf16_f32 v217, v34, v35
  v_cvt_pk_bf16_f32 v218, v36, v37
  v_cvt_pk_bf16_f32 v219, v38, v39
  v_cvt_pk_bf16_f32 v192, v40, v41
  v_mfma_f32_32x32x16_bf16 v[64:79], a[164:167], a[116:119], v[64:79]
  v_cvt_pk_bf16_f32 v193, v42, v43
  v_cvt_pk_bf16_f32 v194, v44, v45
  v_cvt_pk_bf16_f32 v195, v46, v47
  v_mfma_f32_32x32x16_bf16 v[64:79], a[168:171], a[120:123], v[64:79]
  ds_write_b128 v107, v[192:195] offset:0
  v_mfma_f32_32x32x16_bf16 v[64:79], a[172:175], a[124:127], v[64:79]
  buffer_store_dwordx4 v[192:195], v1, s[8:11], s76 offen offset:0
  s_waitcnt lgkmcnt(0)
  v_mfma_f32_32x32x16_bf16 v[16:31], a[152:155], a[128:131], v[176:191]
  s_cmp_eq_u32 s31, 0
  s_cbranch_scc1 L_nox3
  s_add_u32 m0, s99, 6144
  s_nop 0
  buffer_load_dwordx4 v6, s[16:19], s71 offen lds
  s_add_u32 m0, s99, 7168
  s_nop 0
  buffer_load_dwordx4 v7, s[16:19], s71 offen lds
  s_add_u32 m0, s99, 8192
  s_nop 0
  buffer_load_dwordx4 v8, s[16:19], s71 offen lds
  s_add_u32 m0, s99, 9216
  s_add_u32 s39, s71, 86016
  buffer_load_dwordx4 v6, s[16:19], s39 offen lds
  s_add_u32 m0, s99, 10240
  s_nop 0
  buffer_load_dwordx4 v7, s[16:19], s39 offen lds
  s_add_u32 m0, s99, 11264
  s_nop 0
  buffer_load_dwordx4 v8, s[16:19], s39 offen lds
L_nox3:
  v_cvt_pk_bf16_f32 v196, v48, v49
  v_cvt_pk_bf16_f32 v197, v50, v51
  v_cvt_pk_bf16_f32 v198, v52, v53
  v_cvt_pk_bf16_f32 v199, v54, v55
  v_mfma_f32_32x32x16_bf16 v[16:31], a[156:159], a[132:135], v[16:31]
  ds_write_b128 v107, v[196:199] offset:1024
  v_mfma_f32_32x32x16_bf16 v[16:31], a[160:163], a[136:139], v[16:31]
  buffer_store_dwordx4 v[196:199], v1, s[8:11], s76 offen offset:1024
  v_cvt_pk_bf16_f32 v200, v56, v57
  v_mfma_f32_32x32x16_bf16 v[16:31], a[164:167], a[140:143], v[16:31]
  v_cvt_pk_bf16_f32 v201, v58, v59
  v_cvt_pk_bf16_f32 v202, v60, v61
  v_cvt_pk_bf16_f32 v203, v62, v63
  v_mfma_f32_32x32x16_bf16 v[16:31], a[168:171], a[144:147], v[16:31]
  ds_write_b128 v107, v[200:203] offset:2048
  v_mfma_f32_32x32x16_bf16 v[16:31], a[172:175], a[148:151], v[16:31]
  buffer_store_dwordx4 v[200:203], v1, s[8:11], s76 offen offset:2048
  v_mfma_f32_32x32x16_bf16 v[32:47], a[32:35], a[176:179], 0
  v_cvt_pk_bf16_f32 v204, v64, v65
  v_cvt_pk_bf16_f32 v205, v66, v67
  v_cvt_pk_bf16_f32 v206, v68, v69
  v_cvt_pk_bf16_f32 v207, v70, v71
  v_mfma_f32_32x32x16_bf16 v[32:47], a[36:39], a[180:183], v[32:47]
  ds_write_b128 v107, v[204:207] offset:3072
  v_mfma_f32_32x32x16_bf16 v[32:47], a[40:43], a[184:187], v[32:47]
  buffer_store_dwordx4 v[204:207], v1, s[8:11], s76 offen offset:3072
  v_cvt_pk_bf16_f32 v192, v72, v73
  v_mfma_f32_32x32x16_bf16 v[32:47], a[44:47], a[188:191], v[32:47]
  v_cvt_pk_bf16_f32 v193, v74, v75
  v_cvt_pk_bf16_f32 v194, v76, v77
  v_cvt_pk_bf16_f32 v195, v78, v79
  v_mfma_f32_32x32x16_bf16 v[32:47], a[48:51], a[192:195], v[32:47]
  ds_write_b128 v107, v[192:195] offset:4096
  v_mfma_f32_32x32x16_bf16 v[32:47], a[52:55], a[196:199], v[32:47]
  buffer_store_dwordx4 v[192:195], v1, s[8:11], s80 offen offset:0
  v_mfma_f32_32x32x16_bf16 v[48:63], a[56:59], a[176:179], 0
  v_cvt_pk_bf16_f32 v196, v16, v17
  v_cvt_pk_bf16_f32 v197, v18, v19
  v_cvt_pk_bf16_f32 v198, v20, v21
  v_cvt_pk_bf16_f32 v199, v22, v23
  v_mfma_f32_32x32x16_bf16 v[48:63], a[60:63], a[180:183], v[48:63]
  ds_write_b128 v107, v[196:199] offset:5120
  v_mfma_f32_32x32x16_bf16 v[48:63], a[64:67], a[184:187], v[48:63]
  buffer_store_dwordx4 v[196:199], v1, s[8:11], s80 offen offset:1024
  v_cvt_pk_bf16_f32 v200, v24, v25
  v_mfma_f32_32x32x16_bf16 v[48:63], a[68:71], a[188:191], v[48:63]
  v_cvt_pk_bf16_f32 v201, v26, v27
  v_cvt_pk_bf16_f32 v202, v28, v29
  v_cvt_pk_bf16_f32 v203, v30, v31
  v_mfma_f32_32x32x16_bf16 v[48:63], a[72:75], a[192:195], v[48:63]
  ds_write_b128 v107, v[200:203] offset:6144
  v_mfma_f32_32x32x16_bf16 v[48:63], a[76:79], a[196:199], v[48:63]
  buffer_store_dwordx4 v[200:203], v1, s[8:11], s80 offen offset:2048
  v_mfma_f32_32x32x16_bf16 v[64:79], a[80:83], a[176:179], 0
  v_add_u32 v107, s85, v1
  v_pk_mul_f32 v[32:33], v[32:33], s[46:47]
  v_pk_mul_f32 v[34:35], v[34:35], s[46:47]
  v_pk_mul_f32 v[36:37], v[36:37], s[46:47]
  v_pk_mul_f32 v[38:39], v[38:39], s[46:47]
  v_pk_mul_f32 v[40:41], v[40:41], s[46:47]
  v_mfma_f32_32x32x16_bf16 v[64:79], a[84:87], a[180:183], v[64:79]
  v_pk_mul_f32 v[42:43], v[42:43], s[46:47]
  v_pk_mul_f32 v[44:45], v[44:45], s[46:47]
  v_pk_mul_f32 v[46:47], v[46:47], s[46:47]
  v_cvt_pk_bf16_f32 v220, v32, v33
  v_cvt_pk_bf16_f32 v221, v34, v35
  v_cvt_pk_bf16_f32 v222, v36, v37
  v_mfma_f32_32x32x16_bf16 v[64:79], a[88:91], a[184:187], v[64:79]
  v_cvt_pk_bf16_f32 v223, v38, v39
  v_cvt_pk_bf16_f32 v224, v40, v41
  v_cvt_pk_bf16_f32 v225, v42, v43
  v_cvt_pk_bf16_f32 v226, v44, v45
  v_cvt_pk_bf16_f32 v227, v46, v47
  v_mfma_f32_32x32x16_bf16 v[64:79], a[92:95], a[188:191], v[64:79]
  v_mfma_f32_32x32x16_bf16 v[64:79], a[96:99], a[192:195], v[64:79]
  v_mfma_f32_32x32x16_bf16 v[64:79], a[100:103], a[196:199], v[64:79]
  s_waitcnt vmcnt(7)
  v_mfma_f32_32x32x16_bf16 v[16:31], a[176:179], a[104:107], 0
  ds_read_b128 a[200:203], v106 offset:0
  ds_read_b128 a[204:207], v106 offset:32
  ds_read_b128 a[208:211], v106 offset:64
  ds_read_b128 a[212:215], v106 offset:96
  v_mfma_f32_32x32x16_bf16 v[16:31], a[180:183], a[108:111], v[16:31]
  ds_read_b128 a[216:219], v106 offset:128
  ds_read_b128 a[220:223], v106 offset:160
  v_pk_mul_f32 v[48:49], v[48:49], s[46:47]
  v_pk_mul_f32 v[50:51], v[50:51], s[46:47]
  v_pk_mul_f32 v[52:53], v[52:53], s[46:47]
  v_mfma_f32_32x32x16_bf16 v[16:31], a[184:187], a[112:115], v[16:31]
  v_pk_mul_f32 v[54:55], v[54:55], s[46:47]
  v_cvt_pk_bf16_f32 v228, v48, v49
  v_cvt_pk_bf16_f32 v229, v50, v51
  v_cvt_pk_bf16_f32 v230, v52, v53
  v_cvt_pk_bf16_f32 v231, v54, v55
  v_cvt_pk_bf16_f32 v204, v56, v57
  v_mfma_f32_32x32x16_bf16 v[16:31], a[188:191], a[116:119], v[16:31]
  v_cvt_pk_bf16_f32 v205, v58, v59
  v_cvt_pk_bf16_f32 v206, v60, v61
  v_cvt_pk_bf16_f32 v207, v62, v63
  v_mfma_f32_32x32x16_bf16 v[16:31], a[192:195], a[120:123], v[16:31]
  ds_write_b128 v107, v[204:207] offset:0
  v_mfma_f32_32x32x16_bf16 v[16:31], a[196:199], a[124:127], v[16:31]
  buffer_store_dwordx4 v[204:207], v1, s[8:11], s77 offen offset:0
  s_waitcnt lgkmcnt(0)
  v_mfma_f32_32x32x16_bf16 v[32:47], a[176:179], a[128:131], v[176:191]
  v_cvt_pk_bf16_f32 v192, v64, v65
  v_cvt_pk_bf16_f32 v193, v66, v67
  v_cvt_pk_bf16_f32 v194, v68, v69
  v_cvt_pk_bf16_f32 v195, v70, v71
  v_mfma_f32_32x32x16_bf16 v[32:47], a[180:183], a[132:135], v[32:47]
  ds_write_b128 v107, v[192:195] offset:1024
  v_mfma_f32_32x32x16_bf16 v[32:47], a[184:187], a[136:139], v[32:47]
  buffer_store_dwordx4 v[192:195], v1, s[8:11], s77 offen offset:1024
  v_cvt_pk_bf16_f32 v196, v72, v73
  v_mfma_f32_32x32x16_bf16 v[32:47], a[188:191], a[140:143], v[32:47]
  v_cvt_pk_bf16_f32 v197, v74, v75
  v_cvt_pk_bf16_f32 v198, v76, v77
  v_cvt_pk_bf16_f32 v199, v78, v79
  v_mfma_f32_32x32x16_bf16 v[32:47], a[192:195], a[144:147], v[32:47]
  ds_write_b128 v107, v[196:199] offset:2048
  v_mfma_f32_32x32x16_bf16 v[32:47], a[196:199], a[148:151], v[32:47]
  buffer_store_dwordx4 v[196:199], v1, s[8:11], s77 offen offset:2048
  v_mfma_f32_32x32x16_bf16 v[48:63], a[32:35], a[200:203], 0
  v_cvt_pk_bf16_f32 v200, v16, v17
  v_cvt_pk_bf16_f32 v201, v18, v19
  v_cvt_pk_bf16_f32 v202, v20, v21
  v_cvt_pk_bf16_f32 v203, v22, v23
  v_mfma_f32_32x32x16_bf16 v[48:63], a[36:39], a[204:207], v[48:63]
  ds_write_b128 v107, v[200:203] offset:3072
  v_mfma_f32_32x32x16_bf16 v[48:63], a[40:43], a[208:211], v[48:63]
  buffer_store_dwordx4 v[200:203], v1, s[8:11], s77 offen offset:3072
  v_cvt_pk_bf16_f32 v204, v24, v25
  v_mfma_f32_32x32x16_bf16 v[48:63], a[44:47], a[212:215], v[48:63]
  v_cvt_pk_bf16_f32 v205, v26, v27
  v_cvt_pk_bf16_f32 v206, v28, v29
  v_cvt_pk_bf16_f32 v207, v30, v31
  v_mfma_f32_32x32x16_bf16 v[48:63], a[48:51], a[216:219], v[48:63]
  ds_write_b128 v107, v[204:207] offset:4096
  v_mfma_f32_32x32x16_bf16 v[48:63], a[52:55], a[220:223], v[48:63]
  buffer_store_dwordx4 v[204:207], v1, s[8:11], s81 offen offset:0
  v_mfma_f32_32x32x16_bf16 v[64:79], a[56:59], a[200:203], 0
  v_cvt_pk_bf16_f32 v192, v32, v33
  v_cvt_pk_bf16_f32 v193, v34, v35
  v_cvt_pk_bf16_f32 v194, v36, v37
  v_cvt_pk_bf16_f32 v195, v38, v39
  v_mfma_f32_32x32x16_bf16 v[64:79], a[60:63], a[204:207], v[64:79]
  ds_write_b128 v107, v[192:195] offset:5120
  v_mfma_f32_32x32x16_bf16 v[64:79], a[64:67], a[208:211], v[64:79]
  buffer_store_dwordx4 v[192:195], v1, s[8:11], s81 offen offset:1024
  v_cvt_pk_bf16_f32 v196, v40, v41
  v_mfma_f32_32x32x16_bf16 v[64:79], a[68:71], a[212:215], v[64:79]
  v_cvt_pk_bf16_f32 v197, v42, v43
  v_cvt_pk_bf16_f32 v198, v44, v45
  v_cvt_pk_bf16_f32 v199, v46, v47
  v_mfma_f32_32x32x16_bf16 v[64:79], a[72:75], a[216:219], v[64:79]
  ds_write_b128 v107, v[196:199] offset:6144
  v_mfma_f32_32x32x16_bf16 v[64:79], a[76:79], a[220:223], v[64:79]
  buffer_store_dwordx4 v[196:199], v1, s[8:11], s81 offen offset:2048
  v_mfma_f32_32x32x16_bf16 v[16:31], a[80:83], a[200:203], 0
  v_add_u32 v107, s86, v1
  v_pk_mul_f32 v[48:49], v[48:49], s[46:47]
  v_pk_mul_f32 v[50:51], v[50:51], s[46:47]
  v_pk_mul_f32 v[52:53], v[52:53], s[46:47]
  v_pk_mul_f32 v[54:55], v[54:55], s[46:47]
  v_pk_mul_f32 v[56:57], v[56:57], s[46:47]
  v_mfma_f32_32x32x16_bf16 v[16:31], a[84:87], a[204:207], v[16:31]
  v_pk_mul_f32 v[58:59], v[58:59], s[46:47]
  v_pk_mul_f32 v[60:61], v[60:61], s[46:47]
  v_pk_mul_f32 v[62:63], v[62:63], s[46:47]
  v_cvt_pk_bf16_f32 v232, v48, v49
  v_cvt_pk_bf16_f32 v233, v50, v51
  v_cvt_pk_bf16_f32 v234, v52, v53
  v_mfma_f32_32x32x16_bf16 v[16:31], a[88:91], a[208:211], v[16:31]
  v_cvt_pk_bf16_f32 v235, v54, v55
  v_cvt_pk_bf16_f32 v236, v56, v57
  v_cvt_pk_bf16_f32 v237, v58, v59
  v_cvt_pk_bf16_f32 v238, v60, v61
  v_cvt_pk_bf16_f32 v239, v62, v63
  v_mfma_f32_32x32x16_bf16 v[16:31], a[92:95], a[212:215], v[16:31]
  v_mfma_f32_32x32x16_bf16 v[16:31], a[96:99], a[216:219], v[16:31]
  v_mfma_f32_32x32x16_bf16 v[16:31], a[100:103], a[220:223], v[16:31]
  s_cmp_eq_u32 s31, 0
  s_cbranch_scc1 L_prodV
  s_waitcnt vmcnt(13)
  v_mfma_f32_32x32x16_bf16 v[32:47], a[200:203], a[104:107], 0
  ds_read_b128 a[224:227], v106 offset:6144
  ds_read_b128 a[228:231], v106 offset:6176
  ds_read_b128 a[232:235], v106 offset:6208
  ds_read_b128 a[236:239], v106 offset:6240
  v_mfma_f32_32x32x16_bf16 v[32:47], a[204:207], a[108:111], v[32:47]
  ds_read_b128 a[240:243], v106 offset:6272
  ds_read_b128 a[244:247], v106 offset:6304
  v_pk_mul_f32 v[64:65], v[64:65], s[46:47]
  v_pk_mul_f32 v[66:67], v[66:67], s[46:47]
  v_pk_mul_f32 v[68:69], v[68:69], s[46:47]
  v_mfma_f32_32x32x16_bf16 v[32:47], a[208:211], a[112:115], v[32:47]
  v_pk_mul_f32 v[70:71], v[70:71], s[46:47]
  v_cvt_pk_bf16_f32 v240, v64, v65
  v_cvt_pk_bf16_f32 v241, v66, v67
  v_cvt_pk_bf16_f32 v242, v68, v69
  v_cvt_pk_bf16_f32 v243, v70, v71
  v_cvt_pk_bf16_f32 v200, v72, v73
  v_mfma_f32_32x32x16_bf16 v[32:47], a[212:215], a[116:119], v[32:47]
  v_cvt_pk_bf16_f32 v201, v74, v75
  v_cvt_pk_bf16_f32 v202, v76, v77
  v_cvt_pk_bf16_f32 v203, v78, v79
  v_mfma_f32_32x32x16_bf16 v[32:47], a[216:219], a[120:123], v[32:47]
  ds_write_b128 v107, v[200:203] offset:0
  v_mfma_f32_32x32x16_bf16 v[32:47], a[220:223], a[124:127], v[32:47]
  buffer_store_dwordx4 v[200:203], v1, s[8:11], s78 offen offset:0
  s_waitcnt lgkmcnt(0)
  v_mfma_f32_32x32x16_bf16 v[48:63], a[200:203], a[128:131], v[176:191]
  v_cvt_pk_bf16_f32 v204, v16, v17
  v_cvt_pk_bf16_f32 v205, v18, v19
  v_cvt_pk_bf16_f32 v206, v20, v21
  v_cvt_pk_bf16_f32 v207, v22, v23
  v_mfma_f32_32x32x16_bf16 v[48:63], a[204:207], a[132:135], v[48:63]
  ds_write_b128 v107, v[204:207] offset:1024
  v_mfma_f32_32x32x16_bf16 v[48:63], a[208:211], a[136:139], v[48:63]
  buffer_store_dwordx4 v[204:207], v1, s[8:11], s78 offen offset:1024
  v_cvt_pk_bf16_f32 v192, v24, v25
  v_mfma_f32_32x32x16_bf16 v[48:63], a[212:215], a[140:143], v[48:63]
  v_cvt_pk_bf16_f32 v193, v26, v27
  v_cvt_pk_bf16_f32 v194, v28, v29
  v_cvt_pk_bf16_f32 v195, v30, v31
  v_mfma_f32_32x32x16_bf16 v[48:63], a[216:219], a[144:147], v[48:63]
  ds_write_b128 v107, v[192:195] offset:2048
  v_mfma_f32_32x32x16_bf16 v[48:63], a[220:223], a[148:151], v[48:63]
  buffer_store_dwordx4 v[192:195], v1, s[8:11], s78 offen offset:2048
  s_and_b32 s36, s30, 1
  s_cmp_eq_u32 s36, 0
  s_cbranch_scc0 L_prodHodd
  v_mfma_f32_32x32x16_bf16 v[64:79], a[32:35], a[224:227], 0
  v_cvt_pk_bf16_f32 v196, v32, v33
  v_cvt_pk_bf16_f32 v197, v34, v35
  v_cvt_pk_bf16_f32 v198, v36, v37
  v_cvt_pk_bf16_f32 v199, v38, v39
  v_mfma_f32_32x32x16_bf16 v[64:79], a[36:39], a[228:231], v[64:79]
  ds_write_b128 v107, v[196:199] offset:3072
  v_mfma_f32_32x32x16_bf16 v[64:79], a[40:43], a[232:235], v[64:79]
  buffer_store_dwordx4 v[196:199], v1, s[8:11], s78 offen offset:3072
  v_cvt_pk_bf16_f32 v200, v40, v41
  v_mfma_f32_32x32x16_bf16 v[64:79], a[44:47], a[236:239], v[64:79]
  v_cvt_pk_bf16_f32 v201, v42, v43
  v_cvt_pk_bf16_f32 v202, v44, v45
  v_cvt_pk_bf16_f32 v203, v46, v47
  v_mfma_f32_32x32x16_bf16 v[64:79], a[48:51], a[240:243], v[64:79]
  ds_write_b128 v107, v[200:203] offset:4096
  v_mfma_f32_32x32x16_bf16 v[64:79], a[52:55], a[244:247], v[64:79]
  buffer_store_dwordx4 v[200:203], v1, s[8:11], s82 offen offset:0
  v_mfma_f32_32x32x16_bf16 v[16:31], a[56:59], a[224:227], 0
  v_cvt_pk_bf16_f32 v204, v48, v49
  v_cvt_pk_bf16_f32 v205, v50, v51
  v_cvt_pk_bf16_f32 v206, v52, v53
  v_cvt_pk_bf16_f32 v207, v54, v55
  v_mfma_f32_32x32x16_bf16 v[16:31], a[60:63], a[228:231], v[16:31]
  ds_write_b128 v107, v[204:207] offset:5120
  v_mfma_f32_32x32x16_bf16 v[16:31], a[64:67], a[232:235], v[16:31]
  buffer_store_dwordx4 v[204:207], v1, s[8:11], s82 offen offset:1024
  v_cvt_pk_bf16_f32 v192, v56, v57
  v_mfma_f32_32x32x16_bf16 v[16:31], a[68:71], a[236:239], v[16:31]
  v_cvt_pk_bf16_f32 v193, v58, v59
  v_cvt_pk_bf16_f32 v194, v60, v61
  v_cvt_pk_bf16_f32 v195, v62, v63
  v_mfma_f32_32x32x16_bf16 v[16:31], a[72:75], a[240:243], v[16:31]
  ds_write_b128 v107, v[192:195] offset:6144
  v_mfma_f32_32x32x16_bf16 v[16:31], a[76:79], a[244:247], v[16:31]
  buffer_store_dwordx4 v[192:195], v1, s[8:11], s82 offen offset:2048
  v_mfma_f32_32x32x16_bf16 v[32:47], a[80:83], a[224:227], 0
  v_pk_mul_f32 v[64:65], v[64:65], s[46:47]
  v_pk_mul_f32 v[66:67], v[66:67], s[46:47]
  v_pk_mul_f32 v[68:69], v[68:69], s[46:47]
  v_pk_mul_f32 v[70:71], v[70:71], s[46:47]
  v_pk_mul_f32 v[72:73], v[72:73], s[46:47]
  v_pk_mul_f32 v[74:75], v[74:75], s[46:47]
  v_mfma_f32_32x32x16_bf16 v[32:47], a[84:87], a[228:231], v[32:47]
  v_pk_mul_f32 v[76:77], v[76:77], s[46:47]
  v_pk_mul_f32 v[78:79], v[78:79], s[46:47]
  v_cvt_pk_bf16_f32 v244, v64, v65
  v_cvt_pk_bf16_f32 v245, v66, v67
  v_cvt_pk_bf16_f32 v246, v68, v69
  v_cvt_pk_bf16_f32 v247, v70, v71
  v_mfma_f32_32x32x16_bf16 v[32:47], a[88:91], a[232:235], v[32:47]
  v_cvt_pk_bf16_f32 v248, v72, v73
  v_cvt_pk_bf16_f32 v249, v74, v75
  v_cvt_pk_bf16_f32 v250, v76, v77
  v_cvt_pk_bf16_f32 v251, v78, v79
  v_mfma_f32_32x32x16_bf16 v[32:47], a[92:95], a[236:239], v[32:47]
  v_mfma_f32_32x32x16_bf16 v[32:47], a[96:99], a[240:243], v[32:47]
  v_mfma_f32_32x32x16_bf16 v[32:47], a[100:103], a[244:247], v[32:47]
  s_nop 3
  v_pk_mul_f32 v[16:17], v[16:17], s[46:47]
  v_pk_mul_f32 v[18:19], v[18:19], s[46:47]
  v_pk_mul_f32 v[20:21], v[20:21], s[46:47]
  v_pk_mul_f32 v[22:23], v[22:23], s[46:47]
  v_cvt_pk_bf16_f32 v252, v16, v17
  v_cvt_pk_bf16_f32 v253, v18, v19
  v_cvt_pk_bf16_f32 v254, v20, v21
  v_cvt_pk_bf16_f32 v255, v22, v23
  v_cvt_pk_bf16_f32 v196, v24, v25
  v_cvt_pk_bf16_f32 v197, v26, v27
  v_cvt_pk_bf16_f32 v198, v28, v29
  v_cvt_pk_bf16_f32 v199, v30, v31
  buffer_store_dwordx4 v[196:199], v1, s[8:11], s79 offen offset:0
  v_add_u32 v0, s99, v1
  ds_write_b128 v0, v[244:247] offset:0
  ds_write_b128 v0, v[248:251] offset:1024
  ds_write_b128 v0, v[252:255] offset:2048
  s_nop 3
  v_cvt_pk_bf16_f32 v200, v32, v33
  v_cvt_pk_bf16_f32 v201, v34, v35
  v_cvt_pk_bf16_f32 v202, v36, v37
  v_cvt_pk_bf16_f32 v203, v38, v39
  buffer_store_dwordx4 v[200:203], v1, s[8:11], s79 offen offset:1024
  v_cvt_pk_bf16_f32 v204, v40, v41
  v_cvt_pk_bf16_f32 v205, v42, v43
  v_cvt_pk_bf16_f32 v206, v44, v45
  v_cvt_pk_bf16_f32 v207, v46, v47
  buffer_store_dwordx4 v[204:207], v1, s[8:11], s79 offen offset:2048
  s_branch L_proddone
L_prodHodd:
  v_mfma_f32_32x32x16_bf16 v[64:79], a[224:227], a[104:107], 0
  v_cvt_pk_bf16_f32 v200, v32, v33
  v_cvt_pk_bf16_f32 v201, v34, v35
  v_cvt_pk_bf16_f32 v202, v36, v37
  v_cvt_pk_bf16_f32 v203, v38, v39
  v_mfma_f32_32x32x16_bf16 v[64:79], a[228:231], a[108:111], v[64:79]
  ds_write_b128 v107, v[200:203] offset:3072
  v_mfma_f32_32x32x16_bf16 v[64:79], a[232:235], a[112:115], v[64:79]
  buffer_store_dwordx4 v[200:203], v1, s[8:11], s78 offen offset:3072
  v_cvt_pk_bf16_f32 v204, v40, v41
  v_mfma_f32_32x32x16_bf16 v[64:79], a[236:239], a[116:119], v[64:79]
  v_cvt_pk_bf16_f32 v205, v42, v43
  v_cvt_pk_bf16_f32 v206, v44, v45
  v_cvt_pk_bf16_f32 v207, v46, v47
  v_mfma_f32_32x32x16_bf16 v[64:79], a[240:243], a[120:123], v[64:79]
  ds_write_b128 v107, v[204:207] offset:4096
  v_mfma_f32_32x32x16_bf16 v[64:79], a[244:247], a[124:127], v[64:79]
  buffer_store_dwordx4 v[204:207], v1, s[8:11], s82 offen offset:0
  v_mfma_f32_32x32x16_bf16 v[16:31], a[224:227], a[128:131], v[176:191]
  v_cvt_pk_bf16_f32 v192, v48, v49
  v_cvt_pk_bf16_f32 v193, v50, v51
  v_cvt_pk_bf16_f32 v194, v52, v53
  v_cvt_pk_bf16_f32 v195, v54, v55
  v_mfma_f32_32x32x16_bf16 v[16:31], a[228:231], a[132:135], v[16:31]
  ds_write_b128 v107, v[192:195] offset:5120
  v_mfma_f32_32x32x16_bf16 v[16:31], a[232:235], a[136:139], v[16:31]
  buffer_store_dwordx4 v[192:195], v1, s[8:11], s82 offen offset:1024
  v_cvt_pk_bf16_f32 v196, v56, v57
  v_mfma_f32_32x32x16_bf16 v[16:31], a[236:239], a[140:143], v[16:31]
  v_cvt_pk_bf16_f32 v197, v58, v59
  v_cvt_pk_bf16_f32 v198, v60, v61
  v_cvt_pk_bf16_f32 v199, v62, v63
  v_mfma_f32_32x32x16_bf16 v[16:31], a[240:243], a[144:147], v[16:31]
  ds_write_b128 v107, v[196:199] offset:6144
  v_mfma_f32_32x32x16_bf16 v[16:31], a[244:247], a[148:151], v[16:31]
  buffer_store_dwordx4 v[196:199], v1, s[8:11], s82 offen offset:2048
  s_nop 7
  v_cvt_pk_bf16_f32 v200, v64, v65
  v_cvt_pk_bf16_f32 v201, v66, v67
  v_cvt_pk_bf16_f32 v202, v68, v69
  v_cvt_pk_bf16_f32 v203, v70, v71
  buffer_store_dwordx4 v[200:203], v1, s[8:11], s79 offen offset:3072
  v_cvt_pk_bf16_f32 v204, v72, v73
  v_cvt_pk_bf16_f32 v205, v74, v75
  v_cvt_pk_bf16_f32 v206, v76, v77
  v_cvt_pk_bf16_f32 v207, v78, v79
  buffer_store_dwordx4 v[204:207], v1, s[8:11], s83 offen offset:0
  s_nop 3
  v_cvt_pk_bf16_f32 v192, v16, v17
  v_cvt_pk_bf16_f32 v193, v18, v19
  v_cvt_pk_bf16_f32 v194, v20, v21
  v_cvt_pk_bf16_f32 v195, v22, v23
  buffer_store_dwordx4 v[192:195], v1, s[8:11], s83 offen offset:1024
  v_cvt_pk_bf16_f32 v196, v24, v25
  v_cvt_pk_bf16_f32 v197, v26, v27
  v_cvt_pk_bf16_f32 v198, v28, v29
  v_cvt_pk_bf16_f32 v199, v30, v31
  buffer_store_dwordx4 v[196:199], v1, s[8:11], s83 offen offset:2048
  s_branch L_proddone
L_prodV:
  v_mfma_f32_32x32x16_bf16 v[32:47], a[200:203], a[104:107], 0
  v_pk_mul_f32 v[64:65], v[64:65], s[46:47]
  v_pk_mul_f32 v[66:67], v[66:67], s[46:47]
  v_pk_mul_f32 v[68:69], v[68:69], s[46:47]
  v_pk_mul_f32 v[70:71], v[70:71], s[46:47]
  v_cvt_pk_bf16_f32 v240, v64, v65
  v_cvt_pk_bf16_f32 v241, v66, v67
  v_mfma_f32_32x32x16_bf16 v[32:47], a[204:207], a[108:111], v[32:47]
  v_cvt_pk_bf16_f32 v242, v68, v69
  v_cvt_pk_bf16_f32 v243, v70, v71
  v_cvt_pk_bf16_f32 v200, v72, v73
  v_cvt_pk_bf16_f32 v201, v74, v75
  v_cvt_pk_bf16_f32 v202, v76, v77
  v_cvt_pk_bf16_f32 v203, v78, v79
  v_mfma_f32_32x32x16_bf16 v[32:47], a[208:211], a[112:115], v[32:47]
  ds_write_b128 v107, v[200:203] offset:0
  v_mfma_f32_32x32x16_bf16 v[32:47], a[212:215], a[116:119], v[32:47]
  buffer_store_dwordx4 v[200:203], v1, s[8:11], s78 offen offset:0
  v_mfma_f32_32x32x16_bf16 v[32:47], a[216:219], a[120:123], v[32:47]
  v_mfma_f32_32x32x16_bf16 v[32:47], a[220:223], a[124:127], v[32:47]
  v_mfma_f32_32x32x16_bf16 v[48:63], a[200:203], a[128:131], v[176:191]
  v_cvt_pk_bf16_f32 v204, v16, v17
  v_cvt_pk_bf16_f32 v205, v18, v19
  v_cvt_pk_bf16_f32 v206, v20, v21
  v_cvt_pk_bf16_f32 v207, v22, v23
  v_mfma_f32_32x32x16_bf16 v[48:63], a[204:207], a[132:135], v[48:63]
  ds_write_b128 v107, v[204:207] offset:1024
  v_mfma_f32_32x32x16_bf16 v[48:63], a[208:211], a[136:139], v[48:63]
  buffer_store_dwordx4 v[204:207], v1, s[8:11], s78 offen offset:1024
  v_cvt_pk_bf16_f32 v192, v24, v25
  v_mfma_f32_32x32x16_bf16 v[48:63], a[212:215], a[140:143], v[48:63]
  v_cvt_pk_bf16_f32 v193, v26, v27
  v_cvt_pk_bf16_f32 v194, v28, v29
  v_cvt_pk_bf16_f32 v195, v30, v31
  v_mfma_f32_32x32x16_bf16 v[48:63], a[216:219], a[144:147], v[48:63]
  ds_write_b128 v107, v[192:195] offset:2048
  v_mfma_f32_32x32x16_bf16 v[48:63], a[220:223], a[148:151], v[48:63]
  buffer_store_dwordx4 v[192:195], v1, s[8:11], s78 offen offset:2048
  s_nop 3
  v_cvt_pk_bf16_f32 v196, v32, v33
  v_cvt_pk_bf16_f32 v197, v34, v35
  v_cvt_pk_bf16_f32 v198, v36, v37
  v_cvt_pk_bf16_f32 v199, v38, v39
  ds_write_b128 v107, v[196:199] offset:3072
  buffer_store_dwordx4 v[196:199], v1, s[8:11], s78 offen offset:3072
  v_cvt_pk_bf16_f32 v200, v40, v41
  v_cvt_pk_bf16_f32 v201, v42, v43
  v_cvt_pk_bf16_f32 v202, v44, v45
  v_cvt_pk_bf16_f32 v203, v46, v47
  ds_write_b128 v107, v[200:203] offset:4096
  buffer_store_dwordx4 v[200:203], v1, s[8:11], s82 offen offset:0
  s_nop 3
  v_cvt_pk_bf16_f32 v204, v48, v49
  v_cvt_pk_bf16_f32 v205, v50, v51
  v_cvt_pk_bf16_f32 v206, v52, v53
  v_cvt_pk_bf16_f32 v207, v54, v55
  ds_write_b128 v107, v[204:207] offset:5120
  buffer_store_dwordx4 v[204:207], v1, s[8:11], s82 offen offset:1024
  v_cvt_pk_bf16_f32 v192, v56, v57
  v_cvt_pk_bf16_f32 v193, v58, v59
  v_cvt_pk_bf16_f32 v194, v60, v61
  v_cvt_pk_bf16_f32 v195, v62, v63
  ds_write_b128 v107, v[192:195] offset:6144
  buffer_store_dwordx4 v[192:195], v1, s[8:11], s82 offen offset:2048
L_proddone:
  s_cmp_eq_u32 s3, 2
  s_cbranch_scc0 L_noqx
  v_add_u32 v0, s99, v1
  ds_write_b128 v0, v[232:235] offset:0
  ds_write_b128 v0, v[236:239] offset:1024
  ds_write_b128 v0, v[240:243] offset:2048
L_noqx:
  global_load_dword v12, v13, s[44:45] sc1
  s_waitcnt lgkmcnt(0)
  s_barrier
  s_cmp_eq_u32 s3, 2
  s_cbranch_scc0 L_noqr
  s_and_b32 s36, s30, 2
  s_mul_i32 s36, s36, 12288
  s_add_u32 s36, s36, 114688
  v_add_u32 v0, s36, v1
  v_add_u32 v9, 126976, v1
  ds_read_b128 v[232:235], v0 offset:0
  ds_read_b128 v[236:239], v0 offset:1024
  ds_read_b128 v[240:243], v0 offset:2048
  ds_read_b128 v[244:247], v9 offset:0
  ds_read_b128 v[248:251], v9 offset:1024
  ds_read_b128 v[252:255], v9 offset:2048
L_noqr:
  s_and_b32 s36, s30, s31
  s_and_b32 s36, s36, 1
  s_cmp_eq_u32 s36, 1
  s_cbranch_scc0 L_noq3
  s_sub_u32 s36, s99, 12288
  v_add_u32 v0, s36, v1
  ds_read_b128 v[244:247], v0 offset:0
  ds_read_b128 v[248:251], v0 offset:1024
  ds_read_b128 v[252:255], v0 offset:2048
L_noq3:
  s_cmp_eq_u32 s3, 0
  s_cbranch_scc1 L_startV
  s_cmp_eq_u32 s3, 2
  s_cbranch_scc1 L_startW
  ds_read_b128 a[0:3], v2 offset:0
  ds_read_b128 a[4:7], v2 offset:1024
  ds_read_b128 a[8:11], v2 offset:2048
  ds_read_b128 a[60:63], v2 offset:6144
  ds_read_b128 a[56:59], v2 offset:5120
  ds_read_b128 a[32:35], v4 offset:2048
  ds_read_b128 a[52:55], v2 offset:4096
  s_waitcnt lgkmcnt(4)
  v_mfma_f32_32x32x16_bf16 v[144:159], a[0:3], v[208:211], 0
  ds_read_b128 a[28:31], v4 offset:1024
  ds_read_b128 a[48:51], v2 offset:3072
  ds_read_b128 a[20:23], v3 offset:2048
  v_mfma_f32_32x32x16_bf16 v[144:159], a[4:7], v[212:215], v[144:159]
  v_mfma_f32_32x32x16_bf16 v[144:159], a[8:11], v[216:219], v[144:159]
  s_waitcnt lgkmcnt(0)
  s_nop 7
  s_nop 3
  v_mfma_f32_32x32x16_bf16 v[160:175], a[0:3], v[220:223], 0
  ds_read_b128 a[12:15], v3 offset:0
  v_exp_f32 v176, v144
  v_exp_f32 v177, v145
  v_exp_f32 v178, v146
  ds_read_b128 a[16:19], v3 offset:1024
  v_exp_f32 v179, v147
  v_exp_f32 v180, v148
  v_cvt_pk_bf16_f32 v192, v176, v177
  v_mfma_f32_32x32x16_bf16 v[160:175], a[4:7], v[224:227], v[160:175]
  ds_read_b128 a[40:43], v5 offset:1024
  v_exp_f32 v181, v149
  v_cvt_pk_bf16_f32 v206, v188, v189
  v_cvt_pk_bf16_f32 v207, v190, v191
  v_cvt_pk_bf16_f32 v193, v178, v179
  v_exp_f32 v182, v150
  v_exp_f32 v183, v151
  v_exp_f32 v184, v152
  v_mfma_f32_32x32x16_bf16 v[160:175], a[8:11], v[228:231], v[160:175]
  v_exp_f32 v185, v153
  v_exp_f32 v186, v154
  v_cvt_pk_bf16_f32 v194, v180, v181
  v_cvt_pk_bf16_f32 v195, v182, v183
  v_exp_f32 v187, v155
  v_exp_f32 v188, v156
  v_exp_f32 v189, v157
  v_exp_f32 v190, v158
  v_exp_f32 v191, v159
  v_cvt_pk_bf16_f32 v196, v184, v185
  v_cvt_pk_bf16_f32 v197, v186, v187
  v_mfma_f32_32x32x16_bf16 v[144:159], a[0:3], v[232:235], 0
  s_nop 0
  v_exp_f32 v176, v160
  v_exp_f32 v177, v161
  v_exp_f32 v178, v162
  v_mfma_f32_32x32x16_bf16 v[16:31], a[48:51], v[192:195], 0
  ds_read_b128 a[68:71], v3 offset:4096
  v_exp_f32 v179, v163
  v_exp_f32 v180, v164
  v_cvt_pk_bf16_f32 v200, v176, v177
  v_mfma_f32_32x32x16_bf16 v[144:159], a[4:7], v[236:239], v[144:159]
  ds_read_b128 a[76:79], v3 offset:6144
  v_exp_f32 v181, v165
  v_cvt_pk_bf16_f32 v198, v188, v189
  v_cvt_pk_bf16_f32 v199, v190, v191
  v_cvt_pk_bf16_f32 v201, v178, v179
  v_mfma_f32_32x32x16_bf16 v[32:47], a[56:59], v[192:195], 0
  ds_read_b128 a[36:39], v5 offset:0
  v_exp_f32 v182, v166
  v_exp_f32 v183, v167
  v_cvt_pk_bf16_f32 v202, v180, v181
  v_mfma_f32_32x32x16_bf16 v[144:159], a[8:11], v[240:243], v[144:159]
  s_mul_i32 s36, s30, 5120
  v_exp_f32 v184, v168
  v_exp_f32 v185, v169
  v_exp_f32 v186, v170
  v_mfma_f32_32x32x16_bf16 v[16:31], a[52:55], v[196:199], v[16:31]
  s_add_u32 m0, s36, 145408
  v_exp_f32 v187, v171
  v_exp_f32 v188, v172
  v_cvt_pk_bf16_f32 v203, v182, v183
  v_cvt_pk_bf16_f32 v204, v184, v185
  v_mfma_f32_32x32x16_bf16 v[32:47], a[60:63], v[196:199], v[32:47]
  s_waitcnt lgkmcnt(4)
  v_exp_f32 v189, v173
  v_exp_f32 v190, v174
  v_exp_f32 v191, v175
  v_cvt_pk_bf16_f32 v205, v186, v187
  v_mfma_f32_32x32x16_bf16 v[160:175], a[12:15], v[208:211], 0
  ds_read_b128 a[64:67], v3 offset:3072
  v_exp_f32 v176, v144
  v_exp_f32 v177, v145
  v_exp_f32 v178, v146
  v_mfma_f32_32x32x16_bf16 v[48:63], a[48:51], v[200:203], 0
  ds_read_b128 a[72:75], v3 offset:5120
  v_exp_f32 v179, v147
  v_exp_f32 v180, v148
  v_cvt_pk_bf16_f32 v192, v176, v177
  v_mfma_f32_32x32x16_bf16 v[160:175], a[16:19], v[212:215], v[160:175]
  ds_read_b128 a[108:111], v5 offset:6144
  v_exp_f32 v181, v149
  v_cvt_pk_bf16_f32 v206, v188, v189
  v_cvt_pk_bf16_f32 v207, v190, v191
  v_cvt_pk_bf16_f32 v193, v178, v179
  v_mfma_f32_32x32x16_bf16 v[64:79], a[56:59], v[200:203], 0
  buffer_load_dwordx4 v1, s[52:55], s36 offen offset:0 lds
  v_exp_f32 v182, v150
  v_exp_f32 v183, v151
  v_mfma_f32_32x32x16_bf16 v[160:175], a[20:23], v[216:219], v[160:175]
  buffer_load_dwordx4 v1, s[52:55], s36 offen offset:1024 lds
  v_exp_f32 v184, v152
  v_cvt_pk_bf16_f32 v194, v180, v181
  v_cvt_pk_bf16_f32 v195, v182, v183
  v_mfma_f32_32x32x16_bf16 v[48:63], a[52:55], v[204:207], v[48:63]
  buffer_load_dwordx4 v1, s[52:55], s36 offen offset:2048 lds
  v_exp_f32 v185, v153
  v_exp_f32 v186, v154
  v_exp_f32 v187, v155
  v_mfma_f32_32x32x16_bf16 v[64:79], a[60:63], v[204:207], v[64:79]
  buffer_load_dwordx4 v1, s[52:55], s36 offen offset:3072 lds
  v_exp_f32 v188, v156
  v_exp_f32 v189, v157
  v_exp_f32 v190, v158
  v_exp_f32 v191, v159
  v_cvt_pk_bf16_f32 v196, v184, v185
  v_cvt_pk_bf16_f32 v197, v186, v187
  v_mfma_f32_32x32x16_bf16 v[144:159], a[12:15], v[220:223], 0
  ds_read_b128 a[24:27], v4 offset:0
  v_exp_f32 v176, v160
  v_exp_f32 v177, v161
  v_exp_f32 v178, v162
  v_mfma_f32_32x32x16_bf16 v[80:95], a[48:51], v[192:195], 0
  ds_read_b128 a[84:87], v4 offset:4096
  v_exp_f32 v179, v163
  v_exp_f32 v180, v164
  v_cvt_pk_bf16_f32 v200, v176, v177
  v_mfma_f32_32x32x16_bf16 v[144:159], a[16:19], v[224:227], v[144:159]
  ds_read_b128 a[104:107], v5 offset:5120
  v_exp_f32 v181, v165
  v_cvt_pk_bf16_f32 v198, v188, v189
  v_cvt_pk_bf16_f32 v199, v190, v191
  v_cvt_pk_bf16_f32 v201, v178, v179
  v_mfma_f32_32x32x16_bf16 v[96:111], a[56:59], v[192:195], 0
  s_add_u32 s36, s36, 4096
  v_exp_f32 v182, v166
  v_exp_f32 v183, v167
  v_exp_f32 v184, v168
  v_mfma_f32_32x32x16_bf16 v[144:159], a[20:23], v[228:231], v[144:159]
  s_add_u32 m0, s36, 145408
  v_exp_f32 v185, v169
  v_exp_f32 v186, v170
  v_cvt_pk_bf16_f32 v202, v180, v181
  v_cvt_pk_bf16_f32 v203, v182, v183
  v_mfma_f32_32x32x16_bf16 v[80:95], a[52:55], v[196:199], v[80:95]
  s_nop 0
  v_exp_f32 v187, v171
  v_exp_f32 v188, v172
  v_exp_f32 v189, v173
  v_mfma_f32_32x32x16_bf16 v[96:111], a[60:63], v[196:199], v[96:111]
  buffer_load_dwordx4 v1, s[52:55], s36 offen lds
  v_exp_f32 v190, v174
  v_exp_f32 v191, v175
  v_cvt_pk_bf16_f32 v204, v184, v185
  v_cvt_pk_bf16_f32 v205, v186, v187
  v_mfma_f32_32x32x16_bf16 v[160:175], a[12:15], v[232:235], 0
  s_waitcnt lgkmcnt(4)
  v_exp_f32 v176, v144
  v_exp_f32 v177, v145
  v_exp_f32 v178, v146
  v_mfma_f32_32x32x16_bf16 v[16:31], a[64:67], v[200:203], v[16:31]
  ds_read_b128 a[80:83], v4 offset:3072
  v_exp_f32 v179, v147
  v_exp_f32 v180, v148
  v_cvt_pk_bf16_f32 v192, v176, v177
  v_mfma_f32_32x32x16_bf16 v[160:175], a[16:19], v[236:239], v[160:175]
  ds_read_b128 a[92:95], v4 offset:6144
  v_exp_f32 v181, v149
  v_cvt_pk_bf16_f32 v206, v188, v189
  v_cvt_pk_bf16_f32 v207, v190, v191
  v_cvt_pk_bf16_f32 v193, v178, v179
  v_mfma_f32_32x32x16_bf16 v[32:47], a[72:75], v[200:203], v[32:47]
  ds_read_b128 a[100:103], v5 offset:4096
  v_exp_f32 v182, v150
  v_exp_f32 v183, v151
  v_cvt_pk_bf16_f32 v194, v180, v181
  v_mfma_f32_32x32x16_bf16 v[160:175], a[20:23], v[240:243], v[160:175]
  v_lshrrev_b32 v11, 4, v1
  v_exp_f32 v184, v152
  v_exp_f32 v185, v153
  v_cvt_pk_bf16_f32 v195, v182, v183
  v_mfma_f32_32x32x16_bf16 v[16:31], a[68:71], v[204:207], v[16:31]
  v_lshrrev_b32 v0, 5, v11
  v_exp_f32 v186, v154
  v_exp_f32 v187, v155
  v_cvt_pk_bf16_f32 v196, v184, v185
  v_mfma_f32_32x32x16_bf16 v[32:47], a[76:79], v[204:207], v[32:47]
  v_lshlrev_b32 v0, 2, v0
  v_exp_f32 v188, v156
  v_exp_f32 v189, v157
  v_exp_f32 v190, v158
  v_exp_f32 v191, v159
  v_cvt_pk_bf16_f32 v197, v186, v187
  v_mfma_f32_32x32x16_bf16 v[144:159], a[12:15], v[244:247], 0
  ds_read_b128 a[88:91], v4 offset:5120
  v_exp_f32 v176, v160
  v_exp_f32 v177, v161
  v_exp_f32 v178, v162
  v_mfma_f32_32x32x16_bf16 v[48:63], a[64:67], v[192:195], v[48:63]
  ds_read_b128 a[44:47], v5 offset:2048
  v_exp_f32 v179, v163
  v_exp_f32 v180, v164
  v_cvt_pk_bf16_f32 v200, v176, v177
  v_mfma_f32_32x32x16_bf16 v[144:159], a[16:19], v[248:251], v[144:159]
  ds_read_b128 a[96:99], v5 offset:3072
  v_exp_f32 v181, v165
  v_cvt_pk_bf16_f32 v198, v188, v189
  v_cvt_pk_bf16_f32 v199, v190, v191
  v_cvt_pk_bf16_f32 v201, v178, v179
  v_mfma_f32_32x32x16_bf16 v[64:79], a[72:75], v[192:195], v[64:79]
  v_and_b32 v9, 15, v11
  v_exp_f32 v182, v166
  v_exp_f32 v183, v167
  v_cvt_pk_bf16_f32 v202, v180, v181
  v_mfma_f32_32x32x16_bf16 v[144:159], a[20:23], v[252:255], v[144:159]
  v_lshrrev_b32 v9, 2, v9
  v_exp_f32 v184, v168
  v_exp_f32 v185, v169
  v_cvt_pk_bf16_f32 v203, v182, v183
  v_mfma_f32_32x32x16_bf16 v[48:63], a[68:71], v[196:199], v[48:63]
  v_add_u32 v0, v0, v9
  v_exp_f32 v186, v170
  v_exp_f32 v187, v171
  v_cvt_pk_bf16_f32 v204, v184, v185
  v_mfma_f32_32x32x16_bf16 v[64:79], a[76:79], v[196:199], v[64:79]
  s_waitcnt lgkmcnt(8)
  v_exp_f32 v188, v172
  v_exp_f32 v189, v173
  v_exp_f32 v190, v174
  v_exp_f32 v191, v175
  v_cvt_pk_bf16_f32 v205, v186, v187
  v_mfma_f32_32x32x16_bf16 v[160:175], a[24:27], v[208:211], 0
  v_mul_u32_u24 v9, 192, v0
  v_exp_f32 v176, v144
  v_exp_f32 v177, v145
  v_exp_f32 v178, v146
  v_mfma_f32_32x32x16_bf16 v[80:95], a[64:67], v[200:203], v[80:95]
  v_lshrrev_b32 v0, 4, v11
  v_exp_f32 v179, v147
  v_exp_f32 v180, v148
  v_cvt_pk_bf16_f32 v192, v176, v177
  v_mfma_f32_32x32x16_bf16 v[160:175], a[28:31], v[212:215], v[160:175]
  v_and_b32 v0, 1, v0
  v_exp_f32 v181, v149
  v_cvt_pk_bf16_f32 v206, v188, v189
  v_cvt_pk_bf16_f32 v207, v190, v191
  v_cvt_pk_bf16_f32 v193, v178, v179
  v_mfma_f32_32x32x16_bf16 v[96:111], a[72:75], v[200:203], v[96:111]
  v_lshlrev_b32 v0, 5, v0
  v_exp_f32 v182, v150
  v_exp_f32 v183, v151
  v_cvt_pk_bf16_f32 v194, v180, v181
  v_mfma_f32_32x32x16_bf16 v[160:175], a[32:35], v[216:219], v[160:175]
  v_add_u32 v9, v9, v0
  v_exp_f32 v184, v152
  v_exp_f32 v185, v153
  v_cvt_pk_bf16_f32 v195, v182, v183
  v_mfma_f32_32x32x16_bf16 v[80:95], a[68:71], v[204:207], v[80:95]
  v_and_b32 v0, 3, v11
  v_exp_f32 v186, v154
  v_exp_f32 v187, v155
  v_cvt_pk_bf16_f32 v196, v184, v185
  v_mfma_f32_32x32x16_bf16 v[96:111], a[76:79], v[204:207], v[96:111]
  v_lshlrev_b32 v0, 3, v0
  v_exp_f32 v188, v156
  v_exp_f32 v189, v157
  v_exp_f32 v190, v158
  v_exp_f32 v191, v159
  v_cvt_pk_bf16_f32 v197, v186, v187
  v_mfma_f32_32x32x16_bf16 v[144:159], a[24:27], v[220:223], 0
  s_waitcnt vmcnt(0) lgkmcnt(0)
  v_exp_f32 v176, v160
  v_exp_f32 v177, v161
  v_exp_f32 v178, v162
  v_mfma_f32_32x32x16_bf16 v[112:127], a[64:67], v[192:195], 0
  s_barrier
  s_cmp_eq_u32 s30, 0
  s_cbranch_scc0 L_f0_H
  v_readfirstlane_b32 s36, v12
  s_nop 3
  s_bfe_u32 s36, s36, 0x150008
  s_cmp_eq_u32 s36, s95
  s_cbranch_scc1 L_f0w_H
  buffer_wbl2 sc1
  s_waitcnt vmcnt(0)
L_f0w_H:
  v_mov_b32 v10, 1
  s_nop 1
  s_mov_b64 s[92:93], exec
  s_mov_b64 exec, 1
  global_atomic_add v13, v10, s[44:45] sc1
  s_mov_b64 exec, s[92:93]
L_f0_H:
  v_mfma_f32_32x32x16_bf16 v[144:159], a[28:31], v[224:227], v[144:159]
  ds_read_b128 a[60:63], v2 offset:34816
  v_exp_f32 v179, v163
  v_cvt_pk_bf16_f32 v198, v188, v189
  v_cvt_pk_bf16_f32 v199, v190, v191
  v_cvt_pk_bf16_f32 v200, v176, v177
  v_mfma_f32_32x32x16_bf16 v[128:143], a[72:75], v[192:195], 0
  v_add_u32 v9, v9, v0
  v_exp_f32 v180, v164
  v_exp_f32 v181, v165
  v_cvt_pk_bf16_f32 v201, v178, v179
  v_mfma_f32_32x32x16_bf16 v[144:159], a[32:35], v[228:231], v[144:159]
  v_add_u32 v9, 145408, v9
  v_exp_f32 v182, v166
  v_exp_f32 v183, v167
  v_cvt_pk_bf16_f32 v202, v180, v181
  v_mfma_f32_32x32x16_bf16 v[112:127], a[68:71], v[196:199], v[112:127]
  v_exp_f32 v184, v168
  v_exp_f32 v185, v169
  v_exp_f32 v186, v170
  v_exp_f32 v187, v171
  v_mfma_f32_32x32x16_bf16 v[128:143], a[76:79], v[196:199], v[128:143]
  v_exp_f32 v188, v172
  v_exp_f32 v189, v173
  v_exp_f32 v190, v174
  v_exp_f32 v191, v175
  v_cvt_pk_bf16_f32 v203, v182, v183
  v_cvt_pk_bf16_f32 v204, v184, v185
  v_cvt_pk_bf16_f32 v205, v186, v187
  v_mfma_f32_32x32x16_bf16 v[160:175], a[24:27], v[232:235], 0
  s_nop 0
  v_exp_f32 v176, v144
  v_exp_f32 v177, v145
  v_exp_f32 v178, v146
  v_mfma_f32_32x32x16_bf16 v[16:31], a[80:83], v[200:203], v[16:31]
  ds_read_b128 a[56:59], v2 offset:33792
  v_exp_f32 v179, v147
  v_exp_f32 v180, v148
  v_cvt_pk_bf16_f32 v192, v176, v177
  v_mfma_f32_32x32x16_bf16 v[160:175], a[28:31], v[236:239], v[160:175]
  ds_read_b64_tr_b16 a[112:113], v9 offset:0
  v_exp_f32 v181, v149
  v_cvt_pk_bf16_f32 v206, v188, v189
  v_cvt_pk_bf16_f32 v207, v190, v191
  v_cvt_pk_bf16_f32 v193, v178, v179
  v_mfma_f32_32x32x16_bf16 v[32:47], a[88:91], v[200:203], v[32:47]
  ds_read_b64_tr_b16 a[114:115], v9 offset:1536
  v_exp_f32 v182, v150
  v_exp_f32 v183, v151
  v_cvt_pk_bf16_f32 v194, v180, v181
  v_mfma_f32_32x32x16_bf16 v[160:175], a[32:35], v[240:243], v[160:175]
  ds_read_b64_tr_b16 a[116:117], v9 offset:3072
  v_exp_f32 v184, v152
  v_exp_f32 v185, v153
  v_cvt_pk_bf16_f32 v195, v182, v183
  v_mfma_f32_32x32x16_bf16 v[16:31], a[84:87], v[204:207], v[16:31]
  ds_read_b64_tr_b16 a[118:119], v9 offset:4608
  v_exp_f32 v186, v154
  v_exp_f32 v187, v155
  v_cvt_pk_bf16_f32 v196, v184, v185
  v_mfma_f32_32x32x16_bf16 v[32:47], a[92:95], v[204:207], v[32:47]
  s_nop 0
  v_exp_f32 v188, v156
  v_exp_f32 v189, v157
  v_exp_f32 v190, v158
  v_exp_f32 v191, v159
  v_cvt_pk_bf16_f32 v197, v186, v187
  v_mfma_f32_32x32x16_bf16 v[144:159], a[36:39], v[208:211], 0
  ds_read_b128 a[8:11], v2 offset:30720
  v_exp_f32 v176, v160
  v_exp_f32 v177, v161
  v_exp_f32 v178, v162
  v_mfma_f32_32x32x16_bf16 v[48:63], a[80:83], v[192:195], v[48:63]
  ds_read_b64_tr_b16 a[120:121], v9 offset:6144
  v_exp_f32 v179, v163
  v_exp_f32 v180, v164
  v_cvt_pk_bf16_f32 v200, v176, v177
  v_mfma_f32_32x32x16_bf16 v[144:159], a[40:43], v[212:215], v[144:159]
  ds_read_b64_tr_b16 a[122:123], v9 offset:7680
  v_exp_f32 v181, v165
  v_cvt_pk_bf16_f32 v198, v188, v189
  v_cvt_pk_bf16_f32 v199, v190, v191
  v_cvt_pk_bf16_f32 v201, v178, v179
  v_mfma_f32_32x32x16_bf16 v[64:79], a[88:91], v[192:195], v[64:79]
  ds_read_b64_tr_b16 a[124:125], v9 offset:9216
  v_exp_f32 v182, v166
  v_exp_f32 v183, v167
  v_cvt_pk_bf16_f32 v202, v180, v181
  v_mfma_f32_32x32x16_bf16 v[144:159], a[44:47], v[216:219], v[144:159]
  ds_read_b64_tr_b16 a[126:127], v9 offset:10752
  v_exp_f32 v184, v168
  v_exp_f32 v185, v169
  v_cvt_pk_bf16_f32 v203, v182, v183
  v_mfma_f32_32x32x16_bf16 v[48:63], a[84:87], v[196:199], v[48:63]
  ds_read_b64_tr_b16 a[128:129], v9 offset:12288
  v_exp_f32 v186, v170
  v_exp_f32 v187, v171
  v_cvt_pk_bf16_f32 v204, v184, v185
  v_mfma_f32_32x32x16_bf16 v[64:79], a[92:95], v[196:199], v[64:79]
  ds_read_b64_tr_b16 a[130:131], v9 offset:13824
  v_exp_f32 v188, v172
  v_exp_f32 v189, v173
  v_exp_f32 v190, v174
  v_exp_f32 v191, v175
  v_cvt_pk_bf16_f32 v205, v186, v187
  v_mfma_f32_32x32x16_bf16 v[160:175], a[36:39], v[220:223], 0
  ds_read_b128 a[4:7], v2 offset:29696
  v_exp_f32 v176, v144
  v_exp_f32 v177, v145
  v_exp_f32 v178, v146
  v_mfma_f32_32x32x16_bf16 v[80:95], a[80:83], v[200:203], v[80:95]
  ds_read_b64_tr_b16 a[132:133], v9 offset:15360
  v_exp_f32 v179, v147
  v_exp_f32 v180, v148
  v_cvt_pk_bf16_f32 v192, v176, v177
  v_mfma_f32_32x32x16_bf16 v[160:175], a[40:43], v[224:227], v[160:175]
  ds_read_b64_tr_b16 a[134:135], v9 offset:16896
  v_exp_f32 v181, v149
  v_cvt_pk_bf16_f32 v206, v188, v189
  v_cvt_pk_bf16_f32 v207, v190, v191
  v_cvt_pk_bf16_f32 v193, v178, v179
  v_mfma_f32_32x32x16_bf16 v[96:111], a[88:91], v[200:203], v[96:111]
  ds_read_b64_tr_b16 a[136:137], v9 offset:64
  v_exp_f32 v182, v150
  v_exp_f32 v183, v151
  v_cvt_pk_bf16_f32 v194, v180, v181
  v_mfma_f32_32x32x16_bf16 v[160:175], a[44:47], v[228:231], v[160:175]
  ds_read_b64_tr_b16 a[138:139], v9 offset:1600
  v_exp_f32 v184, v152
  v_exp_f32 v185, v153
  v_cvt_pk_bf16_f32 v195, v182, v183
  v_mfma_f32_32x32x16_bf16 v[80:95], a[84:87], v[204:207], v[80:95]
  ds_read_b64_tr_b16 a[140:141], v9 offset:3136
  v_exp_f32 v186, v154
  v_exp_f32 v187, v155
  v_cvt_pk_bf16_f32 v196, v184, v185
  v_mfma_f32_32x32x16_bf16 v[96:111], a[92:95], v[204:207], v[96:111]
  ds_read_b64_tr_b16 a[142:143], v9 offset:4672
  v_exp_f32 v188, v156
  v_exp_f32 v189, v157
  v_exp_f32 v190, v158
  v_exp_f32 v191, v159
  v_cvt_pk_bf16_f32 v197, v186, v187
  v_mfma_f32_32x32x16_bf16 v[144:159], a[36:39], v[232:235], 0
  s_nop 0
  v_exp_f32 v176, v160
  v_exp_f32 v177, v161
  v_exp_f32 v178, v162
  v_mfma_f32_32x32x16_bf16 v[16:31], a[96:99], v[192:195], v[16:31]
  ds_read_b128 a[0:3], v2 offset:28672
  v_exp_f32 v179, v163
  v_exp_f32 v180, v164
  v_cvt_pk_bf16_f32 v200, v176, v177
  v_mfma_f32_32x32x16_bf16 v[144:159], a[40:43], v[236:239], v[144:159]
  ds_read_b128 a[32:35], v4 offset:30720
  v_exp_f32 v181, v165
  v_cvt_pk_bf16_f32 v198, v188, v189
  v_cvt_pk_bf16_f32 v199, v190, v191
  v_cvt_pk_bf16_f32 v201, v178, v179
  v_mfma_f32_32x32x16_bf16 v[32:47], a[104:107], v[192:195], v[32:47]
  ds_read_b64_tr_b16 a[144:145], v9 offset:6208
  v_exp_f32 v182, v166
  v_exp_f32 v183, v167
  v_cvt_pk_bf16_f32 v202, v180, v181
  v_mfma_f32_32x32x16_bf16 v[144:159], a[44:47], v[240:243], v[144:159]
  ds_read_b64_tr_b16 a[146:147], v9 offset:7744
  v_exp_f32 v184, v168
  v_exp_f32 v185, v169
  v_cvt_pk_bf16_f32 v203, v182, v183
  v_mfma_f32_32x32x16_bf16 v[16:31], a[100:103], v[196:199], v[16:31]
  ds_read_b64_tr_b16 a[148:149], v9 offset:9280
  v_exp_f32 v186, v170
  v_exp_f32 v187, v171
  v_cvt_pk_bf16_f32 v204, v184, v185
  v_mfma_f32_32x32x16_bf16 v[32:47], a[108:111], v[196:199], v[32:47]
  ds_read_b64_tr_b16 a[150:151], v9 offset:10816
  v_exp_f32 v188, v172
  v_exp_f32 v189, v173
  v_exp_f32 v190, v174
  v_exp_f32 v191, v175
  v_cvt_pk_bf16_f32 v205, v186, v187
  v_mfma_f32_32x32x16_bf16 v[160:175], a[36:39], v[244:247], 0
  ds_read_b128 a[52:55], v2 offset:32768
  v_exp_f32 v176, v144
  v_exp_f32 v177, v145
  v_exp_f32 v178, v146
  v_mfma_f32_32x32x16_bf16 v[48:63], a[96:99], v[200:203], v[48:63]
  ds_read_b128 a[28:31], v4 offset:29696
  v_exp_f32 v179, v147
  v_exp_f32 v180, v148
  v_cvt_pk_bf16_f32 v192, v176, v177
  v_mfma_f32_32x32x16_bf16 v[160:175], a[40:43], v[248:251], v[160:175]
  ds_read_b64_tr_b16 a[152:153], v9 offset:12352
  v_exp_f32 v181, v149
  v_cvt_pk_bf16_f32 v206, v188, v189
  v_cvt_pk_bf16_f32 v207, v190, v191
  v_cvt_pk_bf16_f32 v193, v178, v179
  v_mfma_f32_32x32x16_bf16 v[64:79], a[104:107], v[200:203], v[64:79]
  ds_read_b64_tr_b16 a[154:155], v9 offset:13888
  v_exp_f32 v182, v150
  v_exp_f32 v183, v151
  v_cvt_pk_bf16_f32 v194, v180, v181
  v_mfma_f32_32x32x16_bf16 v[160:175], a[44:47], v[252:255], v[160:175]
  ds_read_b64_tr_b16 a[156:157], v9 offset:15424
  v_exp_f32 v184, v152
  v_exp_f32 v185, v153
  v_cvt_pk_bf16_f32 v195, v182, v183
  v_mfma_f32_32x32x16_bf16 v[48:63], a[100:103], v[204:207], v[48:63]
  ds_read_b64_tr_b16 a[158:159], v9 offset:16960
  v_exp_f32 v186, v154
  v_exp_f32 v187, v155
  v_cvt_pk_bf16_f32 v196, v184, v185
  v_mfma_f32_32x32x16_bf16 v[64:79], a[108:111], v[204:207], v[64:79]
  s_waitcnt lgkmcnt(11)
  v_exp_f32 v188, v156
  v_exp_f32 v189, v157
  v_exp_f32 v190, v158
  v_exp_f32 v191, v159
  v_cvt_pk_bf16_f32 v197, v186, v187
  v_mfma_f32_32x32x16_bf16 v[144:159], a[0:3], v[208:211], 0
  ds_read_b128 a[48:51], v2 offset:31744
  v_exp_f32 v176, v160
  v_exp_f32 v177, v161
  v_exp_f32 v178, v162
  v_mfma_f32_32x32x16_bf16 v[80:95], a[96:99], v[192:195], v[80:95]
  ds_read_b128 a[20:23], v3 offset:30720
  v_exp_f32 v179, v163
  v_exp_f32 v180, v164
  v_cvt_pk_bf16_f32 v200, v176, v177
  v_mfma_f32_32x32x16_bf16 v[144:159], a[4:7], v[212:215], v[144:159]
  ds_read_b64_tr_b16 a[160:161], v9 offset:128
  v_exp_f32 v181, v165
  v_cvt_pk_bf16_f32 v198, v188, v189
  v_cvt_pk_bf16_f32 v199, v190, v191
  v_cvt_pk_bf16_f32 v201, v178, v179
  v_mfma_f32_32x32x16_bf16 v[96:111], a[104:107], v[192:195], v[96:111]
  ds_read_b64_tr_b16 a[162:163], v9 offset:1664
  v_exp_f32 v182, v166
  v_exp_f32 v183, v167
  v_cvt_pk_bf16_f32 v202, v180, v181
  v_mfma_f32_32x32x16_bf16 v[144:159], a[8:11], v[216:219], v[144:159]
  ds_read_b64_tr_b16 a[164:165], v9 offset:3200
  v_exp_f32 v184, v168
  v_exp_f32 v185, v169
  v_cvt_pk_bf16_f32 v203, v182, v183
  v_mfma_f32_32x32x16_bf16 v[80:95], a[100:103], v[196:199], v[80:95]
  ds_read_b64_tr_b16 a[166:167], v9 offset:4736
  v_exp_f32 v186, v170
  v_exp_f32 v187, v171
  v_cvt_pk_bf16_f32 v204, v184, v185
  v_mfma_f32_32x32x16_bf16 v[96:111], a[108:111], v[196:199], v[96:111]
  ds_read_b64_tr_b16 a[168:169], v9 offset:6272
  v_exp_f32 v188, v172
  v_exp_f32 v189, v173
  v_exp_f32 v190, v174
  v_exp_f32 v191, v175
  v_cvt_pk_bf16_f32 v205, v186, v187
  v_mfma_f32_32x32x16_bf16 v[160:175], a[0:3], v[220:223], 0
  ds_read_b128 a[12:15], v3 offset:28672
  v_exp_f32 v176, v144
  v_exp_f32 v177, v145
  v_exp_f32 v178, v146
  v_mfma_f32_32x32x16_bf16 v[112:127], a[96:99], v[200:203], v[112:127]
  ds_read_b128 a[16:19], v3 offset:29696
  v_exp_f32 v179, v147
  v_exp_f32 v180, v148
  v_cvt_pk_bf16_f32 v192, v176, v177
  v_mfma_f32_32x32x16_bf16 v[160:175], a[4:7], v[224:227], v[160:175]
  ds_read_b128 a[40:43], v5 offset:29696
  v_exp_f32 v181, v149
  v_cvt_pk_bf16_f32 v206, v188, v189
  v_cvt_pk_bf16_f32 v207, v190, v191
  v_cvt_pk_bf16_f32 v193, v178, v179
  v_mfma_f32_32x32x16_bf16 v[128:143], a[104:107], v[200:203], v[128:143]
  ds_read_b64_tr_b16 a[170:171], v9 offset:7808
  v_exp_f32 v182, v150
  v_exp_f32 v183, v151
  v_cvt_pk_bf16_f32 v194, v180, v181
  v_mfma_f32_32x32x16_bf16 v[160:175], a[8:11], v[228:231], v[160:175]
  ds_read_b64_tr_b16 a[172:173], v9 offset:9344
  v_exp_f32 v184, v152
  v_exp_f32 v185, v153
  v_cvt_pk_bf16_f32 v195, v182, v183
  v_mfma_f32_32x32x16_bf16 v[112:127], a[100:103], v[204:207], v[112:127]
  ds_read_b64_tr_b16 a[174:175], v9 offset:10880
  v_exp_f32 v186, v154
  v_exp_f32 v187, v155
  v_cvt_pk_bf16_f32 v196, v184, v185
  v_mfma_f32_32x32x16_bf16 v[128:143], a[108:111], v[204:207], v[128:143]
  ds_read_b64_tr_b16 a[176:177], v9 offset:12416
  v_exp_f32 v188, v156
  v_exp_f32 v189, v157
  v_exp_f32 v190, v158
  v_exp_f32 v191, v159
  v_cvt_pk_bf16_f32 v197, v186, v187
  v_mfma_f32_32x32x16_bf16 v[144:159], a[0:3], v[232:235], 0
  s_waitcnt lgkmcnt(13)
  v_exp_f32 v176, v160
  v_exp_f32 v177, v161
  v_exp_f32 v178, v162
  v_mfma_f32_32x32x16_bf16 v[16:31], a[48:51], v[192:195], v[16:31]
  ds_read_b128 a[68:71], v3 offset:32768
  v_exp_f32 v179, v163
  v_exp_f32 v180, v164
  v_cvt_pk_bf16_f32 v200, v176, v177
  v_mfma_f32_32x32x16_bf16 v[144:159], a[4:7], v[236:239], v[144:159]
  ds_read_b128 a[76:79], v3 offset:34816
  v_exp_f32 v181, v165
  v_cvt_pk_bf16_f32 v198, v188, v189
  v_cvt_pk_bf16_f32 v199, v190, v191
  v_cvt_pk_bf16_f32 v201, v178, v179
  v_mfma_f32_32x32x16_bf16 v[32:47], a[56:59], v[192:195], v[32:47]
  ds_read_b128 a[36:39], v5 offset:28672
  v_exp_f32 v182, v166
  v_exp_f32 v183, v167
  v_cvt_pk_bf16_f32 v202, v180, v181
  v_mfma_f32_32x32x16_bf16 v[144:159], a[8:11], v[240:243], v[144:159]
  ds_read_b64_tr_b16 a[178:179], v9 offset:13952
  v_exp_f32 v184, v168
  v_exp_f32 v185, v169
  v_cvt_pk_bf16_f32 v203, v182, v183
  v_mfma_f32_32x32x16_bf16 v[16:31], a[52:55], v[196:199], v[16:31]
  ds_read_b64_tr_b16 a[180:181], v9 offset:15488
  v_exp_f32 v186, v170
  v_exp_f32 v187, v171
  v_cvt_pk_bf16_f32 v204, v184, v185
  v_mfma_f32_32x32x16_bf16 v[32:47], a[60:63], v[196:199], v[32:47]
  s_waitcnt lgkmcnt(10)
  v_exp_f32 v188, v172
  v_exp_f32 v189, v173
  v_exp_f32 v190, v174
  v_exp_f32 v191, v175
  v_cvt_pk_bf16_f32 v205, v186, v187
  v_mfma_f32_32x32x16_bf16 v[160:175], a[12:15], v[208:211], 0
  ds_read_b128 a[64:67], v3 offset:31744
  v_exp_f32 v176, v144
  v_exp_f32 v177, v145
  v_exp_f32 v178, v146
  v_mfma_f32_32x32x16_bf16 v[48:63], a[48:51], v[200:203], v[48:63]
  ds_read_b128 a[72:75], v3 offset:33792
  v_exp_f32 v179, v147
  v_exp_f32 v180, v148
  v_cvt_pk_bf16_f32 v192, v176, v177
  v_mfma_f32_32x32x16_bf16 v[160:175], a[16:19], v[212:215], v[160:175]
  ds_read_b128 a[108:111], v5 offset:34816
  v_exp_f32 v181, v149
  v_cvt_pk_bf16_f32 v206, v188, v189
  v_cvt_pk_bf16_f32 v207, v190, v191
  v_cvt_pk_bf16_f32 v193, v178, v179
  v_mfma_f32_32x32x16_bf16 v[64:79], a[56:59], v[200:203], v[64:79]
  ds_read_b64_tr_b16 a[182:183], v9 offset:17024
  v_exp_f32 v182, v150
  v_exp_f32 v183, v151
  v_cvt_pk_bf16_f32 v194, v180, v181
  v_mfma_f32_32x32x16_bf16 v[160:175], a[20:23], v[216:219], v[160:175]
  v_exp_f32 v184, v152
  v_exp_f32 v185, v153
  v_exp_f32 v186, v154
  v_mfma_f32_32x32x16_bf16 v[48:63], a[52:55], v[204:207], v[48:63]
  v_exp_f32 v187, v155
  v_exp_f32 v188, v156
  v_cvt_pk_bf16_f32 v195, v182, v183
  v_cvt_pk_bf16_f32 v196, v184, v185
  v_mfma_f32_32x32x16_bf16 v[64:79], a[60:63], v[204:207], v[64:79]
  v_exp_f32 v189, v157
  v_exp_f32 v190, v158
  v_exp_f32 v191, v159
  v_cvt_pk_bf16_f32 v197, v186, v187
  v_mfma_f32_32x32x16_bf16 v[144:159], a[12:15], v[220:223], 0
  ds_read_b128 a[24:27], v4 offset:28672
  v_exp_f32 v176, v160
  v_exp_f32 v177, v161
  v_exp_f32 v178, v162
  v_mfma_f32_32x32x16_bf16 v[80:95], a[48:51], v[192:195], v[80:95]
  ds_read_b128 a[84:87], v4 offset:32768
  v_exp_f32 v179, v163
  v_exp_f32 v180, v164
  v_cvt_pk_bf16_f32 v200, v176, v177
  v_mfma_f32_32x32x16_bf16 v[144:159], a[16:19], v[224:227], v[144:159]
  ds_read_b128 a[104:107], v5 offset:33792
  v_exp_f32 v181, v165
  v_cvt_pk_bf16_f32 v198, v188, v189
  v_cvt_pk_bf16_f32 v199, v190, v191
  v_cvt_pk_bf16_f32 v201, v178, v179
  v_mfma_f32_32x32x16_bf16 v[96:111], a[56:59], v[192:195], v[96:111]
  v_exp_f32 v182, v166
  v_exp_f32 v183, v167
  v_exp_f32 v184, v168
  v_mfma_f32_32x32x16_bf16 v[144:159], a[20:23], v[228:231], v[144:159]
  v_exp_f32 v185, v169
  v_exp_f32 v186, v170
  v_cvt_pk_bf16_f32 v202, v180, v181
  v_cvt_pk_bf16_f32 v203, v182, v183
  v_mfma_f32_32x32x16_bf16 v[80:95], a[52:55], v[196:199], v[80:95]
  v_exp_f32 v187, v171
  v_exp_f32 v188, v172
  v_exp_f32 v189, v173
  v_mfma_f32_32x32x16_bf16 v[96:111], a[60:63], v[196:199], v[96:111]
  v_exp_f32 v190, v174
  v_exp_f32 v191, v175
  v_cvt_pk_bf16_f32 v204, v184, v185
  v_cvt_pk_bf16_f32 v205, v186, v187
  v_mfma_f32_32x32x16_bf16 v[160:175], a[12:15], v[232:235], 0
  s_waitcnt lgkmcnt(5)
  v_exp_f32 v176, v144
  v_exp_f32 v177, v145
  v_exp_f32 v178, v146
  v_mfma_f32_32x32x16_bf16 v[16:31], a[64:67], v[200:203], v[16:31]
  ds_read_b128 a[80:83], v4 offset:31744
  v_exp_f32 v179, v147
  v_exp_f32 v180, v148
  v_cvt_pk_bf16_f32 v192, v176, v177
  v_mfma_f32_32x32x16_bf16 v[160:175], a[16:19], v[236:239], v[160:175]
  ds_read_b128 a[92:95], v4 offset:34816
  v_exp_f32 v181, v149
  v_cvt_pk_bf16_f32 v206, v188, v189
  v_cvt_pk_bf16_f32 v207, v190, v191
  v_cvt_pk_bf16_f32 v193, v178, v179
  v_mfma_f32_32x32x16_bf16 v[32:47], a[72:75], v[200:203], v[32:47]
  global_load_dword v12, v13, s[44:45] sc1
  v_exp_f32 v182, v150
  v_exp_f32 v183, v151
  v_mfma_f32_32x32x16_bf16 v[160:175], a[20:23], v[240:243], v[160:175]
  ds_read_b128 a[100:103], v5 offset:32768
  v_exp_f32 v184, v152
  v_exp_f32 v185, v153
  v_cvt_pk_bf16_f32 v194, v180, v181
  v_mfma_f32_32x32x16_bf16 v[16:31], a[68:71], v[204:207], v[16:31]
  s_add_u32 s20, s20, 28672
  v_exp_f32 v186, v154
  v_exp_f32 v187, v155
  v_cvt_pk_bf16_f32 v195, v182, v183
  v_cvt_pk_bf16_f32 v196, v184, v185
  v_mfma_f32_32x32x16_bf16 v[32:47], a[76:79], v[204:207], v[32:47]
  s_cmp_ge_u32 s20, s21
  s_cselect_b32 s25, 401408, 0
  v_exp_f32 v188, v156
  v_exp_f32 v189, v157
  v_exp_f32 v190, v158
  v_exp_f32 v191, v159
  v_cvt_pk_bf16_f32 v197, v186, v187
  v_mfma_f32_32x32x16_bf16 v[144:159], a[12:15], v[244:247], 0
  ds_read_b128 a[88:91], v4 offset:33792
  v_exp_f32 v176, v160
  v_exp_f32 v177, v161
  v_exp_f32 v178, v162
  v_mfma_f32_32x32x16_bf16 v[48:63], a[64:67], v[192:195], v[48:63]
  ds_read_b128 a[44:47], v5 offset:30720
  v_exp_f32 v179, v163
  v_exp_f32 v180, v164
  v_cvt_pk_bf16_f32 v200, v176, v177
  v_mfma_f32_32x32x16_bf16 v[144:159], a[16:19], v[248:251], v[144:159]
  ds_read_b128 a[96:99], v5 offset:31744
  v_exp_f32 v181, v165
  v_cvt_pk_bf16_f32 v198, v188, v189
  v_cvt_pk_bf16_f32 v199, v190, v191
  v_cvt_pk_bf16_f32 v201, v178, v179
  v_mfma_f32_32x32x16_bf16 v[64:79], a[72:75], v[192:195], v[64:79]
  s_sub_u32 s20, s20, s25
  v_exp_f32 v182, v166
  v_exp_f32 v183, v167
  v_exp_f32 v184, v168
  v_mfma_f32_32x32x16_bf16 v[144:159], a[20:23], v[252:255], v[144:159]
  s_add_u32 s28, s20, 4096
  v_exp_f32 v185, v169
  v_exp_f32 v186, v170
  v_cvt_pk_bf16_f32 v202, v180, v181
  v_cvt_pk_bf16_f32 v203, v182, v183
  v_mfma_f32_32x32x16_bf16 v[48:63], a[68:71], v[196:199], v[48:63]
  v_exp_f32 v187, v171
  v_exp_f32 v188, v172
  v_exp_f32 v189, v173
  v_mfma_f32_32x32x16_bf16 v[64:79], a[76:79], v[196:199], v[64:79]
  s_waitcnt lgkmcnt(8)
  v_exp_f32 v190, v174
  v_exp_f32 v191, v175
  v_cvt_pk_bf16_f32 v204, v184, v185
  v_cvt_pk_bf16_f32 v205, v186, v187
  v_mfma_f32_32x32x16_bf16 v[160:175], a[24:27], v[208:211], 0
  v_exp_f32 v176, v144
  v_exp_f32 v177, v145
  v_exp_f32 v178, v146
  v_mfma_f32_32x32x16_bf16 v[80:95], a[64:67], v[200:203], v[80:95]
  v_exp_f32 v179, v147
  v_exp_f32 v180, v148
  v_cvt_pk_bf16_f32 v192, v176, v177
  v_mfma_f32_32x32x16_bf16 v[160:175], a[28:31], v[212:215], v[160:175]
  v_exp_f32 v181, v149
  v_exp_f32 v182, v150
  v_cvt_pk_bf16_f32 v206, v188, v189
  v_cvt_pk_bf16_f32 v207, v190, v191
  v_mfma_f32_32x32x16_bf16 v[96:111], a[72:75], v[200:203], v[96:111]
  v_exp_f32 v183, v151
  v_exp_f32 v184, v152
  v_cvt_pk_bf16_f32 v193, v178, v179
  v_cvt_pk_bf16_f32 v194, v180, v181
  v_mfma_f32_32x32x16_bf16 v[160:175], a[32:35], v[216:219], v[160:175]
  v_exp_f32 v185, v153
  v_exp_f32 v186, v154
  v_exp_f32 v187, v155
  v_mfma_f32_32x32x16_bf16 v[80:95], a[68:71], v[204:207], v[80:95]
  v_exp_f32 v188, v156
  v_exp_f32 v189, v157
  v_cvt_pk_bf16_f32 v195, v182, v183
  v_cvt_pk_bf16_f32 v196, v184, v185
  v_mfma_f32_32x32x16_bf16 v[96:111], a[76:79], v[204:207], v[96:111]
  v_exp_f32 v190, v158
  v_exp_f32 v191, v159
  v_cvt_pk_bf16_f32 v197, v186, v187
  v_add_u32 v2, s23, v2
  v_mfma_f32_32x32x16_bf16 v[144:159], a[24:27], v[220:223], 0
  s_waitcnt vmcnt(0) lgkmcnt(0)
  v_exp_f32 v176, v160
  v_exp_f32 v177, v161
  v_exp_f32 v178, v162
  v_mfma_f32_32x32x16_bf16 v[112:127], a[64:67], v[192:195], v[112:127]
  s_barrier
  s_mov_b32 s94, 0x40000
L_f1_H:
  v_readfirstlane_b32 s36, v12
  s_nop 3
  s_and_b32 s36, s36, 7
  s_cmp_ge_u32 s36, s29
  s_cbranch_scc1 L_f1ok_H
  global_load_dword v12, v13, s[44:45] sc1
  s_waitcnt vmcnt(0)
  s_sub_u32 s94, s94, 1
  s_cmp_lg_u32 s94, 0
  s_cbranch_scc1 L_f1_H
L_f1ok_H:
  v_readfirstlane_b32 s36, v12
  s_nop 3
  s_bfe_u32 s36, s36, 0x150008
  s_cmp_eq_u32 s36, s95
  s_cbranch_scc1 L_f1s_H
  buffer_inv sc1
  s_waitcnt vmcnt(0)
L_f1s_H:
  v_mfma_f32_32x32x16_bf16 v[144:159], a[28:31], v[224:227], v[144:159]
  ds_read_b128 a[60:63], v2 offset:6144
  v_exp_f32 v179, v163
  v_cvt_pk_bf16_f32 v198, v188, v189
  v_cvt_pk_bf16_f32 v199, v190, v191
  v_cvt_pk_bf16_f32 v200, v176, v177
  v_mfma_f32_32x32x16_bf16 v[128:143], a[72:75], v[192:195], v[128:143]
  s_add_u32 m0, s22, 28672
  v_exp_f32 v180, v164
  v_exp_f32 v181, v165
  v_exp_f32 v182, v166
  v_mfma_f32_32x32x16_bf16 v[144:159], a[32:35], v[228:231], v[144:159]
  buffer_load_dwordx4 v1, s[12:15], s20 offen offset:0 lds
  v_exp_f32 v183, v167
  v_cvt_pk_bf16_f32 v201, v178, v179
  v_cvt_pk_bf16_f32 v202, v180, v181
  v_mfma_f32_32x32x16_bf16 v[112:127], a[68:71], v[196:199], v[112:127]
  buffer_load_dwordx4 v1, s[12:15], s20 offen offset:1024 lds
  v_exp_f32 v184, v168
  v_exp_f32 v185, v169
  v_exp_f32 v186, v170
  v_exp_f32 v187, v171
  v_mfma_f32_32x32x16_bf16 v[128:143], a[76:79], v[196:199], v[128:143]
  buffer_load_dwordx4 v1, s[12:15], s20 offen offset:2048 lds
  v_exp_f32 v188, v172
  v_exp_f32 v189, v173
  v_exp_f32 v190, v174
  v_exp_f32 v191, v175
  v_cvt_pk_bf16_f32 v203, v182, v183
  v_cvt_pk_bf16_f32 v204, v184, v185
  v_cvt_pk_bf16_f32 v205, v186, v187
  v_mfma_f32_32x32x16_bf16 v[160:175], a[24:27], v[232:235], 0
  s_nop 0
  v_exp_f32 v176, v144
  v_exp_f32 v177, v145
  v_exp_f32 v178, v146
  v_mfma_f32_32x32x16_bf16 v[16:31], a[80:83], v[200:203], v[16:31]
  ds_read_b128 a[56:59], v2 offset:5120
  v_exp_f32 v179, v147
  v_exp_f32 v180, v148
  v_cvt_pk_bf16_f32 v192, v176, v177
  v_mfma_f32_32x32x16_bf16 v[160:175], a[28:31], v[236:239], v[160:175]
  buffer_load_dwordx4 v1, s[12:15], s20 offen offset:3072 lds
  v_exp_f32 v181, v149
  v_cvt_pk_bf16_f32 v206, v188, v189
  v_cvt_pk_bf16_f32 v207, v190, v191
  v_mfma_f32_32x32x16_bf16 v[32:47], a[88:91], v[200:203], v[32:47]
  s_add_u32 m0, s22, 32768
  v_exp_f32 v182, v150
  v_exp_f32 v183, v151
  v_cvt_pk_bf16_f32 v193, v178, v179
  v_cvt_pk_bf16_f32 v194, v180, v181
  v_mfma_f32_32x32x16_bf16 v[160:175], a[32:35], v[240:243], v[160:175]
  buffer_load_dwordx4 v1, s[12:15], s28 offen offset:0 lds
  v_exp_f32 v184, v152
  v_exp_f32 v185, v153
  v_mfma_f32_32x32x16_bf16 v[16:31], a[84:87], v[204:207], v[16:31]
  buffer_load_dwordx4 v1, s[12:15], s28 offen offset:1024 lds
  v_exp_f32 v186, v154
  v_exp_f32 v187, v155
  v_mfma_f32_32x32x16_bf16 v[32:47], a[92:95], v[204:207], v[32:47]
  s_nop 0
  v_exp_f32 v188, v156
  v_exp_f32 v189, v157
  v_exp_f32 v190, v158
  v_exp_f32 v191, v159
  v_cvt_pk_bf16_f32 v195, v182, v183
  v_cvt_pk_bf16_f32 v196, v184, v185
  v_cvt_pk_bf16_f32 v197, v186, v187
  v_add_u32 v4, s23, v4
  v_mfma_f32_32x32x16_bf16 v[144:159], a[36:39], v[208:211], 0
  ds_read_b128 a[8:11], v2 offset:2048
  v_exp_f32 v176, v160
  v_exp_f32 v177, v161
  v_exp_f32 v178, v162
  v_mfma_f32_32x32x16_bf16 v[48:63], a[80:83], v[192:195], v[48:63]
  buffer_load_dwordx4 v1, s[12:15], s28 offen offset:2048 lds
  v_exp_f32 v179, v163
  v_exp_f32 v180, v164
  v_mfma_f32_32x32x16_bf16 v[144:159], a[40:43], v[212:215], v[144:159]
  v_exp_f32 v181, v165
  v_cvt_pk_bf16_f32 v198, v188, v189
  v_cvt_pk_bf16_f32 v199, v190, v191
  v_cvt_pk_bf16_f32 v200, v176, v177
  v_cvt_pk_bf16_f32 v201, v178, v179
  v_mfma_f32_32x32x16_bf16 v[64:79], a[88:91], v[192:195], v[64:79]
  v_exp_f32 v182, v166
  v_exp_f32 v183, v167
  v_exp_f32 v184, v168
  v_mfma_f32_32x32x16_bf16 v[144:159], a[44:47], v[216:219], v[144:159]
  v_exp_f32 v185, v169
  v_exp_f32 v186, v170
  v_cvt_pk_bf16_f32 v202, v180, v181
  v_cvt_pk_bf16_f32 v203, v182, v183
  v_mfma_f32_32x32x16_bf16 v[48:63], a[84:87], v[196:199], v[48:63]
  v_exp_f32 v187, v171
  v_exp_f32 v188, v172
  v_exp_f32 v189, v173
  v_mfma_f32_32x32x16_bf16 v[64:79], a[92:95], v[196:199], v[64:79]
  v_exp_f32 v190, v174
  v_exp_f32 v191, v175
  v_cvt_pk_bf16_f32 v204, v184, v185
  v_cvt_pk_bf16_f32 v205, v186, v187
  v_mfma_f32_32x32x16_bf16 v[160:175], a[36:39], v[220:223], 0
  ds_read_b128 a[4:7], v2 offset:1024
  v_exp_f32 v176, v144
  v_exp_f32 v177, v145
  v_cvt_pk_bf16_f32 v206, v188, v189
  v_mfma_f32_32x32x16_bf16 v[80:95], a[80:83], v[200:203], v[80:95]
  v_exp_f32 v178, v146
  v_exp_f32 v179, v147
  v_exp_f32 v180, v148
  v_mfma_f32_32x32x16_bf16 v[160:175], a[40:43], v[224:227], v[160:175]
  v_exp_f32 v181, v149
  v_exp_f32 v182, v150
  v_cvt_pk_bf16_f32 v207, v190, v191
  v_cvt_pk_bf16_f32 v192, v176, v177
  v_mfma_f32_32x32x16_bf16 v[96:111], a[88:91], v[200:203], v[96:111]
  v_exp_f32 v183, v151
  v_exp_f32 v184, v152
  v_cvt_pk_bf16_f32 v193, v178, v179
  v_cvt_pk_bf16_f32 v194, v180, v181
  v_mfma_f32_32x32x16_bf16 v[160:175], a[44:47], v[228:231], v[160:175]
  v_exp_f32 v185, v153
  v_exp_f32 v186, v154
  v_exp_f32 v187, v155
  v_mfma_f32_32x32x16_bf16 v[80:95], a[84:87], v[204:207], v[80:95]
  v_exp_f32 v188, v156
  v_exp_f32 v189, v157
  v_cvt_pk_bf16_f32 v195, v182, v183
  v_cvt_pk_bf16_f32 v196, v184, v185
  v_mfma_f32_32x32x16_bf16 v[96:111], a[92:95], v[204:207], v[96:111]
  v_exp_f32 v190, v158
  v_exp_f32 v191, v159
  v_cvt_pk_bf16_f32 v197, v186, v187
  v_add_u32 v5, s23, v5
  v_mfma_f32_32x32x16_bf16 v[144:159], a[36:39], v[232:235], 0
  s_nop 0
  v_exp_f32 v176, v160
  v_exp_f32 v177, v161
  v_exp_f32 v178, v162
  v_mfma_f32_32x32x16_bf16 v[16:31], a[96:99], v[192:195], v[16:31]
  ds_read_b128 a[0:3], v2 offset:0
  v_exp_f32 v179, v163
  v_exp_f32 v180, v164
  v_cvt_pk_bf16_f32 v200, v176, v177
  v_mfma_f32_32x32x16_bf16 v[144:159], a[40:43], v[236:239], v[144:159]
  ds_read_b128 a[32:35], v4 offset:2048
  v_exp_f32 v181, v165
  v_cvt_pk_bf16_f32 v198, v188, v189
  v_cvt_pk_bf16_f32 v199, v190, v191
  v_cvt_pk_bf16_f32 v201, v178, v179
  v_mfma_f32_32x32x16_bf16 v[32:47], a[104:107], v[192:195], v[32:47]
  v_exp_f32 v182, v166
  v_exp_f32 v183, v167
  v_exp_f32 v184, v168
  v_mfma_f32_32x32x16_bf16 v[144:159], a[44:47], v[240:243], v[144:159]
  v_exp_f32 v185, v169
  v_exp_f32 v186, v170
  v_cvt_pk_bf16_f32 v202, v180, v181
  v_cvt_pk_bf16_f32 v203, v182, v183
  v_mfma_f32_32x32x16_bf16 v[16:31], a[100:103], v[196:199], v[16:31]
  v_exp_f32 v187, v171
  v_exp_f32 v188, v172
  v_exp_f32 v189, v173
  v_mfma_f32_32x32x16_bf16 v[32:47], a[108:111], v[196:199], v[32:47]
  v_exp_f32 v190, v174
  v_exp_f32 v191, v175
  v_cvt_pk_bf16_f32 v204, v184, v185
  v_cvt_pk_bf16_f32 v205, v186, v187
  v_add_u32 v3, s23, v3
  v_mfma_f32_32x32x16_bf16 v[160:175], a[36:39], v[244:247], 0
  ds_read_b128 a[52:55], v2 offset:4096
  v_exp_f32 v176, v144
  v_exp_f32 v177, v145
  v_cvt_pk_bf16_f32 v206, v188, v189
  v_mfma_f32_32x32x16_bf16 v[48:63], a[96:99], v[200:203], v[48:63]
  ds_read_b128 a[28:31], v4 offset:1024
  v_exp_f32 v178, v146
  v_exp_f32 v179, v147
  v_cvt_pk_bf16_f32 v192, v176, v177
  v_mfma_f32_32x32x16_bf16 v[160:175], a[40:43], v[248:251], v[160:175]
  v_exp_f32 v180, v148
  v_exp_f32 v181, v149
  v_cvt_pk_bf16_f32 v207, v190, v191
  v_cvt_pk_bf16_f32 v193, v178, v179
  v_mfma_f32_32x32x16_bf16 v[64:79], a[104:107], v[200:203], v[64:79]
  v_exp_f32 v182, v150
  v_exp_f32 v183, v151
  v_exp_f32 v184, v152
  v_mfma_f32_32x32x16_bf16 v[160:175], a[44:47], v[252:255], v[160:175]
  v_exp_f32 v185, v153
  v_exp_f32 v186, v154
  v_cvt_pk_bf16_f32 v194, v180, v181
  v_cvt_pk_bf16_f32 v195, v182, v183
  v_mfma_f32_32x32x16_bf16 v[48:63], a[100:103], v[204:207], v[48:63]
  v_exp_f32 v187, v155
  v_exp_f32 v188, v156
  v_exp_f32 v189, v157
  v_mfma_f32_32x32x16_bf16 v[64:79], a[108:111], v[204:207], v[64:79]
  s_waitcnt lgkmcnt(3)
  v_exp_f32 v190, v158
  v_exp_f32 v191, v159
  v_cvt_pk_bf16_f32 v196, v184, v185
  v_cvt_pk_bf16_f32 v197, v186, v187
  v_mfma_f32_32x32x16_bf16 v[144:159], a[0:3], v[208:211], 0
  ds_read_b128 a[48:51], v2 offset:3072
  v_exp_f32 v176, v160
  v_exp_f32 v177, v161
  v_cvt_pk_bf16_f32 v198, v188, v189
  v_mfma_f32_32x32x16_bf16 v[80:95], a[96:99], v[192:195], v[80:95]
  ds_read_b128 a[20:23], v3 offset:2048
  v_exp_f32 v178, v162
  v_exp_f32 v179, v163
  v_cvt_pk_bf16_f32 v200, v176, v177
  v_mfma_f32_32x32x16_bf16 v[144:159], a[4:7], v[212:215], v[144:159]
  v_exp_f32 v180, v164
  v_exp_f32 v181, v165
  v_cvt_pk_bf16_f32 v199, v190, v191
  v_cvt_pk_bf16_f32 v201, v178, v179
  v_mfma_f32_32x32x16_bf16 v[96:111], a[104:107], v[192:195], v[96:111]
  v_exp_f32 v182, v166
  v_exp_f32 v183, v167
  v_exp_f32 v184, v168
  v_mfma_f32_32x32x16_bf16 v[144:159], a[8:11], v[216:219], v[144:159]
  v_exp_f32 v185, v169
  v_exp_f32 v186, v170
  v_cvt_pk_bf16_f32 v202, v180, v181
  v_cvt_pk_bf16_f32 v203, v182, v183
  v_mfma_f32_32x32x16_bf16 v[80:95], a[100:103], v[196:199], v[80:95]
  v_exp_f32 v187, v171
  v_exp_f32 v188, v172
  v_exp_f32 v189, v173
  v_mfma_f32_32x32x16_bf16 v[96:111], a[108:111], v[196:199], v[96:111]
  v_exp_f32 v190, v174
  v_exp_f32 v191, v175
  v_cvt_pk_bf16_f32 v204, v184, v185
  v_cvt_pk_bf16_f32 v205, v186, v187
  s_sub_u32 s22, s22, s23
  s_sub_u32 s23, 0, s23
  s_add_u32 s24, s24, 2
  s_cmp_lt_u32 s24, 12
.p2align 6
L_loop_H:
  v_mfma_f32_32x32x16_bf16 v[160:175], a[0:3], v[220:223], 0
  ds_read_b128 a[12:15], v3 offset:0
  v_exp_f32 v176, v144
  v_exp_f32 v177, v145
  v_exp_f32 v178, v146
  v_mfma_f32_32x32x16_bf16 v[112:127], a[96:99], v[200:203], v[112:127]
  ds_read_b128 a[16:19], v3 offset:1024
  v_exp_f32 v179, v147
  v_exp_f32 v180, v148
  v_cvt_pk_bf16_f32 v192, v176, v177
  v_mfma_f32_32x32x16_bf16 v[160:175], a[4:7], v[224:227], v[160:175]
  ds_read_b128 a[40:43], v5 offset:1024
  v_exp_f32 v181, v149
  v_cvt_pk_bf16_f32 v206, v188, v189
  v_cvt_pk_bf16_f32 v207, v190, v191
  v_cvt_pk_bf16_f32 v193, v178, v179
  v_mfma_f32_32x32x16_bf16 v[128:143], a[104:107], v[200:203], v[128:143]
  v_exp_f32 v182, v150
  v_exp_f32 v183, v151
  v_exp_f32 v184, v152
  v_mfma_f32_32x32x16_bf16 v[160:175], a[8:11], v[228:231], v[160:175]
  v_exp_f32 v185, v153
  v_exp_f32 v186, v154
  v_cvt_pk_bf16_f32 v194, v180, v181
  v_cvt_pk_bf16_f32 v195, v182, v183
  v_mfma_f32_32x32x16_bf16 v[112:127], a[100:103], v[204:207], v[112:127]
  v_exp_f32 v187, v155
  v_exp_f32 v188, v156
  v_exp_f32 v189, v157
  v_mfma_f32_32x32x16_bf16 v[128:143], a[108:111], v[204:207], v[128:143]
  v_exp_f32 v190, v158
  v_exp_f32 v191, v159
  v_cvt_pk_bf16_f32 v196, v184, v185
  v_cvt_pk_bf16_f32 v197, v186, v187
  v_mfma_f32_32x32x16_bf16 v[144:159], a[0:3], v[232:235], 0
  s_waitcnt lgkmcnt(4)
  v_exp_f32 v176, v160
  v_exp_f32 v177, v161
  v_exp_f32 v178, v162
  v_mfma_f32_32x32x16_bf16 v[16:31], a[48:51], v[192:195], v[16:31]
  ds_read_b128 a[68:71], v3 offset:4096
  v_exp_f32 v179, v163
  v_exp_f32 v180, v164
  v_cvt_pk_bf16_f32 v200, v176, v177
  v_mfma_f32_32x32x16_bf16 v[144:159], a[4:7], v[236:239], v[144:159]
  ds_read_b128 a[76:79], v3 offset:6144
  v_exp_f32 v181, v165
  v_cvt_pk_bf16_f32 v198, v188, v189
  v_cvt_pk_bf16_f32 v199, v190, v191
  v_cvt_pk_bf16_f32 v201, v178, v179
  v_mfma_f32_32x32x16_bf16 v[32:47], a[56:59], v[192:195], v[32:47]
  ds_read_b128 a[36:39], v5 offset:0
  v_exp_f32 v182, v166
  v_exp_f32 v183, v167
  v_cvt_pk_bf16_f32 v202, v180, v181
  v_mfma_f32_32x32x16_bf16 v[144:159], a[8:11], v[240:243], v[144:159]
  v_exp_f32 v184, v168
  v_exp_f32 v185, v169
  v_exp_f32 v186, v170
  v_mfma_f32_32x32x16_bf16 v[16:31], a[52:55], v[196:199], v[16:31]
  v_exp_f32 v187, v171
  v_exp_f32 v188, v172
  v_cvt_pk_bf16_f32 v203, v182, v183
  v_cvt_pk_bf16_f32 v204, v184, v185
  v_mfma_f32_32x32x16_bf16 v[32:47], a[60:63], v[196:199], v[32:47]
  s_waitcnt lgkmcnt(4)
  v_exp_f32 v189, v173
  v_exp_f32 v190, v174
  v_exp_f32 v191, v175
  v_cvt_pk_bf16_f32 v205, v186, v187
  v_mfma_f32_32x32x16_bf16 v[160:175], a[12:15], v[208:211], 0
  ds_read_b128 a[64:67], v3 offset:3072
  v_exp_f32 v176, v144
  v_exp_f32 v177, v145
  v_exp_f32 v178, v146
  v_mfma_f32_32x32x16_bf16 v[48:63], a[48:51], v[200:203], v[48:63]
  ds_read_b128 a[72:75], v3 offset:5120
  v_exp_f32 v179, v147
  v_exp_f32 v180, v148
  v_cvt_pk_bf16_f32 v192, v176, v177
  v_mfma_f32_32x32x16_bf16 v[160:175], a[16:19], v[212:215], v[160:175]
  ds_read_b128 a[108:111], v5 offset:6144
  v_exp_f32 v181, v149
  v_cvt_pk_bf16_f32 v206, v188, v189
  v_cvt_pk_bf16_f32 v207, v190, v191
  v_cvt_pk_bf16_f32 v193, v178, v179
  v_mfma_f32_32x32x16_bf16 v[64:79], a[56:59], v[200:203], v[64:79]
  v_exp_f32 v182, v150
  v_exp_f32 v183, v151
  v_exp_f32 v184, v152
  v_mfma_f32_32x32x16_bf16 v[160:175], a[20:23], v[216:219], v[160:175]
  v_exp_f32 v185, v153
  v_exp_f32 v186, v154
  v_cvt_pk_bf16_f32 v194, v180, v181
  v_cvt_pk_bf16_f32 v195, v182, v183
  v_mfma_f32_32x32x16_bf16 v[48:63], a[52:55], v[204:207], v[48:63]
  v_exp_f32 v187, v155
  v_exp_f32 v188, v156
  v_exp_f32 v189, v157
  v_mfma_f32_32x32x16_bf16 v[64:79], a[60:63], v[204:207], v[64:79]
  v_exp_f32 v190, v158
  v_exp_f32 v191, v159
  v_cvt_pk_bf16_f32 v196, v184, v185
  v_cvt_pk_bf16_f32 v197, v186, v187
  v_mfma_f32_32x32x16_bf16 v[144:159], a[12:15], v[220:223], 0
  ds_read_b128 a[24:27], v4 offset:0
  v_exp_f32 v176, v160
  v_exp_f32 v177, v161
  v_exp_f32 v178, v162
  v_mfma_f32_32x32x16_bf16 v[80:95], a[48:51], v[192:195], v[80:95]
  ds_read_b128 a[84:87], v4 offset:4096
  v_exp_f32 v179, v163
  v_exp_f32 v180, v164
  v_cvt_pk_bf16_f32 v200, v176, v177
  v_mfma_f32_32x32x16_bf16 v[144:159], a[16:19], v[224:227], v[144:159]
  ds_read_b128 a[104:107], v5 offset:5120
  v_exp_f32 v181, v165
  v_cvt_pk_bf16_f32 v198, v188, v189
  v_cvt_pk_bf16_f32 v199, v190, v191
  v_cvt_pk_bf16_f32 v201, v178, v179
  v_mfma_f32_32x32x16_bf16 v[96:111], a[56:59], v[192:195], v[96:111]
  v_exp_f32 v182, v166
  v_exp_f32 v183, v167
  v_exp_f32 v184, v168
  v_mfma_f32_32x32x16_bf16 v[144:159], a[20:23], v[228:231], v[144:159]
  v_exp_f32 v185, v169
  v_exp_f32 v186, v170
  v_cvt_pk_bf16_f32 v202, v180, v181
  v_cvt_pk_bf16_f32 v203, v182, v183
  v_mfma_f32_32x32x16_bf16 v[80:95], a[52:55], v[196:199], v[80:95]
  v_exp_f32 v187, v171
  v_exp_f32 v188, v172
  v_exp_f32 v189, v173
  v_mfma_f32_32x32x16_bf16 v[96:111], a[60:63], v[196:199], v[96:111]
  v_exp_f32 v190, v174
  v_exp_f32 v191, v175
  v_cvt_pk_bf16_f32 v204, v184, v185
  v_cvt_pk_bf16_f32 v205, v186, v187
  v_mfma_f32_32x32x16_bf16 v[160:175], a[12:15], v[232:235], 0
  s_waitcnt lgkmcnt(4)
  v_exp_f32 v176, v144
  v_exp_f32 v177, v145
  v_exp_f32 v178, v146
  v_mfma_f32_32x32x16_bf16 v[16:31], a[64:67], v[200:203], v[16:31]
  ds_read_b128 a[80:83], v4 offset:3072
  v_exp_f32 v179, v147
  v_exp_f32 v180, v148
  v_cvt_pk_bf16_f32 v192, v176, v177
  v_mfma_f32_32x32x16_bf16 v[160:175], a[16:19], v[236:239], v[160:175]
  ds_read_b128 a[92:95], v4 offset:6144
  v_exp_f32 v181, v149
  v_cvt_pk_bf16_f32 v206, v188, v189
  v_cvt_pk_bf16_f32 v207, v190, v191
  v_cvt_pk_bf16_f32 v193, v178, v179
  v_mfma_f32_32x32x16_bf16 v[32:47], a[72:75], v[200:203], v[32:47]
  ds_read_b128 a[100:103], v5 offset:4096
  v_exp_f32 v182, v150
  v_exp_f32 v183, v151
  v_cvt_pk_bf16_f32 v194, v180, v181
  v_mfma_f32_32x32x16_bf16 v[160:175], a[20:23], v[240:243], v[160:175]
  s_add_u32 s20, s20, 28672
  v_exp_f32 v184, v152
  v_exp_f32 v185, v153
  v_exp_f32 v186, v154
  v_mfma_f32_32x32x16_bf16 v[16:31], a[68:71], v[204:207], v[16:31]
  s_cmp_ge_u32 s20, s21
  s_cselect_b32 s25, 401408, 0
  v_exp_f32 v187, v155
  v_exp_f32 v188, v156
  v_cvt_pk_bf16_f32 v195, v182, v183
  v_mfma_f32_32x32x16_bf16 v[32:47], a[76:79], v[204:207], v[32:47]
  s_sub_u32 s20, s20, s25
  v_exp_f32 v189, v157
  v_exp_f32 v190, v158
  v_exp_f32 v191, v159
  v_cvt_pk_bf16_f32 v196, v184, v185
  v_cvt_pk_bf16_f32 v197, v186, v187
  v_mfma_f32_32x32x16_bf16 v[144:159], a[12:15], v[244:247], 0
  ds_read_b128 a[88:91], v4 offset:5120
  v_exp_f32 v176, v160
  v_exp_f32 v177, v161
  v_exp_f32 v178, v162
  v_mfma_f32_32x32x16_bf16 v[48:63], a[64:67], v[192:195], v[48:63]
  ds_read_b128 a[44:47], v5 offset:2048
  v_exp_f32 v179, v163
  v_exp_f32 v180, v164
  v_cvt_pk_bf16_f32 v200, v176, v177
  v_mfma_f32_32x32x16_bf16 v[144:159], a[16:19], v[248:251], v[144:159]
  ds_read_b128 a[96:99], v5 offset:3072
  v_exp_f32 v181, v165
  v_cvt_pk_bf16_f32 v198, v188, v189
  v_cvt_pk_bf16_f32 v199, v190, v191
  v_cvt_pk_bf16_f32 v201, v178, v179
  v_mfma_f32_32x32x16_bf16 v[64:79], a[72:75], v[192:195], v[64:79]
  s_add_u32 s28, s20, 4096
  v_exp_f32 v182, v166
  v_exp_f32 v183, v167
  v_exp_f32 v184, v168
  v_mfma_f32_32x32x16_bf16 v[144:159], a[20:23], v[252:255], v[144:159]
  v_exp_f32 v185, v169
  v_exp_f32 v186, v170
  v_cvt_pk_bf16_f32 v202, v180, v181
  v_cvt_pk_bf16_f32 v203, v182, v183
  v_mfma_f32_32x32x16_bf16 v[48:63], a[68:71], v[196:199], v[48:63]
  v_exp_f32 v187, v171
  v_exp_f32 v188, v172
  v_exp_f32 v189, v173
  v_mfma_f32_32x32x16_bf16 v[64:79], a[76:79], v[196:199], v[64:79]
  s_waitcnt lgkmcnt(8)
  v_exp_f32 v190, v174
  v_exp_f32 v191, v175
  v_cvt_pk_bf16_f32 v204, v184, v185
  v_cvt_pk_bf16_f32 v205, v186, v187
  v_mfma_f32_32x32x16_bf16 v[160:175], a[24:27], v[208:211], 0
  v_exp_f32 v176, v144
  v_exp_f32 v177, v145
  v_mfma_f32_32x32x16_bf16 v[80:95], a[64:67], v[200:203], v[80:95]
  v_exp_f32 v178, v146
  v_exp_f32 v179, v147
  v_exp_f32 v180, v148
  v_mfma_f32_32x32x16_bf16 v[160:175], a[28:31], v[212:215], v[160:175]
  v_exp_f32 v181, v149
  v_cvt_pk_bf16_f32 v206, v188, v189
  v_cvt_pk_bf16_f32 v207, v190, v191
  v_cvt_pk_bf16_f32 v192, v176, v177
  v_cvt_pk_bf16_f32 v193, v178, v179
  v_mfma_f32_32x32x16_bf16 v[96:111], a[72:75], v[200:203], v[96:111]
  v_exp_f32 v182, v150
  v_exp_f32 v183, v151
  v_exp_f32 v184, v152
  v_mfma_f32_32x32x16_bf16 v[160:175], a[32:35], v[216:219], v[160:175]
  v_exp_f32 v185, v153
  v_exp_f32 v186, v154
  v_cvt_pk_bf16_f32 v194, v180, v181
  v_cvt_pk_bf16_f32 v195, v182, v183
  v_mfma_f32_32x32x16_bf16 v[80:95], a[68:71], v[204:207], v[80:95]
  v_exp_f32 v187, v155
  v_exp_f32 v188, v156
  v_exp_f32 v189, v157
  v_mfma_f32_32x32x16_bf16 v[96:111], a[76:79], v[204:207], v[96:111]
  v_exp_f32 v190, v158
  v_exp_f32 v191, v159
  v_cvt_pk_bf16_f32 v196, v184, v185
  v_cvt_pk_bf16_f32 v197, v186, v187
  v_mfma_f32_32x32x16_bf16 v[144:159], a[24:27], v[220:223], 0
  s_waitcnt vmcnt(0) lgkmcnt(0)
  v_exp_f32 v176, v160
  v_exp_f32 v177, v161
  v_exp_f32 v178, v162
  v_mfma_f32_32x32x16_bf16 v[112:127], a[64:67], v[192:195], v[112:127]
  s_barrier
  v_exp_f32 v179, v163
  v_exp_f32 v180, v164
  v_exp_f32 v181, v165
  v_mfma_f32_32x32x16_bf16 v[144:159], a[28:31], v[224:227], v[144:159]
  ds_read_b128 a[60:63], v2 offset:34816
  v_cvt_pk_bf16_f32 v198, v188, v189
  v_cvt_pk_bf16_f32 v199, v190, v191
  v_cvt_pk_bf16_f32 v200, v176, v177
  v_cvt_pk_bf16_f32 v201, v178, v179
  v_cvt_pk_bf16_f32 v202, v180, v181
  v_mfma_f32_32x32x16_bf16 v[128:143], a[72:75], v[192:195], v[128:143]
  s_add_u32 m0, s22, 0
  v_exp_f32 v182, v166
  v_exp_f32 v183, v167
  v_exp_f32 v184, v168
  v_mfma_f32_32x32x16_bf16 v[144:159], a[32:35], v[228:231], v[144:159]
  buffer_load_dwordx4 v1, s[12:15], s20 offen offset:0 lds
  v_exp_f32 v185, v169
  v_exp_f32 v186, v170
  v_mfma_f32_32x32x16_bf16 v[112:127], a[68:71], v[196:199], v[112:127]
  v_exp_f32 v187, v171
  v_exp_f32 v188, v172
  v_cvt_pk_bf16_f32 v203, v182, v183
  v_cvt_pk_bf16_f32 v204, v184, v185
  v_mfma_f32_32x32x16_bf16 v[128:143], a[76:79], v[196:199], v[128:143]
  v_exp_f32 v189, v173
  v_exp_f32 v190, v174
  v_exp_f32 v191, v175
  v_cvt_pk_bf16_f32 v205, v186, v187
  v_mfma_f32_32x32x16_bf16 v[160:175], a[24:27], v[232:235], 0
  s_nop 0
  v_exp_f32 v176, v144
  v_exp_f32 v177, v145
  v_exp_f32 v178, v146
  v_mfma_f32_32x32x16_bf16 v[16:31], a[80:83], v[200:203], v[16:31]
  ds_read_b128 a[56:59], v2 offset:33792
  v_exp_f32 v179, v147
  v_exp_f32 v180, v148
  v_cvt_pk_bf16_f32 v192, v176, v177
  v_mfma_f32_32x32x16_bf16 v[160:175], a[28:31], v[236:239], v[160:175]
  buffer_load_dwordx4 v1, s[12:15], s20 offen offset:1024 lds
  v_exp_f32 v181, v149
  v_cvt_pk_bf16_f32 v206, v188, v189
  v_cvt_pk_bf16_f32 v207, v190, v191
  v_mfma_f32_32x32x16_bf16 v[32:47], a[88:91], v[200:203], v[32:47]
  v_exp_f32 v182, v150
  v_exp_f32 v183, v151
  v_cvt_pk_bf16_f32 v193, v178, v179
  v_cvt_pk_bf16_f32 v194, v180, v181
  v_mfma_f32_32x32x16_bf16 v[160:175], a[32:35], v[240:243], v[160:175]
  v_exp_f32 v184, v152
  v_exp_f32 v185, v153
  v_exp_f32 v186, v154
  v_mfma_f32_32x32x16_bf16 v[16:31], a[84:87], v[204:207], v[16:31]
  v_exp_f32 v187, v155
  v_exp_f32 v188, v156
  v_cvt_pk_bf16_f32 v195, v182, v183
  v_cvt_pk_bf16_f32 v196, v184, v185
  v_mfma_f32_32x32x16_bf16 v[32:47], a[92:95], v[204:207], v[32:47]
  s_nop 0
  v_exp_f32 v189, v157
  v_exp_f32 v190, v158
  v_exp_f32 v191, v159
  v_cvt_pk_bf16_f32 v197, v186, v187
  v_mfma_f32_32x32x16_bf16 v[144:159], a[36:39], v[208:211], 0
  ds_read_b128 a[8:11], v2 offset:30720
  v_exp_f32 v176, v160
  v_exp_f32 v177, v161
  v_exp_f32 v178, v162
  v_mfma_f32_32x32x16_bf16 v[48:63], a[80:83], v[192:195], v[48:63]
  buffer_load_dwordx4 v1, s[12:15], s20 offen offset:2048 lds
  v_exp_f32 v179, v163
  v_exp_f32 v180, v164
  v_mfma_f32_32x32x16_bf16 v[144:159], a[40:43], v[212:215], v[144:159]
  v_exp_f32 v181, v165
  v_cvt_pk_bf16_f32 v198, v188, v189
  v_cvt_pk_bf16_f32 v199, v190, v191
  v_cvt_pk_bf16_f32 v200, v176, v177
  v_cvt_pk_bf16_f32 v201, v178, v179
  v_mfma_f32_32x32x16_bf16 v[64:79], a[88:91], v[192:195], v[64:79]
  v_exp_f32 v182, v166
  v_exp_f32 v183, v167
  v_exp_f32 v184, v168
  v_mfma_f32_32x32x16_bf16 v[144:159], a[44:47], v[216:219], v[144:159]
  v_exp_f32 v185, v169
  v_exp_f32 v186, v170
  v_cvt_pk_bf16_f32 v202, v180, v181
  v_cvt_pk_bf16_f32 v203, v182, v183
  v_mfma_f32_32x32x16_bf16 v[48:63], a[84:87], v[196:199], v[48:63]
  v_exp_f32 v187, v171
  v_exp_f32 v188, v172
  v_exp_f32 v189, v173
  v_mfma_f32_32x32x16_bf16 v[64:79], a[92:95], v[196:199], v[64:79]
  v_exp_f32 v190, v174
  v_exp_f32 v191, v175
  v_cvt_pk_bf16_f32 v204, v184, v185
  v_cvt_pk_bf16_f32 v205, v186, v187
  v_mfma_f32_32x32x16_bf16 v[160:175], a[36:39], v[220:223], 0
  ds_read_b128 a[4:7], v2 offset:29696
  v_exp_f32 v176, v144
  v_exp_f32 v177, v145
  v_exp_f32 v178, v146
  v_mfma_f32_32x32x16_bf16 v[80:95], a[80:83], v[200:203], v[80:95]
  buffer_load_dwordx4 v1, s[12:15], s20 offen offset:3072 lds
  v_exp_f32 v179, v147
  v_exp_f32 v180, v148
  v_mfma_f32_32x32x16_bf16 v[160:175], a[40:43], v[224:227], v[160:175]
  v_exp_f32 v181, v149
  v_cvt_pk_bf16_f32 v206, v188, v189
  v_cvt_pk_bf16_f32 v207, v190, v191
  v_cvt_pk_bf16_f32 v192, v176, v177
  v_cvt_pk_bf16_f32 v193, v178, v179
  v_mfma_f32_32x32x16_bf16 v[96:111], a[88:91], v[200:203], v[96:111]
  v_exp_f32 v182, v150
  v_exp_f32 v183, v151
  v_exp_f32 v184, v152
  v_mfma_f32_32x32x16_bf16 v[160:175], a[44:47], v[228:231], v[160:175]
  v_exp_f32 v185, v153
  v_exp_f32 v186, v154
  v_cvt_pk_bf16_f32 v194, v180, v181
  v_cvt_pk_bf16_f32 v195, v182, v183
  v_mfma_f32_32x32x16_bf16 v[80:95], a[84:87], v[204:207], v[80:95]
  v_exp_f32 v187, v155
  v_exp_f32 v188, v156
  v_exp_f32 v189, v157
  v_mfma_f32_32x32x16_bf16 v[96:111], a[92:95], v[204:207], v[96:111]
  v_exp_f32 v190, v158
  v_exp_f32 v191, v159
  v_cvt_pk_bf16_f32 v196, v184, v185
  v_cvt_pk_bf16_f32 v197, v186, v187
  v_mfma_f32_32x32x16_bf16 v[144:159], a[36:39], v[232:235], 0
  s_nop 0
  v_exp_f32 v176, v160
  v_exp_f32 v177, v161
  v_exp_f32 v178, v162
  v_mfma_f32_32x32x16_bf16 v[16:31], a[96:99], v[192:195], v[16:31]
  ds_read_b128 a[0:3], v2 offset:28672
  v_exp_f32 v179, v163
  v_exp_f32 v180, v164
  v_cvt_pk_bf16_f32 v200, v176, v177
  v_mfma_f32_32x32x16_bf16 v[144:159], a[40:43], v[236:239], v[144:159]
  ds_read_b128 a[32:35], v4 offset:30720
  v_exp_f32 v181, v165
  v_cvt_pk_bf16_f32 v198, v188, v189
  v_cvt_pk_bf16_f32 v199, v190, v191
  v_cvt_pk_bf16_f32 v201, v178, v179
  v_mfma_f32_32x32x16_bf16 v[32:47], a[104:107], v[192:195], v[32:47]
  s_add_u32 m0, s22, 4096
  v_exp_f32 v182, v166
  v_exp_f32 v183, v167
  v_exp_f32 v184, v168
  v_mfma_f32_32x32x16_bf16 v[144:159], a[44:47], v[240:243], v[144:159]
  buffer_load_dwordx4 v1, s[12:15], s28 offen offset:0 lds
  v_exp_f32 v185, v169
  v_cvt_pk_bf16_f32 v202, v180, v181
  v_cvt_pk_bf16_f32 v203, v182, v183
  v_mfma_f32_32x32x16_bf16 v[16:31], a[100:103], v[196:199], v[16:31]
  v_exp_f32 v186, v170
  v_exp_f32 v187, v171
  v_exp_f32 v188, v172
  v_mfma_f32_32x32x16_bf16 v[32:47], a[108:111], v[196:199], v[32:47]
  v_exp_f32 v189, v173
  v_exp_f32 v190, v174
  v_exp_f32 v191, v175
  v_cvt_pk_bf16_f32 v204, v184, v185
  v_cvt_pk_bf16_f32 v205, v186, v187
  v_mfma_f32_32x32x16_bf16 v[160:175], a[36:39], v[244:247], 0
  ds_read_b128 a[52:55], v2 offset:32768
  v_exp_f32 v176, v144
  v_exp_f32 v177, v145
  v_exp_f32 v178, v146
  v_mfma_f32_32x32x16_bf16 v[48:63], a[96:99], v[200:203], v[48:63]
  ds_read_b128 a[28:31], v4 offset:29696
  v_exp_f32 v179, v147
  v_exp_f32 v180, v148
  v_cvt_pk_bf16_f32 v192, v176, v177
  v_mfma_f32_32x32x16_bf16 v[160:175], a[40:43], v[248:251], v[160:175]
  buffer_load_dwordx4 v1, s[12:15], s28 offen offset:1024 lds
  v_exp_f32 v181, v149
  v_cvt_pk_bf16_f32 v206, v188, v189
  v_cvt_pk_bf16_f32 v207, v190, v191
  v_mfma_f32_32x32x16_bf16 v[64:79], a[104:107], v[200:203], v[64:79]
  v_exp_f32 v182, v150
  v_exp_f32 v183, v151
  v_cvt_pk_bf16_f32 v193, v178, v179
  v_cvt_pk_bf16_f32 v194, v180, v181
  v_mfma_f32_32x32x16_bf16 v[160:175], a[44:47], v[252:255], v[160:175]
  v_exp_f32 v184, v152
  v_exp_f32 v185, v153
  v_exp_f32 v186, v154
  v_mfma_f32_32x32x16_bf16 v[48:63], a[100:103], v[204:207], v[48:63]
  v_exp_f32 v187, v155
  v_exp_f32 v188, v156
  v_cvt_pk_bf16_f32 v195, v182, v183
  v_cvt_pk_bf16_f32 v196, v184, v185
  v_mfma_f32_32x32x16_bf16 v[64:79], a[108:111], v[204:207], v[64:79]
  s_waitcnt lgkmcnt(3)
  v_exp_f32 v189, v157
  v_exp_f32 v190, v158
  v_exp_f32 v191, v159
  v_cvt_pk_bf16_f32 v197, v186, v187
  v_mfma_f32_32x32x16_bf16 v[144:159], a[0:3], v[208:211], 0
  ds_read_b128 a[48:51], v2 offset:31744
  v_exp_f32 v176, v160
  v_exp_f32 v177, v161
  v_exp_f32 v178, v162
  v_mfma_f32_32x32x16_bf16 v[80:95], a[96:99], v[192:195], v[80:95]
  ds_read_b128 a[20:23], v3 offset:30720
  v_exp_f32 v179, v163
  v_exp_f32 v180, v164
  v_cvt_pk_bf16_f32 v200, v176, v177
  v_mfma_f32_32x32x16_bf16 v[144:159], a[4:7], v[212:215], v[144:159]
  buffer_load_dwordx4 v1, s[12:15], s28 offen offset:2048 lds
  v_exp_f32 v181, v165
  v_cvt_pk_bf16_f32 v198, v188, v189
  v_cvt_pk_bf16_f32 v199, v190, v191
  v_mfma_f32_32x32x16_bf16 v[96:111], a[104:107], v[192:195], v[96:111]
  v_exp_f32 v182, v166
  v_exp_f32 v183, v167
  v_cvt_pk_bf16_f32 v201, v178, v179
  v_cvt_pk_bf16_f32 v202, v180, v181
  v_mfma_f32_32x32x16_bf16 v[144:159], a[8:11], v[216:219], v[144:159]
  v_exp_f32 v184, v168
  v_exp_f32 v185, v169
  v_exp_f32 v186, v170
  v_mfma_f32_32x32x16_bf16 v[80:95], a[100:103], v[196:199], v[80:95]
  v_exp_f32 v187, v171
  v_exp_f32 v188, v172
  v_cvt_pk_bf16_f32 v203, v182, v183
  v_cvt_pk_bf16_f32 v204, v184, v185
  v_mfma_f32_32x32x16_bf16 v[96:111], a[108:111], v[196:199], v[96:111]
  v_exp_f32 v189, v173
  v_exp_f32 v190, v174
  v_exp_f32 v191, v175
  v_cvt_pk_bf16_f32 v205, v186, v187
  v_mfma_f32_32x32x16_bf16 v[160:175], a[0:3], v[220:223], 0
  ds_read_b128 a[12:15], v3 offset:28672
  v_exp_f32 v176, v144
  v_exp_f32 v177, v145
  v_exp_f32 v178, v146
  v_mfma_f32_32x32x16_bf16 v[112:127], a[96:99], v[200:203], v[112:127]
  ds_read_b128 a[16:19], v3 offset:29696
  v_exp_f32 v179, v147
  v_exp_f32 v180, v148
  v_cvt_pk_bf16_f32 v192, v176, v177
  v_mfma_f32_32x32x16_bf16 v[160:175], a[4:7], v[224:227], v[160:175]
  ds_read_b128 a[40:43], v5 offset:29696
  v_exp_f32 v181, v149
  v_cvt_pk_bf16_f32 v206, v188, v189
  v_cvt_pk_bf16_f32 v207, v190, v191
  v_cvt_pk_bf16_f32 v193, v178, v179
  v_mfma_f32_32x32x16_bf16 v[128:143], a[104:107], v[200:203], v[128:143]
  v_exp_f32 v182, v150
  v_exp_f32 v183, v151
  v_exp_f32 v184, v152
  v_mfma_f32_32x32x16_bf16 v[160:175], a[8:11], v[228:231], v[160:175]
  v_exp_f32 v185, v153
  v_exp_f32 v186, v154
  v_cvt_pk_bf16_f32 v194, v180, v181
  v_cvt_pk_bf16_f32 v195, v182, v183
  v_mfma_f32_32x32x16_bf16 v[112:127], a[100:103], v[204:207], v[112:127]
  v_exp_f32 v187, v155
  v_exp_f32 v188, v156
  v_exp_f32 v189, v157
  v_mfma_f32_32x32x16_bf16 v[128:143], a[108:111], v[204:207], v[128:143]
  v_exp_f32 v190, v158
  v_exp_f32 v191, v159
  v_cvt_pk_bf16_f32 v196, v184, v185
  v_cvt_pk_bf16_f32 v197, v186, v187
  v_mfma_f32_32x32x16_bf16 v[144:159], a[0:3], v[232:235], 0
  s_waitcnt lgkmcnt(4)
  v_exp_f32 v176, v160
  v_exp_f32 v177, v161
  v_exp_f32 v178, v162
  v_mfma_f32_32x32x16_bf16 v[16:31], a[48:51], v[192:195], v[16:31]
  ds_read_b128 a[68:71], v3 offset:32768
  v_exp_f32 v179, v163
  v_exp_f32 v180, v164
  v_cvt_pk_bf16_f32 v200, v176, v177
  v_mfma_f32_32x32x16_bf16 v[144:159], a[4:7], v[236:239], v[144:159]
  ds_read_b128 a[76:79], v3 offset:34816
  v_exp_f32 v181, v165
  v_cvt_pk_bf16_f32 v198, v188, v189
  v_cvt_pk_bf16_f32 v199, v190, v191
  v_cvt_pk_bf16_f32 v201, v178, v179
  v_mfma_f32_32x32x16_bf16 v[32:47], a[56:59], v[192:195], v[32:47]
  ds_read_b128 a[36:39], v5 offset:28672
  v_exp_f32 v182, v166
  v_exp_f32 v183, v167
  v_cvt_pk_bf16_f32 v202, v180, v181
  v_mfma_f32_32x32x16_bf16 v[144:159], a[8:11], v[240:243], v[144:159]
  v_exp_f32 v184, v168
  v_exp_f32 v185, v169
  v_exp_f32 v186, v170
  v_mfma_f32_32x32x16_bf16 v[16:31], a[52:55], v[196:199], v[16:31]
  v_exp_f32 v187, v171
  v_exp_f32 v188, v172
  v_cvt_pk_bf16_f32 v203, v182, v183
  v_cvt_pk_bf16_f32 v204, v184, v185
  v_mfma_f32_32x32x16_bf16 v[32:47], a[60:63], v[196:199], v[32:47]
  s_waitcnt lgkmcnt(4)
  v_exp_f32 v189, v173
  v_exp_f32 v190, v174
  v_exp_f32 v191, v175
  v_cvt_pk_bf16_f32 v205, v186, v187
  v_mfma_f32_32x32x16_bf16 v[160:175], a[12:15], v[208:211], 0
  ds_read_b128 a[64:67], v3 offset:31744
  v_exp_f32 v176, v144
  v_exp_f32 v177, v145
  v_exp_f32 v178, v146
  v_mfma_f32_32x32x16_bf16 v[48:63], a[48:51], v[200:203], v[48:63]
  ds_read_b128 a[72:75], v3 offset:33792
  v_exp_f32 v179, v147
  v_exp_f32 v180, v148
  v_cvt_pk_bf16_f32 v192, v176, v177
  v_mfma_f32_32x32x16_bf16 v[160:175], a[16:19], v[212:215], v[160:175]
  ds_read_b128 a[108:111], v5 offset:34816
  v_exp_f32 v181, v149
  v_cvt_pk_bf16_f32 v206, v188, v189
  v_cvt_pk_bf16_f32 v207, v190, v191
  v_cvt_pk_bf16_f32 v193, v178, v179
  v_mfma_f32_32x32x16_bf16 v[64:79], a[56:59], v[200:203], v[64:79]
  v_exp_f32 v182, v150
  v_exp_f32 v183, v151
  v_exp_f32 v184, v152
  v_mfma_f32_32x32x16_bf16 v[160:175], a[20:23], v[216:219], v[160:175]
  v_exp_f32 v185, v153
  v_exp_f32 v186, v154
  v_cvt_pk_bf16_f32 v194, v180, v181
  v_cvt_pk_bf16_f32 v195, v182, v183
  v_mfma_f32_32x32x16_bf16 v[48:63], a[52:55], v[204:207], v[48:63]
  v_exp_f32 v187, v155
  v_exp_f32 v188, v156
  v_exp_f32 v189, v157
  v_mfma_f32_32x32x16_bf16 v[64:79], a[60:63], v[204:207], v[64:79]
  v_exp_f32 v190, v158
  v_exp_f32 v191, v159
  v_cvt_pk_bf16_f32 v196, v184, v185
  v_cvt_pk_bf16_f32 v197, v186, v187
  v_mfma_f32_32x32x16_bf16 v[144:159], a[12:15], v[220:223], 0
  ds_read_b128 a[24:27], v4 offset:28672
  v_exp_f32 v176, v160
  v_exp_f32 v177, v161
  v_exp_f32 v178, v162
  v_mfma_f32_32x32x16_bf16 v[80:95], a[48:51], v[192:195], v[80:95]
  ds_read_b128 a[84:87], v4 offset:32768
  v_exp_f32 v179, v163
  v_exp_f32 v180, v164
  v_cvt_pk_bf16_f32 v200, v176, v177
  v_mfma_f32_32x32x16_bf16 v[144:159], a[16:19], v[224:227], v[144:159]
  ds_read_b128 a[104:107], v5 offset:33792
  v_exp_f32 v181, v165
  v_cvt_pk_bf16_f32 v198, v188, v189
  v_cvt_pk_bf16_f32 v199, v190, v191
  v_cvt_pk_bf16_f32 v201, v178, v179
  v_mfma_f32_32x32x16_bf16 v[96:111], a[56:59], v[192:195], v[96:111]
  v_exp_f32 v182, v166
  v_exp_f32 v183, v167
  v_exp_f32 v184, v168
  v_mfma_f32_32x32x16_bf16 v[144:159], a[20:23], v[228:231], v[144:159]
  v_exp_f32 v185, v169
  v_exp_f32 v186, v170
  v_cvt_pk_bf16_f32 v202, v180, v181
  v_cvt_pk_bf16_f32 v203, v182, v183
  v_mfma_f32_32x32x16_bf16 v[80:95], a[52:55], v[196:199], v[80:95]
  v_exp_f32 v187, v171
  v_exp_f32 v188, v172
  v_exp_f32 v189, v173
  v_mfma_f32_32x32x16_bf16 v[96:111], a[60:63], v[196:199], v[96:111]
  v_exp_f32 v190, v174
  v_exp_f32 v191, v175
  v_cvt_pk_bf16_f32 v204, v184, v185
  v_cvt_pk_bf16_f32 v205, v186, v187
  v_mfma_f32_32x32x16_bf16 v[160:175], a[12:15], v[232:235], 0
  s_waitcnt lgkmcnt(4)
  v_exp_f32 v176, v144
  v_exp_f32 v177, v145
  v_exp_f32 v178, v146
  v_mfma_f32_32x32x16_bf16 v[16:31], a[64:67], v[200:203], v[16:31]
  ds_read_b128 a[80:83], v4 offset:31744
  v_exp_f32 v179, v147
  v_exp_f32 v180, v148
  v_cvt_pk_bf16_f32 v192, v176, v177
  v_mfma_f32_32x32x16_bf16 v[160:175], a[16:19], v[236:239], v[160:175]
  ds_read_b128 a[92:95], v4 offset:34816
  v_exp_f32 v181, v149
  v_cvt_pk_bf16_f32 v206, v188, v189
  v_cvt_pk_bf16_f32 v207, v190, v191
  v_cvt_pk_bf16_f32 v193, v178, v179
  v_mfma_f32_32x32x16_bf16 v[32:47], a[72:75], v[200:203], v[32:47]
  ds_read_b128 a[100:103], v5 offset:32768
  v_exp_f32 v182, v150
  v_exp_f32 v183, v151
  v_cvt_pk_bf16_f32 v194, v180, v181
  v_mfma_f32_32x32x16_bf16 v[160:175], a[20:23], v[240:243], v[160:175]
  s_add_u32 s20, s20, 28672
  v_exp_f32 v184, v152
  v_exp_f32 v185, v153
  v_exp_f32 v186, v154
  v_mfma_f32_32x32x16_bf16 v[16:31], a[68:71], v[204:207], v[16:31]
  s_cmp_ge_u32 s20, s21
  s_cselect_b32 s25, 401408, 0
  v_exp_f32 v187, v155
  v_exp_f32 v188, v156
  v_cvt_pk_bf16_f32 v195, v182, v183
  v_mfma_f32_32x32x16_bf16 v[32:47], a[76:79], v[204:207], v[32:47]
  s_sub_u32 s20, s20, s25
  v_exp_f32 v189, v157
  v_exp_f32 v190, v158
  v_exp_f32 v191, v159
  v_cvt_pk_bf16_f32 v196, v184, v185
  v_cvt_pk_bf16_f32 v197, v186, v187
  v_mfma_f32_32x32x16_bf16 v[144:159], a[12:15], v[244:247], 0
  ds_read_b128 a[88:91], v4 offset:33792
  v_exp_f32 v176, v160
  v_exp_f32 v177, v161
  v_exp_f32 v178, v162
  v_mfma_f32_32x32x16_bf16 v[48:63], a[64:67], v[192:195], v[48:63]
  ds_read_b128 a[44:47], v5 offset:30720
  v_exp_f32 v179, v163
  v_exp_f32 v180, v164
  v_cvt_pk_bf16_f32 v200, v176, v177
  v_mfma_f32_32x32x16_bf16 v[144:159], a[16:19], v[248:251], v[144:159]
  ds_read_b128 a[96:99], v5 offset:31744
  v_exp_f32 v181, v165
  v_cvt_pk_bf16_f32 v198, v188, v189
  v_cvt_pk_bf16_f32 v199, v190, v191
  v_cvt_pk_bf16_f32 v201, v178, v179
  v_mfma_f32_32x32x16_bf16 v[64:79], a[72:75], v[192:195], v[64:79]
  s_add_u32 s28, s20, 4096
  v_exp_f32 v182, v166
  v_exp_f32 v183, v167
  v_exp_f32 v184, v168
  v_mfma_f32_32x32x16_bf16 v[144:159], a[20:23], v[252:255], v[144:159]
  v_exp_f32 v185, v169
  v_exp_f32 v186, v170
  v_cvt_pk_bf16_f32 v202, v180, v181
  v_cvt_pk_bf16_f32 v203, v182, v183
  v_mfma_f32_32x32x16_bf16 v[48:63], a[68:71], v[196:199], v[48:63]
  v_exp_f32 v187, v171
  v_exp_f32 v188, v172
  v_exp_f32 v189, v173
  v_mfma_f32_32x32x16_bf16 v[64:79], a[76:79], v[196:199], v[64:79]
  s_waitcnt lgkmcnt(8)
  v_exp_f32 v190, v174
  v_exp_f32 v191, v175
  v_cvt_pk_bf16_f32 v204, v184, v185
  v_cvt_pk_bf16_f32 v205, v186, v187
  v_mfma_f32_32x32x16_bf16 v[160:175], a[24:27], v[208:211], 0
  v_exp_f32 v176, v144
  v_exp_f32 v177, v145
  v_exp_f32 v178, v146
  v_mfma_f32_32x32x16_bf16 v[80:95], a[64:67], v[200:203], v[80:95]
  v_exp_f32 v179, v147
  v_exp_f32 v180, v148
  v_cvt_pk_bf16_f32 v192, v176, v177
  v_mfma_f32_32x32x16_bf16 v[160:175], a[28:31], v[212:215], v[160:175]
  v_exp_f32 v181, v149
  v_exp_f32 v182, v150
  v_cvt_pk_bf16_f32 v206, v188, v189
  v_cvt_pk_bf16_f32 v207, v190, v191
  v_mfma_f32_32x32x16_bf16 v[96:111], a[72:75], v[200:203], v[96:111]
  v_exp_f32 v183, v151
  v_exp_f32 v184, v152
  v_cvt_pk_bf16_f32 v193, v178, v179
  v_cvt_pk_bf16_f32 v194, v180, v181
  v_mfma_f32_32x32x16_bf16 v[160:175], a[32:35], v[216:219], v[160:175]
  v_exp_f32 v185, v153
  v_exp_f32 v186, v154
  v_exp_f32 v187, v155
  v_mfma_f32_32x32x16_bf16 v[80:95], a[68:71], v[204:207], v[80:95]
  v_exp_f32 v188, v156
  v_exp_f32 v189, v157
  v_cvt_pk_bf16_f32 v195, v182, v183
  v_cvt_pk_bf16_f32 v196, v184, v185
  v_mfma_f32_32x32x16_bf16 v[96:111], a[76:79], v[204:207], v[96:111]
  v_exp_f32 v190, v158
  v_exp_f32 v191, v159
  v_cvt_pk_bf16_f32 v197, v186, v187
  v_add_u32 v2, s23, v2
  v_mfma_f32_32x32x16_bf16 v[144:159], a[24:27], v[220:223], 0
  s_waitcnt vmcnt(0) lgkmcnt(0)
  v_exp_f32 v176, v160
  v_exp_f32 v177, v161
  v_exp_f32 v178, v162
  v_mfma_f32_32x32x16_bf16 v[112:127], a[64:67], v[192:195], v[112:127]
  s_barrier
  v_exp_f32 v179, v163
  v_exp_f32 v180, v164
  v_exp_f32 v181, v165
  v_mfma_f32_32x32x16_bf16 v[144:159], a[28:31], v[224:227], v[144:159]
  ds_read_b128 a[60:63], v2 offset:6144
  v_cvt_pk_bf16_f32 v198, v188, v189
  v_cvt_pk_bf16_f32 v199, v190, v191
  v_cvt_pk_bf16_f32 v200, v176, v177
  v_cvt_pk_bf16_f32 v201, v178, v179
  v_cvt_pk_bf16_f32 v202, v180, v181
  v_mfma_f32_32x32x16_bf16 v[128:143], a[72:75], v[192:195], v[128:143]
  s_add_u32 m0, s22, 28672
  v_exp_f32 v182, v166
  v_exp_f32 v183, v167
  v_exp_f32 v184, v168
  v_mfma_f32_32x32x16_bf16 v[144:159], a[32:35], v[228:231], v[144:159]
  buffer_load_dwordx4 v1, s[12:15], s20 offen offset:0 lds
  v_exp_f32 v185, v169
  v_exp_f32 v186, v170
  v_mfma_f32_32x32x16_bf16 v[112:127], a[68:71], v[196:199], v[112:127]
  v_exp_f32 v187, v171
  v_exp_f32 v188, v172
  v_cvt_pk_bf16_f32 v203, v182, v183
  v_cvt_pk_bf16_f32 v204, v184, v185
  v_mfma_f32_32x32x16_bf16 v[128:143], a[76:79], v[196:199], v[128:143]
  v_exp_f32 v189, v173
  v_exp_f32 v190, v174
  v_exp_f32 v191, v175
  v_cvt_pk_bf16_f32 v205, v186, v187
  v_mfma_f32_32x32x16_bf16 v[160:175], a[24:27], v[232:235], 0
  s_nop 0
  v_exp_f32 v176, v144
  v_exp_f32 v177, v145
  v_exp_f32 v178, v146
  v_mfma_f32_32x32x16_bf16 v[16:31], a[80:83], v[200:203], v[16:31]
  ds_read_b128 a[56:59], v2 offset:5120
  v_exp_f32 v179, v147
  v_exp_f32 v180, v148
  v_cvt_pk_bf16_f32 v192, v176, v177
  v_mfma_f32_32x32x16_bf16 v[160:175], a[28:31], v[236:239], v[160:175]
  buffer_load_dwordx4 v1, s[12:15], s20 offen offset:1024 lds
  v_exp_f32 v181, v149
  v_cvt_pk_bf16_f32 v206, v188, v189
  v_cvt_pk_bf16_f32 v207, v190, v191
  v_mfma_f32_32x32x16_bf16 v[32:47], a[88:91], v[200:203], v[32:47]
  v_exp_f32 v182, v150
  v_exp_f32 v183, v151
  v_cvt_pk_bf16_f32 v193, v178, v179
  v_cvt_pk_bf16_f32 v194, v180, v181
  v_mfma_f32_32x32x16_bf16 v[160:175], a[32:35], v[240:243], v[160:175]
  v_exp_f32 v184, v152
  v_exp_f32 v185, v153
  v_exp_f32 v186, v154
  v_mfma_f32_32x32x16_bf16 v[16:31], a[84:87], v[204:207], v[16:31]
  v_exp_f32 v187, v155
  v_exp_f32 v188, v156
  v_cvt_pk_bf16_f32 v195, v182, v183
  v_cvt_pk_bf16_f32 v196, v184, v185
  v_mfma_f32_32x32x16_bf16 v[32:47], a[92:95], v[204:207], v[32:47]
  s_nop 0
  v_exp_f32 v189, v157
  v_exp_f32 v190, v158
  v_exp_f32 v191, v159
  v_cvt_pk_bf16_f32 v197, v186, v187
  v_add_u32 v4, s23, v4
  v_mfma_f32_32x32x16_bf16 v[144:159], a[36:39], v[208:211], 0
  ds_read_b128 a[8:11], v2 offset:2048
  v_exp_f32 v176, v160
  v_exp_f32 v177, v161
  v_exp_f32 v178, v162
  v_mfma_f32_32x32x16_bf16 v[48:63], a[80:83], v[192:195], v[48:63]
  buffer_load_dwordx4 v1, s[12:15], s20 offen offset:2048 lds
  v_exp_f32 v179, v163
  v_exp_f32 v180, v164
  v_mfma_f32_32x32x16_bf16 v[144:159], a[40:43], v[212:215], v[144:159]
  v_exp_f32 v181, v165
  v_cvt_pk_bf16_f32 v198, v188, v189
  v_cvt_pk_bf16_f32 v199, v190, v191
  v_cvt_pk_bf16_f32 v200, v176, v177
  v_cvt_pk_bf16_f32 v201, v178, v179
  v_mfma_f32_32x32x16_bf16 v[64:79], a[88:91], v[192:195], v[64:79]
  v_exp_f32 v182, v166
  v_exp_f32 v183, v167
  v_exp_f32 v184, v168
  v_mfma_f32_32x32x16_bf16 v[144:159], a[44:47], v[216:219], v[144:159]
  v_exp_f32 v185, v169
  v_exp_f32 v186, v170
  v_cvt_pk_bf16_f32 v202, v180, v181
  v_cvt_pk_bf16_f32 v203, v182, v183
  v_mfma_f32_32x32x16_bf16 v[48:63], a[84:87], v[196:199], v[48:63]
  v_exp_f32 v187, v171
  v_exp_f32 v188, v172
  v_exp_f32 v189, v173
  v_mfma_f32_32x32x16_bf16 v[64:79], a[92:95], v[196:199], v[64:79]
  v_exp_f32 v190, v174
  v_exp_f32 v191, v175
  v_cvt_pk_bf16_f32 v204, v184, v185
  v_cvt_pk_bf16_f32 v205, v186, v187
  v_mfma_f32_32x32x16_bf16 v[160:175], a[36:39], v[220:223], 0
  ds_read_b128 a[4:7], v2 offset:1024
  v_exp_f32 v176, v144
  v_exp_f32 v177, v145
  v_exp_f32 v178, v146
  v_mfma_f32_32x32x16_bf16 v[80:95], a[80:83], v[200:203], v[80:95]
  buffer_load_dwordx4 v1, s[12:15], s20 offen offset:3072 lds
  v_exp_f32 v179, v147
  v_exp_f32 v180, v148
  v_mfma_f32_32x32x16_bf16 v[160:175], a[40:43], v[224:227], v[160:175]
  v_exp_f32 v181, v149
  v_cvt_pk_bf16_f32 v206, v188, v189
  v_cvt_pk_bf16_f32 v207, v190, v191
  v_cvt_pk_bf16_f32 v192, v176, v177
  v_cvt_pk_bf16_f32 v193, v178, v179
  v_mfma_f32_32x32x16_bf16 v[96:111], a[88:91], v[200:203], v[96:111]
  v_exp_f32 v182, v150
  v_exp_f32 v183, v151
  v_exp_f32 v184, v152
  v_mfma_f32_32x32x16_bf16 v[160:175], a[44:47], v[228:231], v[160:175]
  v_exp_f32 v185, v153
  v_exp_f32 v186, v154
  v_cvt_pk_bf16_f32 v194, v180, v181
  v_cvt_pk_bf16_f32 v195, v182, v183
  v_mfma_f32_32x32x16_bf16 v[80:95], a[84:87], v[204:207], v[80:95]
  v_exp_f32 v187, v155
  v_exp_f32 v188, v156
  v_exp_f32 v189, v157
  v_mfma_f32_32x32x16_bf16 v[96:111], a[92:95], v[204:207], v[96:111]
  v_exp_f32 v190, v158
  v_exp_f32 v191, v159
  v_cvt_pk_bf16_f32 v196, v184, v185
  v_cvt_pk_bf16_f32 v197, v186, v187
  v_add_u32 v5, s23, v5
  v_mfma_f32_32x32x16_bf16 v[144:159], a[36:39], v[232:235], 0
  s_nop 0
  v_exp_f32 v176, v160
  v_exp_f32 v177, v161
  v_exp_f32 v178, v162
  v_mfma_f32_32x32x16_bf16 v[16:31], a[96:99], v[192:195], v[16:31]
  ds_read_b128 a[0:3], v2 offset:0
  v_exp_f32 v179, v163
  v_exp_f32 v180, v164
  v_cvt_pk_bf16_f32 v200, v176, v177
  v_mfma_f32_32x32x16_bf16 v[144:159], a[40:43], v[236:239], v[144:159]
  ds_read_b128 a[32:35], v4 offset:2048
  v_exp_f32 v181, v165
  v_cvt_pk_bf16_f32 v198, v188, v189
  v_cvt_pk_bf16_f32 v199, v190, v191
  v_cvt_pk_bf16_f32 v201, v178, v179
  v_mfma_f32_32x32x16_bf16 v[32:47], a[104:107], v[192:195], v[32:47]
  s_add_u32 m0, s22, 32768
  v_exp_f32 v182, v166
  v_exp_f32 v183, v167
  v_exp_f32 v184, v168
  v_mfma_f32_32x32x16_bf16 v[144:159], a[44:47], v[240:243], v[144:159]
  buffer_load_dwordx4 v1, s[12:15], s28 offen offset:0 lds
  v_exp_f32 v185, v169
  v_cvt_pk_bf16_f32 v202, v180, v181
  v_cvt_pk_bf16_f32 v203, v182, v183
  v_mfma_f32_32x32x16_bf16 v[16:31], a[100:103], v[196:199], v[16:31]
  v_exp_f32 v186, v170
  v_exp_f32 v187, v171
  v_exp_f32 v188, v172
  v_mfma_f32_32x32x16_bf16 v[32:47], a[108:111], v[196:199], v[32:47]
  v_exp_f32 v189, v173
  v_exp_f32 v190, v174
  v_exp_f32 v191, v175
  v_cvt_pk_bf16_f32 v204, v184, v185
  v_cvt_pk_bf16_f32 v205, v186, v187
  v_add_u32 v3, s23, v3
  v_mfma_f32_32x32x16_bf16 v[160:175], a[36:39], v[244:247], 0
  ds_read_b128 a[52:55], v2 offset:4096
  v_exp_f32 v176, v144
  v_exp_f32 v177, v145
  v_exp_f32 v178, v146
  v_mfma_f32_32x32x16_bf16 v[48:63], a[96:99], v[200:203], v[48:63]
  ds_read_b128 a[28:31], v4 offset:1024
  v_exp_f32 v179, v147
  v_exp_f32 v180, v148
  v_cvt_pk_bf16_f32 v192, v176, v177
  v_mfma_f32_32x32x16_bf16 v[160:175], a[40:43], v[248:251], v[160:175]
  buffer_load_dwordx4 v1, s[12:15], s28 offen offset:1024 lds
  v_exp_f32 v181, v149
  v_cvt_pk_bf16_f32 v206, v188, v189
  v_cvt_pk_bf16_f32 v207, v190, v191
  v_mfma_f32_32x32x16_bf16 v[64:79], a[104:107], v[200:203], v[64:79]
  v_exp_f32 v182, v150
  v_exp_f32 v183, v151
  v_cvt_pk_bf16_f32 v193, v178, v179
  v_cvt_pk_bf16_f32 v194, v180, v181
  v_mfma_f32_32x32x16_bf16 v[160:175], a[44:47], v[252:255], v[160:175]
  v_exp_f32 v184, v152
  v_exp_f32 v185, v153
  v_exp_f32 v186, v154
  v_mfma_f32_32x32x16_bf16 v[48:63], a[100:103], v[204:207], v[48:63]
  v_exp_f32 v187, v155
  v_exp_f32 v188, v156
  v_cvt_pk_bf16_f32 v195, v182, v183
  v_cvt_pk_bf16_f32 v196, v184, v185
  v_mfma_f32_32x32x16_bf16 v[64:79], a[108:111], v[204:207], v[64:79]
  s_waitcnt lgkmcnt(3)
  v_exp_f32 v189, v157
  v_exp_f32 v190, v158
  v_exp_f32 v191, v159
  v_cvt_pk_bf16_f32 v197, v186, v187
  v_mfma_f32_32x32x16_bf16 v[144:159], a[0:3], v[208:211], 0
  ds_read_b128 a[48:51], v2 offset:3072
  v_exp_f32 v176, v160
  v_exp_f32 v177, v161
  v_exp_f32 v178, v162
  v_mfma_f32_32x32x16_bf16 v[80:95], a[96:99], v[192:195], v[80:95]
  ds_read_b128 a[20:23], v3 offset:2048
  v_exp_f32 v179, v163
  v_exp_f32 v180, v164
  v_cvt_pk_bf16_f32 v200, v176, v177
  v_mfma_f32_32x32x16_bf16 v[144:159], a[4:7], v[212:215], v[144:159]
  buffer_load_dwordx4 v1, s[12:15], s28 offen offset:2048 lds
  v_exp_f32 v181, v165
  v_cvt_pk_bf16_f32 v198, v188, v189
  v_cvt_pk_bf16_f32 v199, v190, v191
  v_mfma_f32_32x32x16_bf16 v[96:111], a[104:107], v[192:195], v[96:111]
  v_exp_f32 v182, v166
  v_exp_f32 v183, v167
  v_cvt_pk_bf16_f32 v201, v178, v179
  v_cvt_pk_bf16_f32 v202, v180, v181
  v_mfma_f32_32x32x16_bf16 v[144:159], a[8:11], v[216:219], v[144:159]
  v_exp_f32 v184, v168
  v_exp_f32 v185, v169
  v_exp_f32 v186, v170
  v_mfma_f32_32x32x16_bf16 v[80:95], a[100:103], v[196:199], v[80:95]
  v_exp_f32 v187, v171
  v_exp_f32 v188, v172
  v_cvt_pk_bf16_f32 v203, v182, v183
  v_cvt_pk_bf16_f32 v204, v184, v185
  v_mfma_f32_32x32x16_bf16 v[96:111], a[108:111], v[196:199], v[96:111]
  v_exp_f32 v189, v173
  v_exp_f32 v190, v174
  v_exp_f32 v191, v175
  v_cvt_pk_bf16_f32 v205, v186, v187
  s_sub_u32 s22, s22, s23
  s_sub_u32 s23, 0, s23
  s_add_u32 s24, s24, 2
  s_cmp_lt_u32 s24, 12
  s_cbranch_scc1 L_loop_H
  v_mfma_f32_32x32x16_bf16 v[160:175], a[0:3], v[220:223], 0
  ds_read_b128 a[12:15], v3 offset:0
  v_exp_f32 v176, v144
  v_exp_f32 v177, v145
  v_exp_f32 v178, v146
  v_mfma_f32_32x32x16_bf16 v[112:127], a[96:99], v[200:203], v[112:127]
  ds_read_b128 a[16:19], v3 offset:1024
  v_exp_f32 v179, v147
  v_exp_f32 v180, v148
  v_cvt_pk_bf16_f32 v192, v176, v177
  v_mfma_f32_32x32x16_bf16 v[160:175], a[4:7], v[224:227], v[160:175]
  ds_read_b128 a[40:43], v5 offset:1024
  v_exp_f32 v181, v149
  v_cvt_pk_bf16_f32 v206, v188, v189
  v_cvt_pk_bf16_f32 v207, v190, v191
  v_cvt_pk_bf16_f32 v193, v178, v179
  v_mfma_f32_32x32x16_bf16 v[128:143], a[104:107], v[200:203], v[128:143]
  v_exp_f32 v182, v150
  v_exp_f32 v183, v151
  v_exp_f32 v184, v152
  v_mfma_f32_32x32x16_bf16 v[160:175], a[8:11], v[228:231], v[160:175]
  v_exp_f32 v185, v153
  v_exp_f32 v186, v154
  v_cvt_pk_bf16_f32 v194, v180, v181
  v_cvt_pk_bf16_f32 v195, v182, v183
  v_mfma_f32_32x32x16_bf16 v[112:127], a[100:103], v[204:207], v[112:127]
  v_exp_f32 v187, v155
  v_exp_f32 v188, v156
  v_exp_f32 v189, v157
  v_mfma_f32_32x32x16_bf16 v[128:143], a[108:111], v[204:207], v[128:143]
  v_exp_f32 v190, v158
  v_exp_f32 v191, v159
  v_cvt_pk_bf16_f32 v196, v184, v185
  v_cvt_pk_bf16_f32 v197, v186, v187
  v_mfma_f32_32x32x16_bf16 v[144:159], a[0:3], v[232:235], 0
  s_waitcnt lgkmcnt(0)
  v_exp_f32 v176, v160
  v_exp_f32 v177, v161
  v_exp_f32 v178, v162
  v_mfma_f32_32x32x16_bf16 v[16:31], a[48:51], v[192:195], v[16:31]
  ds_read_b128 a[68:71], v3 offset:4096
  v_exp_f32 v179, v163
  v_exp_f32 v180, v164
  v_cvt_pk_bf16_f32 v200, v176, v177
  v_mfma_f32_32x32x16_bf16 v[144:159], a[4:7], v[236:239], v[144:159]
  ds_read_b128 a[76:79], v3 offset:6144
  v_exp_f32 v181, v165
  v_cvt_pk_bf16_f32 v198, v188, v189
  v_cvt_pk_bf16_f32 v199, v190, v191
  v_cvt_pk_bf16_f32 v201, v178, v179
  v_mfma_f32_32x32x16_bf16 v[32:47], a[56:59], v[192:195], v[32:47]
  ds_read_b128 a[36:39], v5 offset:0
  v_exp_f32 v182, v166
  v_exp_f32 v183, v167
  v_cvt_pk_bf16_f32 v202, v180, v181
  v_mfma_f32_32x32x16_bf16 v[144:159], a[8:11], v[240:243], v[144:159]
  v_exp_f32 v184, v168
  v_exp_f32 v185, v169
  v_exp_f32 v186, v170
  v_mfma_f32_32x32x16_bf16 v[16:31], a[52:55], v[196:199], v[16:31]
  v_exp_f32 v187, v171
  v_exp_f32 v188, v172
  v_cvt_pk_bf16_f32 v203, v182, v183
  v_cvt_pk_bf16_f32 v204, v184, v185
  v_mfma_f32_32x32x16_bf16 v[32:47], a[60:63], v[196:199], v[32:47]
  s_waitcnt lgkmcnt(4)
  v_exp_f32 v189, v173
  v_exp_f32 v190, v174
  v_exp_f32 v191, v175
  v_cvt_pk_bf16_f32 v205, v186, v187
  v_mfma_f32_32x32x16_bf16 v[160:175], a[12:15], v[208:211], 0
  ds_read_b128 a[64:67], v3 offset:3072
  v_exp_f32 v176, v144
  v_exp_f32 v177, v145
  v_exp_f32 v178, v146
  v_mfma_f32_32x32x16_bf16 v[48:63], a[48:51], v[200:203], v[48:63]
  ds_read_b128 a[72:75], v3 offset:5120
  v_exp_f32 v179, v147
  v_exp_f32 v180, v148
  v_cvt_pk_bf16_f32 v192, v176, v177
  v_mfma_f32_32x32x16_bf16 v[160:175], a[16:19], v[212:215], v[160:175]
  ds_read_b128 a[108:111], v5 offset:6144
  v_exp_f32 v181, v149
  v_cvt_pk_bf16_f32 v206, v188, v189
  v_cvt_pk_bf16_f32 v207, v190, v191
  v_cvt_pk_bf16_f32 v193, v178, v179
  v_mfma_f32_32x32x16_bf16 v[64:79], a[56:59], v[200:203], v[64:79]
  v_exp_f32 v182, v150
  v_exp_f32 v183, v151
  v_exp_f32 v184, v152
  v_mfma_f32_32x32x16_bf16 v[160:175], a[20:23], v[216:219], v[160:175]
  v_exp_f32 v185, v153
  v_exp_f32 v186, v154
  v_cvt_pk_bf16_f32 v194, v180, v181
  v_cvt_pk_bf16_f32 v195, v182, v183
  v_mfma_f32_32x32x16_bf16 v[48:63], a[52:55], v[204:207], v[48:63]
  v_exp_f32 v187, v155
  v_exp_f32 v188, v156
  v_exp_f32 v189, v157
  v_mfma_f32_32x32x16_bf16 v[64:79], a[60:63], v[204:207], v[64:79]
  v_exp_f32 v190, v158
  v_exp_f32 v191, v159
  v_cvt_pk_bf16_f32 v196, v184, v185
  v_cvt_pk_bf16_f32 v197, v186, v187
  v_mfma_f32_32x32x16_bf16 v[144:159], a[12:15], v[220:223], 0
  ds_read_b128 a[24:27], v4 offset:0
  v_exp_f32 v176, v160
  v_exp_f32 v177, v161
  v_exp_f32 v178, v162
  v_mfma_f32_32x32x16_bf16 v[80:95], a[48:51], v[192:195], v[80:95]
  ds_read_b128 a[84:87], v4 offset:4096
  v_exp_f32 v179, v163
  v_exp_f32 v180, v164
  v_cvt_pk_bf16_f32 v200, v176, v177
  v_mfma_f32_32x32x16_bf16 v[144:159], a[16:19], v[224:227], v[144:159]
  ds_read_b128 a[104:107], v5 offset:5120
  v_exp_f32 v181, v165
  v_cvt_pk_bf16_f32 v198, v188, v189
  v_cvt_pk_bf16_f32 v199, v190, v191
  v_cvt_pk_bf16_f32 v201, v178, v179
  v_mfma_f32_32x32x16_bf16 v[96:111], a[56:59], v[192:195], v[96:111]
  v_exp_f32 v182, v166
  v_exp_f32 v183, v167
  v_exp_f32 v184, v168
  v_mfma_f32_32x32x16_bf16 v[144:159], a[20:23], v[228:231], v[144:159]
  v_exp_f32 v185, v169
  v_exp_f32 v186, v170
  v_cvt_pk_bf16_f32 v202, v180, v181
  v_cvt_pk_bf16_f32 v203, v182, v183
  v_mfma_f32_32x32x16_bf16 v[80:95], a[52:55], v[196:199], v[80:95]
  v_exp_f32 v187, v171
  v_exp_f32 v188, v172
  v_exp_f32 v189, v173
  v_mfma_f32_32x32x16_bf16 v[96:111], a[60:63], v[196:199], v[96:111]
  v_exp_f32 v190, v174
  v_exp_f32 v191, v175
  v_cvt_pk_bf16_f32 v204, v184, v185
  v_cvt_pk_bf16_f32 v205, v186, v187
  v_mfma_f32_32x32x16_bf16 v[160:175], a[12:15], v[232:235], 0
  s_waitcnt lgkmcnt(4)
  v_exp_f32 v176, v144
  v_exp_f32 v177, v145
  v_exp_f32 v178, v146
  v_mfma_f32_32x32x16_bf16 v[16:31], a[64:67], v[200:203], v[16:31]
  ds_read_b128 a[80:83], v4 offset:3072
  v_exp_f32 v179, v147
  v_exp_f32 v180, v148
  v_cvt_pk_bf16_f32 v192, v176, v177
  v_mfma_f32_32x32x16_bf16 v[160:175], a[16:19], v[236:239], v[160:175]
  ds_read_b128 a[92:95], v4 offset:6144
  v_exp_f32 v181, v149
  v_cvt_pk_bf16_f32 v206, v188, v189
  v_cvt_pk_bf16_f32 v207, v190, v191
  v_cvt_pk_bf16_f32 v193, v178, v179
  v_mfma_f32_32x32x16_bf16 v[32:47], a[72:75], v[200:203], v[32:47]
  ds_read_b128 a[100:103], v5 offset:4096
  v_exp_f32 v182, v150
  v_exp_f32 v183, v151
  v_cvt_pk_bf16_f32 v194, v180, v181
  v_mfma_f32_32x32x16_bf16 v[160:175], a[20:23], v[240:243], v[160:175]
  v_exp_f32 v184, v152
  v_exp_f32 v185, v153
  v_exp_f32 v186, v154
  v_mfma_f32_32x32x16_bf16 v[16:31], a[68:71], v[204:207], v[16:31]
  v_exp_f32 v187, v155
  v_exp_f32 v188, v156
  v_cvt_pk_bf16_f32 v195, v182, v183
  v_cvt_pk_bf16_f32 v196, v184, v185
  v_mfma_f32_32x32x16_bf16 v[32:47], a[76:79], v[204:207], v[32:47]
  v_exp_f32 v189, v157
  v_exp_f32 v190, v158
  v_exp_f32 v191, v159
  v_cvt_pk_bf16_f32 v197, v186, v187
  v_mfma_f32_32x32x16_bf16 v[144:159], a[12:15], v[244:247], 0
  ds_read_b128 a[88:91], v4 offset:5120
  v_exp_f32 v176, v160
  v_exp_f32 v177, v161
  v_exp_f32 v178, v162
  v_mfma_f32_32x32x16_bf16 v[48:63], a[64:67], v[192:195], v[48:63]
  ds_read_b128 a[44:47], v5 offset:2048
  v_exp_f32 v179, v163
  v_exp_f32 v180, v164
  v_cvt_pk_bf16_f32 v200, v176, v177
  v_mfma_f32_32x32x16_bf16 v[144:159], a[16:19], v[248:251], v[144:159]
  ds_read_b128 a[96:99], v5 offset:3072
  v_exp_f32 v181, v165
  v_cvt_pk_bf16_f32 v198, v188, v189
  v_cvt_pk_bf16_f32 v199, v190, v191
  v_cvt_pk_bf16_f32 v201, v178, v179
  v_mfma_f32_32x32x16_bf16 v[64:79], a[72:75], v[192:195], v[64:79]
  v_exp_f32 v182, v166
  v_exp_f32 v183, v167
  v_exp_f32 v184, v168
  v_mfma_f32_32x32x16_bf16 v[144:159], a[20:23], v[252:255], v[144:159]
  v_exp_f32 v185, v169
  v_exp_f32 v186, v170
  v_cvt_pk_bf16_f32 v202, v180, v181
  v_cvt_pk_bf16_f32 v203, v182, v183
  v_mfma_f32_32x32x16_bf16 v[48:63], a[68:71], v[196:199], v[48:63]
  v_exp_f32 v187, v171
  v_exp_f32 v188, v172
  v_exp_f32 v189, v173
  v_mfma_f32_32x32x16_bf16 v[64:79], a[76:79], v[196:199], v[64:79]
  s_waitcnt lgkmcnt(8)
  v_exp_f32 v190, v174
  v_exp_f32 v191, v175
  v_cvt_pk_bf16_f32 v204, v184, v185
  v_cvt_pk_bf16_f32 v205, v186, v187
  v_mfma_f32_32x32x16_bf16 v[160:175], a[24:27], v[208:211], 0
  v_exp_f32 v176, v144
  v_exp_f32 v177, v145
  v_mfma_f32_32x32x16_bf16 v[80:95], a[64:67], v[200:203], v[80:95]
  v_exp_f32 v178, v146
  v_exp_f32 v179, v147
  v_exp_f32 v180, v148
  v_mfma_f32_32x32x16_bf16 v[160:175], a[28:31], v[212:215], v[160:175]
  v_exp_f32 v181, v149
  v_cvt_pk_bf16_f32 v206, v188, v189
  v_cvt_pk_bf16_f32 v207, v190, v191
  v_cvt_pk_bf16_f32 v192, v176, v177
  v_cvt_pk_bf16_f32 v193, v178, v179
  v_mfma_f32_32x32x16_bf16 v[96:111], a[72:75], v[200:203], v[96:111]
  v_exp_f32 v182, v150
  v_exp_f32 v183, v151
  v_exp_f32 v184, v152
  v_mfma_f32_32x32x16_bf16 v[160:175], a[32:35], v[216:219], v[160:175]
  v_exp_f32 v185, v153
  v_exp_f32 v186, v154
  v_cvt_pk_bf16_f32 v194, v180, v181
  v_cvt_pk_bf16_f32 v195, v182, v183
  v_mfma_f32_32x32x16_bf16 v[80:95], a[68:71], v[204:207], v[80:95]
  v_exp_f32 v187, v155
  v_exp_f32 v188, v156
  v_exp_f32 v189, v157
  v_mfma_f32_32x32x16_bf16 v[96:111], a[76:79], v[204:207], v[96:111]
  v_exp_f32 v190, v158
  v_exp_f32 v191, v159
  v_cvt_pk_bf16_f32 v196, v184, v185
  v_cvt_pk_bf16_f32 v197, v186, v187
  v_mfma_f32_32x32x16_bf16 v[144:159], a[24:27], v[220:223], 0
  s_waitcnt vmcnt(0) lgkmcnt(0)
  v_exp_f32 v176, v160
  v_exp_f32 v177, v161
  v_exp_f32 v178, v162
  v_mfma_f32_32x32x16_bf16 v[112:127], a[64:67], v[192:195], v[112:127]
  s_barrier
  v_exp_f32 v179, v163
  v_exp_f32 v180, v164
  v_cvt_pk_bf16_f32 v200, v176, v177
  v_mfma_f32_32x32x16_bf16 v[144:159], a[28:31], v[224:227], v[144:159]
  ds_read_b128 a[60:63], v2 offset:34816
  v_exp_f32 v181, v165
  v_cvt_pk_bf16_f32 v198, v188, v189
  v_cvt_pk_bf16_f32 v199, v190, v191
  v_cvt_pk_bf16_f32 v201, v178, v179
  v_mfma_f32_32x32x16_bf16 v[128:143], a[72:75], v[192:195], v[128:143]
  v_exp_f32 v182, v166
  v_exp_f32 v183, v167
  v_exp_f32 v184, v168
  v_mfma_f32_32x32x16_bf16 v[144:159], a[32:35], v[228:231], v[144:159]
  v_exp_f32 v185, v169
  v_exp_f32 v186, v170
  v_cvt_pk_bf16_f32 v202, v180, v181
  v_cvt_pk_bf16_f32 v203, v182, v183
  v_mfma_f32_32x32x16_bf16 v[112:127], a[68:71], v[196:199], v[112:127]
  v_exp_f32 v187, v171
  v_exp_f32 v188, v172
  v_exp_f32 v189, v173
  v_mfma_f32_32x32x16_bf16 v[128:143], a[76:79], v[196:199], v[128:143]
  v_exp_f32 v190, v174
  v_exp_f32 v191, v175
  v_cvt_pk_bf16_f32 v204, v184, v185
  v_cvt_pk_bf16_f32 v205, v186, v187
  v_mfma_f32_32x32x16_bf16 v[160:175], a[24:27], v[232:235], 0
  s_nop 0
  v_exp_f32 v176, v144
  v_exp_f32 v177, v145
  v_exp_f32 v178, v146
  v_mfma_f32_32x32x16_bf16 v[16:31], a[80:83], v[200:203], v[16:31]
  ds_read_b128 a[56:59], v2 offset:33792
  v_exp_f32 v179, v147
  v_exp_f32 v180, v148
  v_mfma_f32_32x32x16_bf16 v[160:175], a[28:31], v[236:239], v[160:175]
  v_exp_f32 v181, v149
  v_cvt_pk_bf16_f32 v206, v188, v189
  v_cvt_pk_bf16_f32 v207, v190, v191
  v_cvt_pk_bf16_f32 v192, v176, v177
  v_cvt_pk_bf16_f32 v193, v178, v179
  v_mfma_f32_32x32x16_bf16 v[32:47], a[88:91], v[200:203], v[32:47]
  v_exp_f32 v182, v150
  v_exp_f32 v183, v151
  v_exp_f32 v184, v152
  v_mfma_f32_32x32x16_bf16 v[160:175], a[32:35], v[240:243], v[160:175]
  v_exp_f32 v185, v153
  v_exp_f32 v186, v154
  v_cvt_pk_bf16_f32 v194, v180, v181
  v_cvt_pk_bf16_f32 v195, v182, v183
  v_mfma_f32_32x32x16_bf16 v[16:31], a[84:87], v[204:207], v[16:31]
  v_exp_f32 v187, v155
  v_exp_f32 v188, v156
  v_exp_f32 v189, v157
  v_mfma_f32_32x32x16_bf16 v[32:47], a[92:95], v[204:207], v[32:47]
  s_nop 0
  v_exp_f32 v190, v158
  v_exp_f32 v191, v159
  v_cvt_pk_bf16_f32 v196, v184, v185
  v_cvt_pk_bf16_f32 v197, v186, v187
  v_mfma_f32_32x32x16_bf16 v[144:159], a[36:39], v[208:211], 0
  ds_read_b128 a[8:11], v2 offset:30720
  v_exp_f32 v176, v160
  v_exp_f32 v177, v161
  v_mfma_f32_32x32x16_bf16 v[48:63], a[80:83], v[192:195], v[48:63]
  v_exp_f32 v178, v162
  v_exp_f32 v179, v163
  v_exp_f32 v180, v164
  v_mfma_f32_32x32x16_bf16 v[144:159], a[40:43], v[212:215], v[144:159]
  v_exp_f32 v181, v165
  v_cvt_pk_bf16_f32 v198, v188, v189
  v_cvt_pk_bf16_f32 v199, v190, v191
  v_cvt_pk_bf16_f32 v200, v176, v177
  v_cvt_pk_bf16_f32 v201, v178, v179
  v_mfma_f32_32x32x16_bf16 v[64:79], a[88:91], v[192:195], v[64:79]
  v_exp_f32 v182, v166
  v_exp_f32 v183, v167
  v_exp_f32 v184, v168
  v_mfma_f32_32x32x16_bf16 v[144:159], a[44:47], v[216:219], v[144:159]
  v_exp_f32 v185, v169
  v_exp_f32 v186, v170
  v_cvt_pk_bf16_f32 v202, v180, v181
  v_cvt_pk_bf16_f32 v203, v182, v183
  v_mfma_f32_32x32x16_bf16 v[48:63], a[84:87], v[196:199], v[48:63]
  v_exp_f32 v187, v171
  v_exp_f32 v188, v172
  v_exp_f32 v189, v173
  v_mfma_f32_32x32x16_bf16 v[64:79], a[92:95], v[196:199], v[64:79]
  v_exp_f32 v190, v174
  v_exp_f32 v191, v175
  v_cvt_pk_bf16_f32 v204, v184, v185
  v_cvt_pk_bf16_f32 v205, v186, v187
  v_mfma_f32_32x32x16_bf16 v[160:175], a[36:39], v[220:223], 0
  ds_read_b128 a[4:7], v2 offset:29696
  v_exp_f32 v176, v144
  v_exp_f32 v177, v145
  v_mfma_f32_32x32x16_bf16 v[80:95], a[80:83], v[200:203], v[80:95]
  v_exp_f32 v178, v146
  v_exp_f32 v179, v147
  v_exp_f32 v180, v148
  v_mfma_f32_32x32x16_bf16 v[160:175], a[40:43], v[224:227], v[160:175]
  v_exp_f32 v181, v149
  v_cvt_pk_bf16_f32 v206, v188, v189
  v_cvt_pk_bf16_f32 v207, v190, v191
  v_cvt_pk_bf16_f32 v192, v176, v177
  v_cvt_pk_bf16_f32 v193, v178, v179
  v_mfma_f32_32x32x16_bf16 v[96:111], a[88:91], v[200:203], v[96:111]
  v_exp_f32 v182, v150
  v_exp_f32 v183, v151
  v_exp_f32 v184, v152
  v_mfma_f32_32x32x16_bf16 v[160:175], a[44:47], v[228:231], v[160:175]
  v_exp_f32 v185, v153
  v_exp_f32 v186, v154
  v_cvt_pk_bf16_f32 v194, v180, v181
  v_cvt_pk_bf16_f32 v195, v182, v183
  v_mfma_f32_32x32x16_bf16 v[80:95], a[84:87], v[204:207], v[80:95]
  v_exp_f32 v187, v155
  v_exp_f32 v188, v156
  v_exp_f32 v189, v157
  v_mfma_f32_32x32x16_bf16 v[96:111], a[92:95], v[204:207], v[96:111]
  v_exp_f32 v190, v158
  v_exp_f32 v191, v159
  v_cvt_pk_bf16_f32 v196, v184, v185
  v_cvt_pk_bf16_f32 v197, v186, v187
  v_mfma_f32_32x32x16_bf16 v[144:159], a[36:39], v[232:235], 0
  s_nop 0
  v_exp_f32 v176, v160
  v_exp_f32 v177, v161
  v_exp_f32 v178, v162
  v_mfma_f32_32x32x16_bf16 v[16:31], a[96:99], v[192:195], v[16:31]
  ds_read_b128 a[0:3], v2 offset:28672
  v_exp_f32 v179, v163
  v_exp_f32 v180, v164
  v_cvt_pk_bf16_f32 v200, v176, v177
  v_mfma_f32_32x32x16_bf16 v[144:159], a[40:43], v[236:239], v[144:159]
  ds_read_b128 a[32:35], v4 offset:30720
  v_exp_f32 v181, v165
  v_cvt_pk_bf16_f32 v198, v188, v189
  v_cvt_pk_bf16_f32 v199, v190, v191
  v_cvt_pk_bf16_f32 v201, v178, v179
  v_mfma_f32_32x32x16_bf16 v[32:47], a[104:107], v[192:195], v[32:47]
  v_exp_f32 v182, v166
  v_exp_f32 v183, v167
  v_exp_f32 v184, v168
  v_mfma_f32_32x32x16_bf16 v[144:159], a[44:47], v[240:243], v[144:159]
  v_exp_f32 v185, v169
  v_exp_f32 v186, v170
  v_cvt_pk_bf16_f32 v202, v180, v181
  v_cvt_pk_bf16_f32 v203, v182, v183
  v_mfma_f32_32x32x16_bf16 v[16:31], a[100:103], v[196:199], v[16:31]
  v_exp_f32 v187, v171
  v_exp_f32 v188, v172
  v_exp_f32 v189, v173
  v_mfma_f32_32x32x16_bf16 v[32:47], a[108:111], v[196:199], v[32:47]
  v_exp_f32 v190, v174
  v_exp_f32 v191, v175
  v_cvt_pk_bf16_f32 v204, v184, v185
  v_cvt_pk_bf16_f32 v205, v186, v187
  v_mfma_f32_32x32x16_bf16 v[160:175], a[36:39], v[244:247], 0
  ds_read_b128 a[52:55], v2 offset:32768
  v_exp_f32 v176, v144
  v_exp_f32 v177, v145
  v_cvt_pk_bf16_f32 v206, v188, v189
  v_mfma_f32_32x32x16_bf16 v[48:63], a[96:99], v[200:203], v[48:63]
  ds_read_b128 a[28:31], v4 offset:29696
  v_exp_f32 v178, v146
  v_exp_f32 v179, v147
  v_cvt_pk_bf16_f32 v192, v176, v177
  v_mfma_f32_32x32x16_bf16 v[160:175], a[40:43], v[248:251], v[160:175]
  v_exp_f32 v180, v148
  v_exp_f32 v181, v149
  v_cvt_pk_bf16_f32 v207, v190, v191
  v_cvt_pk_bf16_f32 v193, v178, v179
  v_mfma_f32_32x32x16_bf16 v[64:79], a[104:107], v[200:203], v[64:79]
  v_exp_f32 v182, v150
  v_exp_f32 v183, v151
  v_exp_f32 v184, v152
  v_mfma_f32_32x32x16_bf16 v[160:175], a[44:47], v[252:255], v[160:175]
  v_exp_f32 v185, v153
  v_exp_f32 v186, v154
  v_cvt_pk_bf16_f32 v194, v180, v181
  v_cvt_pk_bf16_f32 v195, v182, v183
  v_mfma_f32_32x32x16_bf16 v[48:63], a[100:103], v[204:207], v[48:63]
  v_exp_f32 v187, v155
  v_exp_f32 v188, v156
  v_exp_f32 v189, v157
  v_mfma_f32_32x32x16_bf16 v[64:79], a[108:111], v[204:207], v[64:79]
  s_waitcnt lgkmcnt(3)
  v_exp_f32 v190, v158
  v_exp_f32 v191, v159
  v_cvt_pk_bf16_f32 v196, v184, v185
  v_cvt_pk_bf16_f32 v197, v186, v187
  v_mfma_f32_32x32x16_bf16 v[144:159], a[0:3], v[208:211], 0
  ds_read_b128 a[48:51], v2 offset:31744
  v_exp_f32 v176, v160
  v_exp_f32 v177, v161
  v_cvt_pk_bf16_f32 v198, v188, v189
  v_mfma_f32_32x32x16_bf16 v[80:95], a[96:99], v[192:195], v[80:95]
  ds_read_b128 a[20:23], v3 offset:30720
  v_exp_f32 v178, v162
  v_exp_f32 v179, v163
  v_cvt_pk_bf16_f32 v200, v176, v177
  v_mfma_f32_32x32x16_bf16 v[144:159], a[4:7], v[212:215], v[144:159]
  v_exp_f32 v180, v164
  v_exp_f32 v181, v165
  v_cvt_pk_bf16_f32 v199, v190, v191
  v_cvt_pk_bf16_f32 v201, v178, v179
  v_mfma_f32_32x32x16_bf16 v[96:111], a[104:107], v[192:195], v[96:111]
  v_exp_f32 v182, v166
  v_exp_f32 v183, v167
  v_exp_f32 v184, v168
  v_mfma_f32_32x32x16_bf16 v[144:159], a[8:11], v[216:219], v[144:159]
  v_exp_f32 v185, v169
  v_exp_f32 v186, v170
  v_cvt_pk_bf16_f32 v202, v180, v181
  v_cvt_pk_bf16_f32 v203, v182, v183
  v_mfma_f32_32x32x16_bf16 v[80:95], a[100:103], v[196:199], v[80:95]
  v_exp_f32 v187, v171
  v_exp_f32 v188, v172
  v_exp_f32 v189, v173
  v_mfma_f32_32x32x16_bf16 v[96:111], a[108:111], v[196:199], v[96:111]
  v_exp_f32 v190, v174
  v_exp_f32 v191, v175
  v_cvt_pk_bf16_f32 v204, v184, v185
  v_cvt_pk_bf16_f32 v205, v186, v187
  v_mfma_f32_32x32x16_bf16 v[160:175], a[0:3], v[220:223], 0
  ds_read_b128 a[12:15], v3 offset:28672
  v_exp_f32 v176, v144
  v_exp_f32 v177, v145
  v_exp_f32 v178, v146
  v_mfma_f32_32x32x16_bf16 v[112:127], a[96:99], v[200:203], v[112:127]
  ds_read_b128 a[16:19], v3 offset:29696
  v_exp_f32 v179, v147
  v_exp_f32 v180, v148
  v_cvt_pk_bf16_f32 v192, v176, v177
  v_mfma_f32_32x32x16_bf16 v[160:175], a[4:7], v[224:227], v[160:175]
  ds_read_b128 a[40:43], v5 offset:29696
  v_exp_f32 v181, v149
  v_cvt_pk_bf16_f32 v206, v188, v189
  v_cvt_pk_bf16_f32 v207, v190, v191
  v_cvt_pk_bf16_f32 v193, v178, v179
  v_mfma_f32_32x32x16_bf16 v[128:143], a[104:107], v[200:203], v[128:143]
  v_exp_f32 v182, v150
  v_exp_f32 v183, v151
  v_exp_f32 v184, v152
  v_mfma_f32_32x32x16_bf16 v[160:175], a[8:11], v[228:231], v[160:175]
  v_exp_f32 v185, v153
  v_exp_f32 v186, v154
  v_cvt_pk_bf16_f32 v194, v180, v181
  v_cvt_pk_bf16_f32 v195, v182, v183
  v_mfma_f32_32x32x16_bf16 v[112:127], a[100:103], v[204:207], v[112:127]
  v_exp_f32 v187, v155
  v_exp_f32 v188, v156
  v_exp_f32 v189, v157
  v_mfma_f32_32x32x16_bf16 v[128:143], a[108:111], v[204:207], v[128:143]
  v_exp_f32 v190, v158
  v_exp_f32 v191, v159
  v_cvt_pk_bf16_f32 v196, v184, v185
  v_cvt_pk_bf16_f32 v197, v186, v187
  v_mfma_f32_32x32x16_bf16 v[144:159], a[0:3], v[232:235], 0
  s_waitcnt lgkmcnt(4)
  v_exp_f32 v176, v160
  v_exp_f32 v177, v161
  v_exp_f32 v178, v162
  v_mfma_f32_32x32x16_bf16 v[16:31], a[48:51], v[192:195], v[16:31]
  ds_read_b128 a[68:71], v3 offset:32768
  v_exp_f32 v179, v163
  v_exp_f32 v180, v164
  v_cvt_pk_bf16_f32 v200, v176, v177
  v_mfma_f32_32x32x16_bf16 v[144:159], a[4:7], v[236:239], v[144:159]
  ds_read_b128 a[76:79], v3 offset:34816
  v_exp_f32 v181, v165
  v_cvt_pk_bf16_f32 v198, v188, v189
  v_cvt_pk_bf16_f32 v199, v190, v191
  v_cvt_pk_bf16_f32 v201, v178, v179
  v_mfma_f32_32x32x16_bf16 v[32:47], a[56:59], v[192:195], v[32:47]
  ds_read_b128 a[36:39], v5 offset:28672
  v_exp_f32 v182, v166
  v_exp_f32 v183, v167
  v_cvt_pk_bf16_f32 v202, v180, v181
  v_mfma_f32_32x32x16_bf16 v[144:159], a[8:11], v[240:243], v[144:159]
  v_exp_f32 v184, v168
  v_exp_f32 v185, v169
  v_exp_f32 v186, v170
  v_mfma_f32_32x32x16_bf16 v[16:31], a[52:55], v[196:199], v[16:31]
  v_exp_f32 v187, v171
  v_exp_f32 v188, v172
  v_cvt_pk_bf16_f32 v203, v182, v183
  v_cvt_pk_bf16_f32 v204, v184, v185
  v_mfma_f32_32x32x16_bf16 v[32:47], a[60:63], v[196:199], v[32:47]
  s_waitcnt lgkmcnt(4)
  v_exp_f32 v189, v173
  v_exp_f32 v190, v174
  v_exp_f32 v191, v175
  v_cvt_pk_bf16_f32 v205, v186, v187
  v_mfma_f32_32x32x16_bf16 v[160:175], a[12:15], v[208:211], 0
  ds_read_b128 a[64:67], v3 offset:31744
  v_exp_f32 v176, v144
  v_exp_f32 v177, v145
  v_exp_f32 v178, v146
  v_mfma_f32_32x32x16_bf16 v[48:63], a[48:51], v[200:203], v[48:63]
  ds_read_b128 a[72:75], v3 offset:33792
  v_exp_f32 v179, v147
  v_exp_f32 v180, v148
  v_cvt_pk_bf16_f32 v192, v176, v177
  v_mfma_f32_32x32x16_bf16 v[160:175], a[16:19], v[212:215], v[160:175]
  ds_read_b128 a[108:111], v5 offset:34816
  v_exp_f32 v181, v149
  v_cvt_pk_bf16_f32 v206, v188, v189
  v_cvt_pk_bf16_f32 v207, v190, v191
  v_cvt_pk_bf16_f32 v193, v178, v179
  v_mfma_f32_32x32x16_bf16 v[64:79], a[56:59], v[200:203], v[64:79]
  v_exp_f32 v182, v150
  v_exp_f32 v183, v151
  v_exp_f32 v184, v152
  v_mfma_f32_32x32x16_bf16 v[160:175], a[20:23], v[216:219], v[160:175]
  v_exp_f32 v185, v153
  v_exp_f32 v186, v154
  v_cvt_pk_bf16_f32 v194, v180, v181
  v_cvt_pk_bf16_f32 v195, v182, v183
  v_mfma_f32_32x32x16_bf16 v[48:63], a[52:55], v[204:207], v[48:63]
  v_exp_f32 v187, v155
  v_exp_f32 v188, v156
  v_exp_f32 v189, v157
  v_mfma_f32_32x32x16_bf16 v[64:79], a[60:63], v[204:207], v[64:79]
  v_exp_f32 v190, v158
  v_exp_f32 v191, v159
  v_cvt_pk_bf16_f32 v196, v184, v185
  v_cvt_pk_bf16_f32 v197, v186, v187
  v_mfma_f32_32x32x16_bf16 v[144:159], a[12:15], v[220:223], 0
  ds_read_b128 a[24:27], v4 offset:28672
  v_exp_f32 v176, v160
  v_exp_f32 v177, v161
  v_exp_f32 v178, v162
  v_mfma_f32_32x32x16_bf16 v[80:95], a[48:51], v[192:195], v[80:95]
  ds_read_b128 a[84:87], v4 offset:32768
  v_exp_f32 v179, v163
  v_exp_f32 v180, v164
  v_cvt_pk_bf16_f32 v200, v176, v177
  v_mfma_f32_32x32x16_bf16 v[144:159], a[16:19], v[224:227], v[144:159]
  ds_read_b128 a[104:107], v5 offset:33792
  v_exp_f32 v181, v165
  v_cvt_pk_bf16_f32 v198, v188, v189
  v_cvt_pk_bf16_f32 v199, v190, v191
  v_cvt_pk_bf16_f32 v201, v178, v179
  v_mfma_f32_32x32x16_bf16 v[96:111], a[56:59], v[192:195], v[96:111]
  v_exp_f32 v182, v166
  v_exp_f32 v183, v167
  v_exp_f32 v184, v168
  v_mfma_f32_32x32x16_bf16 v[144:159], a[20:23], v[228:231], v[144:159]
  v_exp_f32 v185, v169
  v_exp_f32 v186, v170
  v_cvt_pk_bf16_f32 v202, v180, v181
  v_cvt_pk_bf16_f32 v203, v182, v183
  v_mfma_f32_32x32x16_bf16 v[80:95], a[52:55], v[196:199], v[80:95]
  v_exp_f32 v187, v171
  v_exp_f32 v188, v172
  v_exp_f32 v189, v173
  v_mfma_f32_32x32x16_bf16 v[96:111], a[60:63], v[196:199], v[96:111]
  v_exp_f32 v190, v174
  v_exp_f32 v191, v175
  v_cvt_pk_bf16_f32 v204, v184, v185
  v_cvt_pk_bf16_f32 v205, v186, v187
  v_mfma_f32_32x32x16_bf16 v[160:175], a[12:15], v[232:235], 0
  s_waitcnt lgkmcnt(4)
  v_exp_f32 v176, v144
  v_exp_f32 v177, v145
  v_exp_f32 v178, v146
  v_mfma_f32_32x32x16_bf16 v[16:31], a[64:67], v[200:203], v[16:31]
  ds_read_b128 a[80:83], v4 offset:31744
  v_exp_f32 v179, v147
  v_exp_f32 v180, v148
  v_cvt_pk_bf16_f32 v192, v176, v177
  v_mfma_f32_32x32x16_bf16 v[160:175], a[16:19], v[236:239], v[160:175]
  ds_read_b128 a[92:95], v4 offset:34816
  v_exp_f32 v181, v149
  v_cvt_pk_bf16_f32 v206, v188, v189
  v_cvt_pk_bf16_f32 v207, v190, v191
  v_cvt_pk_bf16_f32 v193, v178, v179
  v_mfma_f32_32x32x16_bf16 v[32:47], a[72:75], v[200:203], v[32:47]
  s_mul_i32 s36, s33, 7
  v_lshrrev_b32 v13, 4, v1
  v_min_u32 v13, 6, v13
  v_add_u32 v13, s36, v13
  v_lshlrev_b32 v13, 2, v13
  s_lshl_b32 s38, s35, 1
  s_mul_i32 s39, s38, 47
  s_lshr_b32 s39, s39, 9
  s_max_u32 s38, s38, 1
  s_sub_u32 s38, s38, 1
  s_mul_i32 s38, s38, 47
  s_lshr_b32 s38, s38, 9
  s_lshl_b32 s38, 8, s38
  s_lshl_b32 s39, 8, s39
  s_or_b32 s38, s38, s39
  global_load_dword v12, v13, s[44:45] sc1
  v_mfma_f32_32x32x16_bf16 v[160:175], a[20:23], v[240:243], v[160:175]
  ds_read_b128 a[100:103], v5 offset:32768
  v_exp_f32 v182, v150
  v_exp_f32 v183, v151
  v_cvt_pk_bf16_f32 v194, v180, v181
  v_mfma_f32_32x32x16_bf16 v[16:31], a[68:71], v[204:207], v[16:31]
  v_exp_f32 v184, v152
  v_exp_f32 v185, v153
  v_exp_f32 v186, v154
  v_exp_f32 v187, v155
  v_mfma_f32_32x32x16_bf16 v[32:47], a[76:79], v[204:207], v[32:47]
  v_exp_f32 v188, v156
  v_exp_f32 v189, v157
  v_exp_f32 v190, v158
  v_exp_f32 v191, v159
  v_cvt_pk_bf16_f32 v195, v182, v183
  v_cvt_pk_bf16_f32 v196, v184, v185
  v_cvt_pk_bf16_f32 v197, v186, v187
  v_mfma_f32_32x32x16_bf16 v[144:159], a[12:15], v[244:247], 0
  ds_read_b128 a[88:91], v4 offset:33792
  v_exp_f32 v176, v160
  v_exp_f32 v177, v161
  v_exp_f32 v178, v162
  v_mfma_f32_32x32x16_bf16 v[48:63], a[64:67], v[192:195], v[48:63]
  ds_read_b128 a[44:47], v5 offset:30720
  v_exp_f32 v179, v163
  v_exp_f32 v180, v164
  v_cvt_pk_bf16_f32 v200, v176, v177
  v_mfma_f32_32x32x16_bf16 v[144:159], a[16:19], v[248:251], v[144:159]
  ds_read_b128 a[96:99], v5 offset:31744
  v_exp_f32 v181, v165
  v_cvt_pk_bf16_f32 v198, v188, v189
  v_cvt_pk_bf16_f32 v199, v190, v191
  v_cvt_pk_bf16_f32 v201, v178, v179
  v_mfma_f32_32x32x16_bf16 v[64:79], a[72:75], v[192:195], v[64:79]
  v_exp_f32 v182, v166
  v_exp_f32 v183, v167
  v_exp_f32 v184, v168
  v_mfma_f32_32x32x16_bf16 v[144:159], a[20:23], v[252:255], v[144:159]
  v_exp_f32 v185, v169
  v_exp_f32 v186, v170
  v_cvt_pk_bf16_f32 v202, v180, v181
  v_cvt_pk_bf16_f32 v203, v182, v183
  v_mfma_f32_32x32x16_bf16 v[48:63], a[68:71], v[196:199], v[48:63]
  v_exp_f32 v187, v171
  v_exp_f32 v188, v172
  v_exp_f32 v189, v173
  v_mfma_f32_32x32x16_bf16 v[64:79], a[76:79], v[196:199], v[64:79]
  s_waitcnt lgkmcnt(8)
  v_exp_f32 v190, v174
  v_exp_f32 v191, v175
  v_cvt_pk_bf16_f32 v204, v184, v185
  v_cvt_pk_bf16_f32 v205, v186, v187
  v_mfma_f32_32x32x16_bf16 v[160:175], a[24:27], v[208:211], 0
  v_exp_f32 v176, v144
  v_exp_f32 v177, v145
  v_mfma_f32_32x32x16_bf16 v[80:95], a[64:67], v[200:203], v[80:95]
  v_exp_f32 v178, v146
  v_exp_f32 v179, v147
  v_exp_f32 v180, v148
  v_mfma_f32_32x32x16_bf16 v[160:175], a[28:31], v[212:215], v[160:175]
  v_exp_f32 v181, v149
  v_cvt_pk_bf16_f32 v206, v188, v189
  v_cvt_pk_bf16_f32 v207, v190, v191
  v_cvt_pk_bf16_f32 v192, v176, v177
  v_cvt_pk_bf16_f32 v193, v178, v179
  v_mfma_f32_32x32x16_bf16 v[96:111], a[72:75], v[200:203], v[96:111]
  v_exp_f32 v182, v150
  v_exp_f32 v183, v151
  v_exp_f32 v184, v152
  v_mfma_f32_32x32x16_bf16 v[160:175], a[32:35], v[216:219], v[160:175]
  v_exp_f32 v185, v153
  v_exp_f32 v186, v154
  v_cvt_pk_bf16_f32 v194, v180, v181
  v_cvt_pk_bf16_f32 v195, v182, v183
  v_mfma_f32_32x32x16_bf16 v[80:95], a[68:71], v[204:207], v[80:95]
  v_exp_f32 v187, v155
  v_exp_f32 v188, v156
  v_exp_f32 v189, v157
  v_mfma_f32_32x32x16_bf16 v[96:111], a[76:79], v[204:207], v[96:111]
  v_exp_f32 v190, v158
  v_exp_f32 v191, v159
  v_cvt_pk_bf16_f32 v196, v184, v185
  v_cvt_pk_bf16_f32 v197, v186, v187
  v_mfma_f32_32x32x16_bf16 v[144:159], a[24:27], v[220:223], 0
  v_exp_f32 v176, v160
  v_exp_f32 v177, v161
  v_mfma_f32_32x32x16_bf16 v[112:127], a[64:67], v[192:195], v[112:127]
  v_exp_f32 v178, v162
  v_exp_f32 v179, v163
  v_exp_f32 v180, v164
  v_mfma_f32_32x32x16_bf16 v[144:159], a[28:31], v[224:227], v[144:159]
  v_exp_f32 v181, v165
  v_cvt_pk_bf16_f32 v198, v188, v189
  v_cvt_pk_bf16_f32 v199, v190, v191
  v_cvt_pk_bf16_f32 v200, v176, v177
  v_cvt_pk_bf16_f32 v201, v178, v179
  v_mfma_f32_32x32x16_bf16 v[128:143], a[72:75], v[192:195], v[128:143]
  v_exp_f32 v182, v166
  v_exp_f32 v183, v167
  v_exp_f32 v184, v168
  v_mfma_f32_32x32x16_bf16 v[144:159], a[32:35], v[228:231], v[144:159]
  v_exp_f32 v185, v169
  v_exp_f32 v186, v170
  v_cvt_pk_bf16_f32 v202, v180, v181
  v_cvt_pk_bf16_f32 v203, v182, v183
  v_mfma_f32_32x32x16_bf16 v[112:127], a[68:71], v[196:199], v[112:127]
  v_exp_f32 v187, v171
  v_exp_f32 v188, v172
  v_exp_f32 v189, v173
  v_mfma_f32_32x32x16_bf16 v[128:143], a[76:79], v[196:199], v[128:143]
  v_exp_f32 v190, v174
  v_exp_f32 v191, v175
  v_cvt_pk_bf16_f32 v204, v184, v185
  v_cvt_pk_bf16_f32 v205, v186, v187
  v_mfma_f32_32x32x16_bf16 v[160:175], a[24:27], v[232:235], 0
  s_waitcnt lgkmcnt(2)
  v_exp_f32 v176, v144
  v_exp_f32 v177, v145
  v_exp_f32 v178, v146
  v_mfma_f32_32x32x16_bf16 v[16:31], a[80:83], v[200:203], v[16:31]
  v_exp_f32 v179, v147
  v_exp_f32 v180, v148
  v_exp_f32 v181, v149
  v_mfma_f32_32x32x16_bf16 v[160:175], a[28:31], v[236:239], v[160:175]
  s_waitcnt vmcnt(0)
  v_and_b32 v12, s38, v12
  v_cmp_ne_u32 vcc, s38, v12
  s_nop 3
  s_cmp_eq_u64 vcc, 0
  s_cselect_b32 s14, 31457280, 0
  v_cvt_pk_bf16_f32 v206, v188, v189
  v_cvt_pk_bf16_f32 v207, v190, v191
  v_mfma_f32_32x32x16_bf16 v[32:47], a[88:91], v[200:203], v[32:47]
  v_exp_f32 v182, v150
  v_exp_f32 v183, v151
  v_cvt_pk_bf16_f32 v192, v176, v177
  v_cvt_pk_bf16_f32 v193, v178, v179
  v_mfma_f32_32x32x16_bf16 v[160:175], a[32:35], v[240:243], v[160:175]
  v_exp_f32 v184, v152
  v_exp_f32 v185, v153
  v_cvt_pk_bf16_f32 v194, v180, v181
  v_cvt_pk_bf16_f32 v195, v182, v183
  v_mfma_f32_32x32x16_bf16 v[16:31], a[84:87], v[204:207], v[16:31]
  v_exp_f32 v186, v154
  v_exp_f32 v187, v155
  v_exp_f32 v188, v156
  v_mfma_f32_32x32x16_bf16 v[32:47], a[92:95], v[204:207], v[32:47]
  s_waitcnt lgkmcnt(1)
  v_exp_f32 v189, v157
  v_exp_f32 v190, v158
  v_exp_f32 v191, v159
  v_cvt_pk_bf16_f32 v196, v184, v185
  v_cvt_pk_bf16_f32 v197, v186, v187
  v_mfma_f32_32x32x16_bf16 v[144:159], a[36:39], v[208:211], 0
  buffer_load_dwordx4 a[184:187], v1, s[12:15], s88 offen offset:0 sc1
  v_exp_f32 v176, v160
  v_exp_f32 v177, v161
  v_mfma_f32_32x32x16_bf16 v[48:63], a[80:83], v[192:195], v[48:63]
  buffer_load_dwordx4 a[188:191], v1, s[12:15], s88 offen offset:1024 sc1
  v_exp_f32 v178, v162
  v_exp_f32 v179, v163
  v_mfma_f32_32x32x16_bf16 v[144:159], a[40:43], v[212:215], v[144:159]
  buffer_load_dwordx4 a[192:195], v1, s[12:15], s88 offen offset:2048 sc1
  v_cvt_pk_bf16_f32 v198, v188, v189
  v_cvt_pk_bf16_f32 v199, v190, v191
  v_cvt_pk_bf16_f32 v200, v176, v177
  v_cvt_pk_bf16_f32 v201, v178, v179
  v_mfma_f32_32x32x16_bf16 v[64:79], a[88:91], v[192:195], v[64:79]
  buffer_load_dwordx4 a[196:199], v1, s[12:15], s89 offen offset:0 sc1
  v_exp_f32 v180, v164
  v_exp_f32 v181, v165
  v_mfma_f32_32x32x16_bf16 v[144:159], a[44:47], v[216:219], v[144:159]
  buffer_load_dwordx4 a[200:203], v1, s[12:15], s89 offen offset:1024 sc1
  v_exp_f32 v182, v166
  v_exp_f32 v183, v167
  v_mfma_f32_32x32x16_bf16 v[48:63], a[84:87], v[196:199], v[48:63]
  buffer_load_dwordx4 a[204:207], v1, s[12:15], s89 offen offset:2048 sc1
  v_exp_f32 v184, v168
  v_exp_f32 v185, v169
  v_exp_f32 v186, v170
  v_exp_f32 v187, v171
  v_mfma_f32_32x32x16_bf16 v[64:79], a[92:95], v[196:199], v[64:79]
  buffer_load_dwordx4 a[208:211], v1, s[12:15], s90 offen offset:0 sc1
  v_exp_f32 v188, v172
  v_exp_f32 v189, v173
  v_exp_f32 v190, v174
  v_exp_f32 v191, v175
  v_cvt_pk_bf16_f32 v202, v180, v181
  v_cvt_pk_bf16_f32 v203, v182, v183
  v_cvt_pk_bf16_f32 v204, v184, v185
  v_cvt_pk_bf16_f32 v205, v186, v187
  v_mfma_f32_32x32x16_bf16 v[160:175], a[36:39], v[220:223], 0
  buffer_load_dwordx4 a[212:215], v1, s[12:15], s90 offen offset:1024 sc1
  v_exp_f32 v176, v144
  v_exp_f32 v177, v145
  v_mfma_f32_32x32x16_bf16 v[80:95], a[80:83], v[200:203], v[80:95]
  buffer_load_dwordx4 a[216:219], v1, s[12:15], s90 offen offset:2048 sc1
  v_exp_f32 v178, v146
  v_exp_f32 v179, v147
  v_mfma_f32_32x32x16_bf16 v[160:175], a[40:43], v[224:227], v[160:175]
  buffer_load_dwordx4 a[220:223], v1, s[12:15], s91 offen offset:0 sc1
  v_cvt_pk_bf16_f32 v206, v188, v189
  v_cvt_pk_bf16_f32 v207, v190, v191
  v_cvt_pk_bf16_f32 v192, v176, v177
  v_cvt_pk_bf16_f32 v193, v178, v179
  v_mfma_f32_32x32x16_bf16 v[96:111], a[88:91], v[200:203], v[96:111]
  buffer_load_dwordx4 a[224:227], v1, s[12:15], s91 offen offset:1024 sc1
  v_exp_f32 v180, v148
  v_exp_f32 v181, v149
  v_mfma_f32_32x32x16_bf16 v[160:175], a[44:47], v[228:231], v[160:175]
  buffer_load_dwordx4 a[228:231], v1, s[12:15], s91 offen offset:2048 sc1
  v_exp_f32 v182, v150
  v_exp_f32 v183, v151
  v_mfma_f32_32x32x16_bf16 v[80:95], a[84:87], v[204:207], v[80:95]
  v_exp_f32 v184, v152
  v_exp_f32 v185, v153
  v_exp_f32 v186, v154
  v_exp_f32 v187, v155
  v_mfma_f32_32x32x16_bf16 v[96:111], a[92:95], v[204:207], v[96:111]
  v_exp_f32 v188, v156
  v_exp_f32 v189, v157
  v_exp_f32 v190, v158
  v_exp_f32 v191, v159
  v_cvt_pk_bf16_f32 v194, v180, v181
  v_cvt_pk_bf16_f32 v195, v182, v183
  v_cvt_pk_bf16_f32 v196, v184, v185
  v_cvt_pk_bf16_f32 v197, v186, v187
  v_mfma_f32_32x32x16_bf16 v[144:159], a[36:39], v[232:235], 0
  s_waitcnt lgkmcnt(0)
  v_exp_f32 v176, v160
  v_exp_f32 v177, v161
  v_mfma_f32_32x32x16_bf16 v[16:31], a[96:99], v[192:195], v[16:31]
  v_exp_f32 v178, v162
  v_exp_f32 v179, v163
  v_exp_f32 v180, v164
  v_mfma_f32_32x32x16_bf16 v[144:159], a[40:43], v[236:239], v[144:159]
  v_exp_f32 v181, v165
  v_cvt_pk_bf16_f32 v198, v188, v189
  v_cvt_pk_bf16_f32 v199, v190, v191
  v_cvt_pk_bf16_f32 v200, v176, v177
  v_cvt_pk_bf16_f32 v201, v178, v179
  v_mfma_f32_32x32x16_bf16 v[32:47], a[104:107], v[192:195], v[32:47]
  v_exp_f32 v182, v166
  v_exp_f32 v183, v167
  v_exp_f32 v184, v168
  v_mfma_f32_32x32x16_bf16 v[144:159], a[44:47], v[240:243], v[144:159]
  v_exp_f32 v185, v169
  v_exp_f32 v186, v170
  v_cvt_pk_bf16_f32 v202, v180, v181
  v_cvt_pk_bf16_f32 v203, v182, v183
  v_mfma_f32_32x32x16_bf16 v[16:31], a[100:103], v[196:199], v[16:31]
  v_exp_f32 v187, v171
  v_exp_f32 v188, v172
  v_exp_f32 v189, v173
  v_mfma_f32_32x32x16_bf16 v[32:47], a[108:111], v[196:199], v[32:47]
  v_exp_f32 v190, v174
  v_exp_f32 v191, v175
  v_cvt_pk_bf16_f32 v204, v184, v185
  v_cvt_pk_bf16_f32 v205, v186, v187
  v_mfma_f32_32x32x16_bf16 v[160:175], a[36:39], v[244:247], 0
  v_exp_f32 v176, v144
  v_exp_f32 v177, v145
  v_mfma_f32_32x32x16_bf16 v[48:63], a[96:99], v[200:203], v[48:63]
  v_exp_f32 v178, v146
  v_exp_f32 v179, v147
  v_exp_f32 v180, v148
  v_mfma_f32_32x32x16_bf16 v[160:175], a[40:43], v[248:251], v[160:175]
  v_exp_f32 v181, v149
  v_cvt_pk_bf16_f32 v206, v188, v189
  v_cvt_pk_bf16_f32 v207, v190, v191
  v_cvt_pk_bf16_f32 v192, v176, v177
  v_cvt_pk_bf16_f32 v193, v178, v179
  v_mfma_f32_32x32x16_bf16 v[64:79], a[104:107], v[200:203], v[64:79]
  v_exp_f32 v182, v150
  v_exp_f32 v183, v151
  v_exp_f32 v184, v152
  v_mfma_f32_32x32x16_bf16 v[160:175], a[44:47], v[252:255], v[160:175]
  v_exp_f32 v185, v153
  v_exp_f32 v186, v154
  v_cvt_pk_bf16_f32 v194, v180, v181
  v_cvt_pk_bf16_f32 v195, v182, v183
  v_mfma_f32_32x32x16_bf16 v[48:63], a[100:103], v[204:207], v[48:63]
  v_exp_f32 v187, v155
  v_exp_f32 v188, v156
  v_exp_f32 v189, v157
  v_mfma_f32_32x32x16_bf16 v[64:79], a[108:111], v[204:207], v[64:79]
  v_exp_f32 v190, v158
  v_exp_f32 v191, v159
  v_cvt_pk_bf16_f32 v196, v184, v185
  v_cvt_pk_bf16_f32 v197, v186, v187
  v_exp_f32 v176, v160
  v_exp_f32 v177, v161
  v_mfma_f32_32x32x16_bf16 v[80:95], a[96:99], v[192:195], v[80:95]
  v_exp_f32 v178, v162
  v_exp_f32 v179, v163
  v_exp_f32 v180, v164
  v_exp_f32 v181, v165
  v_cvt_pk_bf16_f32 v198, v188, v189
  v_cvt_pk_bf16_f32 v199, v190, v191
  v_cvt_pk_bf16_f32 v200, v176, v177
  v_cvt_pk_bf16_f32 v201, v178, v179
  v_mfma_f32_32x32x16_bf16 v[96:111], a[104:107], v[192:195], v[96:111]
  v_exp_f32 v182, v166
  v_exp_f32 v183, v167
  v_exp_f32 v184, v168
  v_exp_f32 v185, v169
  v_exp_f32 v186, v170
  v_cvt_pk_bf16_f32 v202, v180, v181
  v_cvt_pk_bf16_f32 v203, v182, v183
  v_mfma_f32_32x32x16_bf16 v[80:95], a[100:103], v[196:199], v[80:95]
  v_exp_f32 v187, v171
  v_exp_f32 v188, v172
  v_exp_f32 v189, v173
  v_mfma_f32_32x32x16_bf16 v[96:111], a[108:111], v[196:199], v[96:111]
  v_exp_f32 v190, v174
  v_exp_f32 v191, v175
  v_cvt_pk_bf16_f32 v204, v184, v185
  v_cvt_pk_bf16_f32 v205, v186, v187
  v_cvt_pk_bf16_f32 v206, v188, v189
  v_cvt_pk_bf16_f32 v207, v190, v191
  s_nop 1
  v_mfma_f32_32x32x16_bf16 v[112:127], a[96:99], v[200:203], v[112:127]
  v_mfma_f32_32x32x16_bf16 v[128:143], a[104:107], v[200:203], v[128:143]
  v_mfma_f32_32x32x16_bf16 v[112:127], a[100:103], v[204:207], v[112:127]
  v_mfma_f32_32x32x16_bf16 v[128:143], a[108:111], v[204:207], v[128:143]
  s_branch L_epiH
L_startW:
  ds_read_b128 a[0:3], v2 offset:0
  ds_read_b128 a[4:7], v2 offset:1024
  ds_read_b128 a[8:11], v2 offset:2048
  ds_read_b128 a[12:15], v3 offset:0
  ds_read_b128 a[68:71], v3 offset:4096
  ds_read_b128 a[60:63], v2 offset:6144
  ds_read_b128 a[24:27], v4 offset:0
  s_waitcnt lgkmcnt(4)
  v_mfma_f32_32x32x16_bf16 v[144:159], a[0:3], v[208:211], 0
  ds_read_b128 a[56:59], v2 offset:5120
  ds_read_b128 a[72:75], v3 offset:5120
  ds_read_b128 a[16:19], v3 offset:1024
  ds_read_b128 a[20:23], v3 offset:2048
  v_mfma_f32_32x32x16_bf16 v[144:159], a[4:7], v[212:215], v[144:159]
  ds_read_b128 a[48:51], v2 offset:3072
  ds_read_b128 a[52:55], v2 offset:4096
  v_mfma_f32_32x32x16_bf16 v[144:159], a[8:11], v[216:219], v[144:159]
  s_waitcnt lgkmcnt(0)
  s_nop 7
  s_nop 3
  v_mfma_f32_32x32x16_bf16 v[160:175], a[0:3], v[220:223], 0
  ds_read_b128 a[64:67], v3 offset:3072
  v_exp_f32 v176, v144
  v_exp_f32 v177, v145
  v_exp_f32 v178, v146
  ds_read_b128 a[84:87], v4 offset:4096
  v_exp_f32 v179, v147
  v_exp_f32 v180, v148
  v_cvt_pk_bf16_f32 v192, v176, v177
  v_mfma_f32_32x32x16_bf16 v[160:175], a[4:7], v[224:227], v[160:175]
  ds_read_b128 a[92:95], v4 offset:6144
  v_exp_f32 v181, v149
  v_cvt_pk_bf16_f32 v206, v188, v189
  v_cvt_pk_bf16_f32 v207, v190, v191
  v_cvt_pk_bf16_f32 v193, v178, v179
  ds_read_b128 a[44:47], v5 offset:2048
  v_exp_f32 v182, v150
  v_exp_f32 v183, v151
  v_cvt_pk_bf16_f32 v194, v180, v181
  v_mfma_f32_32x32x16_bf16 v[160:175], a[8:11], v[228:231], v[160:175]
  v_exp_f32 v184, v152
  v_exp_f32 v185, v153
  v_exp_f32 v186, v154
  v_exp_f32 v187, v155
  v_exp_f32 v188, v156
  v_cvt_pk_bf16_f32 v195, v182, v183
  v_cvt_pk_bf16_f32 v196, v184, v185
  s_nop 0
  v_exp_f32 v189, v157
  v_exp_f32 v190, v158
  v_exp_f32 v191, v159
  v_cvt_pk_bf16_f32 v197, v186, v187
  v_mfma_f32_32x32x16_bf16 v[144:159], a[12:15], v[208:211], 0
  s_nop 0
  v_exp_f32 v176, v160
  v_exp_f32 v177, v161
  v_exp_f32 v178, v162
  v_mfma_f32_32x32x16_bf16 v[16:31], a[48:51], v[192:195], 0
  ds_read_b128 a[76:79], v3 offset:6144
  v_exp_f32 v179, v163
  v_exp_f32 v180, v164
  v_cvt_pk_bf16_f32 v200, v176, v177
  v_mfma_f32_32x32x16_bf16 v[144:159], a[16:19], v[212:215], v[144:159]
  ds_read_b128 a[28:31], v4 offset:1024
  v_exp_f32 v181, v165
  v_cvt_pk_bf16_f32 v198, v188, v189
  v_cvt_pk_bf16_f32 v199, v190, v191
  v_cvt_pk_bf16_f32 v201, v178, v179
  v_mfma_f32_32x32x16_bf16 v[32:47], a[56:59], v[192:195], 0
  ds_read_b128 a[40:43], v5 offset:1024
  v_exp_f32 v182, v166
  v_exp_f32 v183, v167
  v_cvt_pk_bf16_f32 v202, v180, v181
  v_mfma_f32_32x32x16_bf16 v[144:159], a[20:23], v[216:219], v[144:159]
  ds_read_b128 a[96:99], v5 offset:3072
  v_exp_f32 v184, v168
  v_exp_f32 v185, v169
  v_cvt_pk_bf16_f32 v203, v182, v183
  v_mfma_f32_32x32x16_bf16 v[16:31], a[52:55], v[196:199], v[16:31]
  v_exp_f32 v186, v170
  v_exp_f32 v187, v171
  v_exp_f32 v188, v172
  v_mfma_f32_32x32x16_bf16 v[32:47], a[60:63], v[196:199], v[32:47]
  v_exp_f32 v189, v173
  v_exp_f32 v190, v174
  v_exp_f32 v191, v175
  v_cvt_pk_bf16_f32 v204, v184, v185
  v_cvt_pk_bf16_f32 v205, v186, v187
  v_mfma_f32_32x32x16_bf16 v[160:175], a[12:15], v[220:223], 0
  ds_read_b128 a[32:35], v4 offset:2048
  v_exp_f32 v176, v144
  v_exp_f32 v177, v145
  v_exp_f32 v178, v146
  v_mfma_f32_32x32x16_bf16 v[48:63], a[48:51], v[200:203], 0
  ds_read_b128 a[88:91], v4 offset:5120
  v_exp_f32 v179, v147
  v_exp_f32 v180, v148
  v_cvt_pk_bf16_f32 v192, v176, v177
  v_mfma_f32_32x32x16_bf16 v[160:175], a[16:19], v[224:227], v[160:175]
  ds_read_b128 a[36:39], v5 offset:0
  v_exp_f32 v181, v149
  v_cvt_pk_bf16_f32 v206, v188, v189
  v_cvt_pk_bf16_f32 v207, v190, v191
  v_cvt_pk_bf16_f32 v193, v178, v179
  v_mfma_f32_32x32x16_bf16 v[64:79], a[56:59], v[200:203], 0
  ds_read_b128 a[108:111], v5 offset:6144
  v_exp_f32 v182, v150
  v_exp_f32 v183, v151
  v_cvt_pk_bf16_f32 v194, v180, v181
  v_mfma_f32_32x32x16_bf16 v[160:175], a[20:23], v[228:231], v[160:175]
  v_exp_f32 v184, v152
  v_exp_f32 v185, v153
  v_exp_f32 v186, v154
  v_mfma_f32_32x32x16_bf16 v[48:63], a[52:55], v[204:207], v[48:63]
  v_exp_f32 v187, v155
  v_exp_f32 v188, v156
  v_cvt_pk_bf16_f32 v195, v182, v183
  v_cvt_pk_bf16_f32 v196, v184, v185
  v_mfma_f32_32x32x16_bf16 v[64:79], a[60:63], v[204:207], v[64:79]
  v_exp_f32 v189, v157
  v_exp_f32 v190, v158
  v_exp_f32 v191, v159
  v_cvt_pk_bf16_f32 v197, v186, v187
  v_mfma_f32_32x32x16_bf16 v[144:159], a[12:15], v[232:235], 0
  s_waitcnt lgkmcnt(7)
  v_exp_f32 v176, v160
  v_exp_f32 v177, v161
  v_exp_f32 v178, v162
  v_mfma_f32_32x32x16_bf16 v[16:31], a[64:67], v[192:195], v[16:31]
  ds_read_b128 a[80:83], v4 offset:3072
  v_exp_f32 v179, v163
  v_exp_f32 v180, v164
  v_cvt_pk_bf16_f32 v200, v176, v177
  v_mfma_f32_32x32x16_bf16 v[144:159], a[16:19], v[236:239], v[144:159]
  ds_read_b128 a[100:103], v5 offset:4096
  v_exp_f32 v181, v165
  v_cvt_pk_bf16_f32 v198, v188, v189
  v_cvt_pk_bf16_f32 v199, v190, v191
  v_cvt_pk_bf16_f32 v201, v178, v179
  v_mfma_f32_32x32x16_bf16 v[32:47], a[72:75], v[192:195], v[32:47]
  ds_read_b128 a[104:107], v5 offset:5120
  v_exp_f32 v182, v166
  v_exp_f32 v183, v167
  v_cvt_pk_bf16_f32 v202, v180, v181
  v_mfma_f32_32x32x16_bf16 v[144:159], a[20:23], v[240:243], v[144:159]
  v_exp_f32 v184, v168
  v_exp_f32 v185, v169
  v_exp_f32 v186, v170
  v_mfma_f32_32x32x16_bf16 v[16:31], a[68:71], v[196:199], v[16:31]
  v_exp_f32 v187, v171
  v_exp_f32 v188, v172
  v_cvt_pk_bf16_f32 v203, v182, v183
  v_cvt_pk_bf16_f32 v204, v184, v185
  v_mfma_f32_32x32x16_bf16 v[32:47], a[76:79], v[196:199], v[32:47]
  s_waitcnt lgkmcnt(6)
  v_exp_f32 v189, v173
  v_exp_f32 v190, v174
  v_exp_f32 v191, v175
  v_cvt_pk_bf16_f32 v205, v186, v187
  v_mfma_f32_32x32x16_bf16 v[160:175], a[24:27], v[208:211], 0
  v_exp_f32 v176, v144
  v_exp_f32 v177, v145
  v_mfma_f32_32x32x16_bf16 v[48:63], a[64:67], v[200:203], v[48:63]
  v_exp_f32 v178, v146
  v_exp_f32 v179, v147
  v_exp_f32 v180, v148
  v_mfma_f32_32x32x16_bf16 v[160:175], a[28:31], v[212:215], v[160:175]
  v_exp_f32 v181, v149
  v_cvt_pk_bf16_f32 v206, v188, v189
  v_cvt_pk_bf16_f32 v207, v190, v191
  v_cvt_pk_bf16_f32 v192, v176, v177
  v_cvt_pk_bf16_f32 v193, v178, v179
  v_mfma_f32_32x32x16_bf16 v[64:79], a[72:75], v[200:203], v[64:79]
  v_exp_f32 v182, v150
  v_exp_f32 v183, v151
  v_exp_f32 v184, v152
  v_mfma_f32_32x32x16_bf16 v[160:175], a[32:35], v[216:219], v[160:175]
  v_exp_f32 v185, v153
  v_exp_f32 v186, v154
  v_cvt_pk_bf16_f32 v194, v180, v181
  v_cvt_pk_bf16_f32 v195, v182, v183
  v_mfma_f32_32x32x16_bf16 v[48:63], a[68:71], v[204:207], v[48:63]
  v_exp_f32 v187, v155
  v_exp_f32 v188, v156
  v_exp_f32 v189, v157
  v_mfma_f32_32x32x16_bf16 v[64:79], a[76:79], v[204:207], v[64:79]
  v_exp_f32 v190, v158
  v_exp_f32 v191, v159
  v_cvt_pk_bf16_f32 v196, v184, v185
  v_cvt_pk_bf16_f32 v197, v186, v187
  v_mfma_f32_32x32x16_bf16 v[144:159], a[24:27], v[220:223], 0
  s_waitcnt vmcnt(0) lgkmcnt(0)
  v_exp_f32 v176, v160
  v_exp_f32 v177, v161
  v_exp_f32 v178, v162
  v_mfma_f32_32x32x16_bf16 v[80:95], a[64:67], v[192:195], 0
  s_barrier
  s_cmp_eq_u32 s30, 0
  s_cbranch_scc0 L_f0_W
  v_readfirstlane_b32 s36, v12
  s_nop 3
  s_bfe_u32 s36, s36, 0x150008
  s_cmp_eq_u32 s36, s95
  s_cbranch_scc1 L_f0w_W
  buffer_wbl2 sc1
  s_waitcnt vmcnt(0)
L_f0w_W:
  v_mov_b32 v10, 1
  s_nop 1
  s_mov_b64 s[92:93], exec
  s_mov_b64 exec, 1
  global_atomic_add v13, v10, s[44:45] sc1
  s_mov_b64 exec, s[92:93]
L_f0_W:
  v_mfma_f32_32x32x16_bf16 v[144:159], a[28:31], v[224:227], v[144:159]
  v_exp_f32 v179, v163
  v_exp_f32 v180, v164
  v_cvt_pk_bf16_f32 v198, v188, v189
  v_cvt_pk_bf16_f32 v199, v190, v191
  v_mfma_f32_32x32x16_bf16 v[96:111], a[72:75], v[192:195], 0
  v_exp_f32 v181, v165
  v_exp_f32 v182, v166
  v_cvt_pk_bf16_f32 v200, v176, v177
  v_cvt_pk_bf16_f32 v201, v178, v179
  v_mfma_f32_32x32x16_bf16 v[144:159], a[32:35], v[228:231], v[144:159]
  v_exp_f32 v183, v167
  v_exp_f32 v184, v168
  v_exp_f32 v185, v169
  v_mfma_f32_32x32x16_bf16 v[80:95], a[68:71], v[196:199], v[80:95]
  v_exp_f32 v186, v170
  v_exp_f32 v187, v171
  v_cvt_pk_bf16_f32 v202, v180, v181
  v_cvt_pk_bf16_f32 v203, v182, v183
  v_mfma_f32_32x32x16_bf16 v[96:111], a[76:79], v[196:199], v[96:111]
  v_exp_f32 v188, v172
  v_exp_f32 v189, v173
  v_exp_f32 v190, v174
  v_exp_f32 v191, v175
  v_cvt_pk_bf16_f32 v204, v184, v185
  v_cvt_pk_bf16_f32 v205, v186, v187
  v_mfma_f32_32x32x16_bf16 v[160:175], a[24:27], v[244:247], 0
  s_nop 0
  v_exp_f32 v176, v144
  v_exp_f32 v177, v145
  v_exp_f32 v178, v146
  v_mfma_f32_32x32x16_bf16 v[16:31], a[80:83], v[200:203], v[16:31]
  ds_read_b128 a[4:7], v2 offset:29696
  v_exp_f32 v179, v147
  v_exp_f32 v180, v148
  v_cvt_pk_bf16_f32 v192, v176, v177
  v_mfma_f32_32x32x16_bf16 v[160:175], a[28:31], v[248:251], v[160:175]
  ds_read_b128 a[56:59], v2 offset:33792
  v_exp_f32 v181, v149
  v_cvt_pk_bf16_f32 v206, v188, v189
  v_cvt_pk_bf16_f32 v207, v190, v191
  v_cvt_pk_bf16_f32 v193, v178, v179
  v_mfma_f32_32x32x16_bf16 v[32:47], a[88:91], v[200:203], v[32:47]
  ds_read_b128 a[76:79], v3 offset:34816
  v_exp_f32 v182, v150
  v_exp_f32 v183, v151
  v_cvt_pk_bf16_f32 v194, v180, v181
  v_mfma_f32_32x32x16_bf16 v[160:175], a[32:35], v[252:255], v[160:175]
  v_exp_f32 v184, v152
  v_exp_f32 v185, v153
  v_exp_f32 v186, v154
  v_mfma_f32_32x32x16_bf16 v[16:31], a[84:87], v[204:207], v[16:31]
  v_exp_f32 v187, v155
  v_exp_f32 v188, v156
  v_cvt_pk_bf16_f32 v195, v182, v183
  v_cvt_pk_bf16_f32 v196, v184, v185
  v_mfma_f32_32x32x16_bf16 v[32:47], a[92:95], v[204:207], v[32:47]
  s_nop 0
  v_exp_f32 v189, v157
  v_exp_f32 v190, v158
  v_exp_f32 v191, v159
  v_cvt_pk_bf16_f32 v197, v186, v187
  v_mfma_f32_32x32x16_bf16 v[144:159], a[36:39], v[208:211], 0
  v_exp_f32 v176, v160
  v_exp_f32 v177, v161
  v_mfma_f32_32x32x16_bf16 v[48:63], a[80:83], v[192:195], v[48:63]
  v_exp_f32 v178, v162
  v_exp_f32 v179, v163
  v_exp_f32 v180, v164
  v_mfma_f32_32x32x16_bf16 v[144:159], a[40:43], v[212:215], v[144:159]
  v_exp_f32 v181, v165
  v_cvt_pk_bf16_f32 v198, v188, v189
  v_cvt_pk_bf16_f32 v199, v190, v191
  v_cvt_pk_bf16_f32 v200, v176, v177
  v_cvt_pk_bf16_f32 v201, v178, v179
  v_mfma_f32_32x32x16_bf16 v[64:79], a[88:91], v[192:195], v[64:79]
  v_exp_f32 v182, v166
  v_exp_f32 v183, v167
  v_exp_f32 v184, v168
  v_mfma_f32_32x32x16_bf16 v[144:159], a[44:47], v[216:219], v[144:159]
  v_exp_f32 v185, v169
  v_exp_f32 v186, v170
  v_cvt_pk_bf16_f32 v202, v180, v181
  v_cvt_pk_bf16_f32 v203, v182, v183
  v_mfma_f32_32x32x16_bf16 v[48:63], a[84:87], v[196:199], v[48:63]
  v_exp_f32 v187, v171
  v_exp_f32 v188, v172
  v_exp_f32 v189, v173
  v_mfma_f32_32x32x16_bf16 v[64:79], a[92:95], v[196:199], v[64:79]
  v_exp_f32 v190, v174
  v_exp_f32 v191, v175
  v_cvt_pk_bf16_f32 v204, v184, v185
  v_cvt_pk_bf16_f32 v205, v186, v187
  v_mfma_f32_32x32x16_bf16 v[160:175], a[36:39], v[220:223], 0
  ds_read_b128 a[0:3], v2 offset:28672
  v_exp_f32 v176, v144
  v_exp_f32 v177, v145
  v_exp_f32 v178, v146
  v_mfma_f32_32x32x16_bf16 v[112:127], a[80:83], v[200:203], 0
  ds_read_b128 a[8:11], v2 offset:30720
  v_exp_f32 v179, v147
  v_exp_f32 v180, v148
  v_cvt_pk_bf16_f32 v192, v176, v177
  v_mfma_f32_32x32x16_bf16 v[160:175], a[40:43], v[224:227], v[160:175]
  ds_read_b128 a[24:27], v4 offset:28672
  v_exp_f32 v181, v149
  v_cvt_pk_bf16_f32 v206, v188, v189
  v_cvt_pk_bf16_f32 v207, v190, v191
  v_cvt_pk_bf16_f32 v193, v178, v179
  v_mfma_f32_32x32x16_bf16 v[128:143], a[88:91], v[200:203], 0
  v_exp_f32 v182, v150
  v_exp_f32 v183, v151
  v_exp_f32 v184, v152
  v_mfma_f32_32x32x16_bf16 v[160:175], a[44:47], v[228:231], v[160:175]
  v_exp_f32 v185, v153
  v_exp_f32 v186, v154
  v_cvt_pk_bf16_f32 v194, v180, v181
  v_cvt_pk_bf16_f32 v195, v182, v183
  v_mfma_f32_32x32x16_bf16 v[112:127], a[84:87], v[204:207], v[112:127]
  v_exp_f32 v187, v155
  v_exp_f32 v188, v156
  v_exp_f32 v189, v157
  v_mfma_f32_32x32x16_bf16 v[128:143], a[92:95], v[204:207], v[128:143]
  v_exp_f32 v190, v158
  v_exp_f32 v191, v159
  v_cvt_pk_bf16_f32 v196, v184, v185
  v_cvt_pk_bf16_f32 v197, v186, v187
  v_mfma_f32_32x32x16_bf16 v[144:159], a[36:39], v[232:235], 0
  s_nop 0
  v_exp_f32 v176, v160
  v_exp_f32 v177, v161
  v_exp_f32 v178, v162
  v_mfma_f32_32x32x16_bf16 v[16:31], a[96:99], v[192:195], v[16:31]
  ds_read_b128 a[20:23], v3 offset:30720
  v_exp_f32 v179, v163
  v_exp_f32 v180, v164
  v_cvt_pk_bf16_f32 v200, v176, v177
  v_mfma_f32_32x32x16_bf16 v[144:159], a[40:43], v[236:239], v[144:159]
  ds_read_b128 a[60:63], v2 offset:34816
  v_exp_f32 v181, v165
  v_cvt_pk_bf16_f32 v198, v188, v189
  v_cvt_pk_bf16_f32 v199, v190, v191
  v_cvt_pk_bf16_f32 v201, v178, v179
  v_mfma_f32_32x32x16_bf16 v[32:47], a[104:107], v[192:195], v[32:47]
  ds_read_b128 a[72:75], v3 offset:33792
  v_exp_f32 v182, v166
  v_exp_f32 v183, v167
  v_cvt_pk_bf16_f32 v202, v180, v181
  v_mfma_f32_32x32x16_bf16 v[144:159], a[44:47], v[240:243], v[144:159]
  v_exp_f32 v184, v168
  v_exp_f32 v185, v169
  v_exp_f32 v186, v170
  v_mfma_f32_32x32x16_bf16 v[16:31], a[100:103], v[196:199], v[16:31]
  v_exp_f32 v187, v171
  v_exp_f32 v188, v172
  v_cvt_pk_bf16_f32 v203, v182, v183
  v_cvt_pk_bf16_f32 v204, v184, v185
  v_mfma_f32_32x32x16_bf16 v[32:47], a[108:111], v[196:199], v[32:47]
  s_waitcnt lgkmcnt(4)
  v_exp_f32 v189, v173
  v_exp_f32 v190, v174
  v_exp_f32 v191, v175
  v_cvt_pk_bf16_f32 v205, v186, v187
  v_mfma_f32_32x32x16_bf16 v[160:175], a[0:3], v[208:211], 0
  ds_read_b128 a[12:15], v3 offset:28672
  v_exp_f32 v176, v144
  v_exp_f32 v177, v145
  v_exp_f32 v178, v146
  v_mfma_f32_32x32x16_bf16 v[48:63], a[96:99], v[200:203], v[48:63]
  ds_read_b128 a[16:19], v3 offset:29696
  v_exp_f32 v179, v147
  v_exp_f32 v180, v148
  v_cvt_pk_bf16_f32 v192, v176, v177
  v_mfma_f32_32x32x16_bf16 v[160:175], a[4:7], v[212:215], v[160:175]
  ds_read_b128 a[48:51], v2 offset:31744
  v_exp_f32 v181, v149
  v_cvt_pk_bf16_f32 v206, v188, v189
  v_cvt_pk_bf16_f32 v207, v190, v191
  v_cvt_pk_bf16_f32 v193, v178, v179
  v_mfma_f32_32x32x16_bf16 v[64:79], a[104:107], v[200:203], v[64:79]
  ds_read_b128 a[52:55], v2 offset:32768
  v_exp_f32 v182, v150
  v_exp_f32 v183, v151
  v_cvt_pk_bf16_f32 v194, v180, v181
  v_mfma_f32_32x32x16_bf16 v[160:175], a[8:11], v[216:219], v[160:175]
  v_exp_f32 v184, v152
  v_exp_f32 v185, v153
  v_exp_f32 v186, v154
  v_mfma_f32_32x32x16_bf16 v[48:63], a[100:103], v[204:207], v[48:63]
  v_exp_f32 v187, v155
  v_exp_f32 v188, v156
  v_cvt_pk_bf16_f32 v195, v182, v183
  v_cvt_pk_bf16_f32 v196, v184, v185
  v_mfma_f32_32x32x16_bf16 v[64:79], a[108:111], v[204:207], v[64:79]
  v_exp_f32 v189, v157
  v_exp_f32 v190, v158
  v_exp_f32 v191, v159
  v_cvt_pk_bf16_f32 v197, v186, v187
  v_mfma_f32_32x32x16_bf16 v[144:159], a[0:3], v[220:223], 0
  ds_read_b128 a[68:71], v3 offset:32768
  v_exp_f32 v176, v160
  v_exp_f32 v177, v161
  v_exp_f32 v178, v162
  v_mfma_f32_32x32x16_bf16 v[80:95], a[96:99], v[192:195], v[80:95]
  ds_read_b128 a[32:35], v4 offset:30720
  v_exp_f32 v179, v163
  v_exp_f32 v180, v164
  v_cvt_pk_bf16_f32 v200, v176, v177
  v_mfma_f32_32x32x16_bf16 v[144:159], a[4:7], v[224:227], v[144:159]
  ds_read_b128 a[84:87], v4 offset:32768
  v_exp_f32 v181, v165
  v_cvt_pk_bf16_f32 v198, v188, v189
  v_cvt_pk_bf16_f32 v199, v190, v191
  v_cvt_pk_bf16_f32 v201, v178, v179
  v_mfma_f32_32x32x16_bf16 v[96:111], a[104:107], v[192:195], v[96:111]
  ds_read_b128 a[40:43], v5 offset:29696
  v_exp_f32 v182, v166
  v_exp_f32 v183, v167
  v_cvt_pk_bf16_f32 v202, v180, v181
  v_mfma_f32_32x32x16_bf16 v[144:159], a[8:11], v[228:231], v[144:159]
  v_exp_f32 v184, v168
  v_exp_f32 v185, v169
  v_exp_f32 v186, v170
  v_mfma_f32_32x32x16_bf16 v[80:95], a[100:103], v[196:199], v[80:95]
  v_exp_f32 v187, v171
  v_exp_f32 v188, v172
  v_cvt_pk_bf16_f32 v203, v182, v183
  v_cvt_pk_bf16_f32 v204, v184, v185
  v_mfma_f32_32x32x16_bf16 v[96:111], a[108:111], v[196:199], v[96:111]
  s_waitcnt lgkmcnt(6)
  v_exp_f32 v189, v173
  v_exp_f32 v190, v174
  v_exp_f32 v191, v175
  v_cvt_pk_bf16_f32 v205, v186, v187
  v_mfma_f32_32x32x16_bf16 v[160:175], a[12:15], v[208:211], 0
  s_waitcnt lgkmcnt(4)
  v_exp_f32 v176, v144
  v_exp_f32 v177, v145
  v_exp_f32 v178, v146
  v_mfma_f32_32x32x16_bf16 v[16:31], a[48:51], v[200:203], v[16:31]
  ds_read_b128 a[64:67], v3 offset:31744
  v_exp_f32 v179, v147
  v_exp_f32 v180, v148
  v_cvt_pk_bf16_f32 v192, v176, v177
  v_mfma_f32_32x32x16_bf16 v[160:175], a[16:19], v[212:215], v[160:175]
  ds_read_b128 a[88:91], v4 offset:33792
  v_exp_f32 v181, v149
  v_cvt_pk_bf16_f32 v206, v188, v189
  v_cvt_pk_bf16_f32 v207, v190, v191
  v_cvt_pk_bf16_f32 v193, v178, v179
  v_mfma_f32_32x32x16_bf16 v[32:47], a[56:59], v[200:203], v[32:47]
  ds_read_b128 a[100:103], v5 offset:32768
  v_exp_f32 v182, v150
  v_exp_f32 v183, v151
  v_cvt_pk_bf16_f32 v194, v180, v181
  v_mfma_f32_32x32x16_bf16 v[160:175], a[20:23], v[216:219], v[160:175]
  ds_read_b128 a[108:111], v5 offset:34816
  v_exp_f32 v184, v152
  v_exp_f32 v185, v153
  v_cvt_pk_bf16_f32 v195, v182, v183
  v_mfma_f32_32x32x16_bf16 v[16:31], a[52:55], v[204:207], v[16:31]
  v_exp_f32 v186, v154
  v_exp_f32 v187, v155
  v_exp_f32 v188, v156
  v_mfma_f32_32x32x16_bf16 v[32:47], a[60:63], v[204:207], v[32:47]
  v_exp_f32 v189, v157
  v_exp_f32 v190, v158
  v_exp_f32 v191, v159
  v_cvt_pk_bf16_f32 v196, v184, v185
  v_cvt_pk_bf16_f32 v197, v186, v187
  v_mfma_f32_32x32x16_bf16 v[144:159], a[12:15], v[220:223], 0
  ds_read_b128 a[28:31], v4 offset:29696
  v_exp_f32 v176, v160
  v_exp_f32 v177, v161
  v_exp_f32 v178, v162
  v_mfma_f32_32x32x16_bf16 v[48:63], a[48:51], v[192:195], v[48:63]
  ds_read_b128 a[80:83], v4 offset:31744
  v_exp_f32 v179, v163
  v_exp_f32 v180, v164
  v_cvt_pk_bf16_f32 v200, v176, v177
  v_mfma_f32_32x32x16_bf16 v[144:159], a[16:19], v[224:227], v[144:159]
  ds_read_b128 a[44:47], v5 offset:30720
  v_exp_f32 v181, v165
  v_cvt_pk_bf16_f32 v198, v188, v189
  v_cvt_pk_bf16_f32 v199, v190, v191
  v_cvt_pk_bf16_f32 v201, v178, v179
  v_mfma_f32_32x32x16_bf16 v[64:79], a[56:59], v[192:195], v[64:79]
  global_load_dword v12, v13, s[44:45] sc1
  v_exp_f32 v182, v166
  v_exp_f32 v183, v167
  v_mfma_f32_32x32x16_bf16 v[144:159], a[20:23], v[228:231], v[144:159]
  ds_read_b128 a[104:107], v5 offset:33792
  v_exp_f32 v184, v168
  v_exp_f32 v185, v169
  v_cvt_pk_bf16_f32 v202, v180, v181
  v_mfma_f32_32x32x16_bf16 v[48:63], a[52:55], v[196:199], v[48:63]
  s_add_u32 s20, s20, 28672
  v_exp_f32 v186, v170
  v_exp_f32 v187, v171
  v_cvt_pk_bf16_f32 v203, v182, v183
  v_cvt_pk_bf16_f32 v204, v184, v185
  v_mfma_f32_32x32x16_bf16 v[64:79], a[60:63], v[196:199], v[64:79]
  s_cmp_ge_u32 s20, s21
  s_cselect_b32 s25, 401408, 0
  v_exp_f32 v188, v172
  v_exp_f32 v189, v173
  v_exp_f32 v190, v174
  v_exp_f32 v191, v175
  v_cvt_pk_bf16_f32 v205, v186, v187
  v_mfma_f32_32x32x16_bf16 v[160:175], a[12:15], v[232:235], 0
  s_waitcnt lgkmcnt(7)
  v_exp_f32 v176, v144
  v_exp_f32 v177, v145
  v_exp_f32 v178, v146
  v_mfma_f32_32x32x16_bf16 v[16:31], a[64:67], v[200:203], v[16:31]
  ds_read_b128 a[92:95], v4 offset:34816
  v_exp_f32 v179, v147
  v_exp_f32 v180, v148
  v_cvt_pk_bf16_f32 v192, v176, v177
  v_mfma_f32_32x32x16_bf16 v[160:175], a[16:19], v[236:239], v[160:175]
  ds_read_b128 a[36:39], v5 offset:28672
  v_exp_f32 v181, v149
  v_cvt_pk_bf16_f32 v206, v188, v189
  v_cvt_pk_bf16_f32 v207, v190, v191
  v_cvt_pk_bf16_f32 v193, v178, v179
  v_mfma_f32_32x32x16_bf16 v[32:47], a[72:75], v[200:203], v[32:47]
  ds_read_b128 a[96:99], v5 offset:31744
  v_exp_f32 v182, v150
  v_exp_f32 v183, v151
  v_cvt_pk_bf16_f32 v194, v180, v181
  v_mfma_f32_32x32x16_bf16 v[160:175], a[20:23], v[240:243], v[160:175]
  s_sub_u32 s20, s20, s25
  v_exp_f32 v184, v152
  v_exp_f32 v185, v153
  v_exp_f32 v186, v154
  v_mfma_f32_32x32x16_bf16 v[16:31], a[68:71], v[204:207], v[16:31]
  s_add_u32 s28, s20, 4096
  v_exp_f32 v187, v155
  v_exp_f32 v188, v156
  v_cvt_pk_bf16_f32 v195, v182, v183
  v_cvt_pk_bf16_f32 v196, v184, v185
  v_mfma_f32_32x32x16_bf16 v[32:47], a[76:79], v[204:207], v[32:47]
  s_waitcnt lgkmcnt(6)
  v_exp_f32 v189, v157
  v_exp_f32 v190, v158
  v_exp_f32 v191, v159
  v_cvt_pk_bf16_f32 v197, v186, v187
  v_mfma_f32_32x32x16_bf16 v[144:159], a[24:27], v[208:211], 0
  v_exp_f32 v176, v160
  v_exp_f32 v177, v161
  v_exp_f32 v178, v162
  v_mfma_f32_32x32x16_bf16 v[48:63], a[64:67], v[192:195], v[48:63]
  v_exp_f32 v179, v163
  v_exp_f32 v180, v164
  v_exp_f32 v181, v165
  v_mfma_f32_32x32x16_bf16 v[144:159], a[28:31], v[212:215], v[144:159]
  v_exp_f32 v182, v166
  v_cvt_pk_bf16_f32 v198, v188, v189
  v_cvt_pk_bf16_f32 v199, v190, v191
  v_cvt_pk_bf16_f32 v200, v176, v177
  v_cvt_pk_bf16_f32 v201, v178, v179
  v_mfma_f32_32x32x16_bf16 v[64:79], a[72:75], v[192:195], v[64:79]
  v_exp_f32 v183, v167
  v_exp_f32 v184, v168
  v_exp_f32 v185, v169
  v_mfma_f32_32x32x16_bf16 v[144:159], a[32:35], v[216:219], v[144:159]
  v_exp_f32 v186, v170
  v_exp_f32 v187, v171
  v_cvt_pk_bf16_f32 v202, v180, v181
  v_cvt_pk_bf16_f32 v203, v182, v183
  v_mfma_f32_32x32x16_bf16 v[48:63], a[68:71], v[196:199], v[48:63]
  v_exp_f32 v188, v172
  v_exp_f32 v189, v173
  v_cvt_pk_bf16_f32 v204, v184, v185
  v_cvt_pk_bf16_f32 v205, v186, v187
  v_mfma_f32_32x32x16_bf16 v[64:79], a[76:79], v[196:199], v[64:79]
  v_exp_f32 v190, v174
  v_exp_f32 v191, v175
  v_add_u32 v3, s23, v3
  v_add_u32 v4, s23, v4
  v_mfma_f32_32x32x16_bf16 v[160:175], a[24:27], v[220:223], 0
  s_waitcnt vmcnt(0) lgkmcnt(0)
  v_exp_f32 v176, v144
  v_exp_f32 v177, v145
  v_exp_f32 v178, v146
  v_mfma_f32_32x32x16_bf16 v[80:95], a[64:67], v[200:203], v[80:95]
  s_barrier
  s_mov_b32 s94, 0x40000
L_f1_W:
  v_readfirstlane_b32 s36, v12
  s_nop 3
  s_and_b32 s36, s36, 7
  s_cmp_ge_u32 s36, s29
  s_cbranch_scc1 L_f1ok_W
  global_load_dword v12, v13, s[44:45] sc1
  s_waitcnt vmcnt(0)
  s_sub_u32 s94, s94, 1
  s_cmp_lg_u32 s94, 0
  s_cbranch_scc1 L_f1_W
L_f1ok_W:
  v_readfirstlane_b32 s36, v12
  s_nop 3
  s_bfe_u32 s36, s36, 0x150008
  s_cmp_eq_u32 s36, s95
  s_cbranch_scc1 L_f1s_W
  buffer_inv sc1
  s_waitcnt vmcnt(0)
L_f1s_W:
  v_mfma_f32_32x32x16_bf16 v[160:175], a[28:31], v[224:227], v[160:175]
  s_add_u32 m0, s22, 28672
  v_exp_f32 v179, v147
  v_exp_f32 v180, v148
  v_cvt_pk_bf16_f32 v206, v188, v189
  v_cvt_pk_bf16_f32 v207, v190, v191
  v_mfma_f32_32x32x16_bf16 v[96:111], a[72:75], v[200:203], v[96:111]
  buffer_load_dwordx4 v1, s[12:15], s20 offen offset:0 lds
  v_exp_f32 v181, v149
  v_cvt_pk_bf16_f32 v192, v176, v177
  v_cvt_pk_bf16_f32 v193, v178, v179
  v_mfma_f32_32x32x16_bf16 v[160:175], a[32:35], v[228:231], v[160:175]
  buffer_load_dwordx4 v1, s[12:15], s20 offen offset:1024 lds
  v_exp_f32 v182, v150
  v_exp_f32 v183, v151
  v_mfma_f32_32x32x16_bf16 v[80:95], a[68:71], v[204:207], v[80:95]
  buffer_load_dwordx4 v1, s[12:15], s20 offen offset:2048 lds
  v_exp_f32 v184, v152
  v_exp_f32 v185, v153
  v_exp_f32 v186, v154
  v_exp_f32 v187, v155
  v_mfma_f32_32x32x16_bf16 v[96:111], a[76:79], v[204:207], v[96:111]
  v_exp_f32 v188, v156
  v_exp_f32 v189, v157
  v_exp_f32 v190, v158
  v_exp_f32 v191, v159
  v_cvt_pk_bf16_f32 v194, v180, v181
  v_cvt_pk_bf16_f32 v195, v182, v183
  v_cvt_pk_bf16_f32 v196, v184, v185
  v_cvt_pk_bf16_f32 v197, v186, v187
  v_add_u32 v2, s23, v2
  v_mfma_f32_32x32x16_bf16 v[144:159], a[24:27], v[244:247], 0
  s_nop 0
  v_exp_f32 v176, v160
  v_exp_f32 v177, v161
  v_exp_f32 v178, v162
  v_mfma_f32_32x32x16_bf16 v[16:31], a[80:83], v[192:195], v[16:31]
  ds_read_b128 a[4:7], v2 offset:1024
  v_exp_f32 v179, v163
  v_exp_f32 v180, v164
  v_cvt_pk_bf16_f32 v200, v176, v177
  v_mfma_f32_32x32x16_bf16 v[144:159], a[28:31], v[248:251], v[144:159]
  ds_read_b128 a[12:15], v3 offset:0
  v_exp_f32 v181, v165
  v_cvt_pk_bf16_f32 v198, v188, v189
  v_cvt_pk_bf16_f32 v199, v190, v191
  v_cvt_pk_bf16_f32 v201, v178, v179
  v_mfma_f32_32x32x16_bf16 v[32:47], a[88:91], v[192:195], v[32:47]
  ds_read_b128 a[68:71], v3 offset:4096
  v_exp_f32 v182, v166
  v_exp_f32 v183, v167
  v_cvt_pk_bf16_f32 v202, v180, v181
  v_mfma_f32_32x32x16_bf16 v[144:159], a[32:35], v[252:255], v[144:159]
  buffer_load_dwordx4 v1, s[12:15], s20 offen offset:3072 lds
  v_exp_f32 v184, v168
  v_exp_f32 v185, v169
  v_mfma_f32_32x32x16_bf16 v[16:31], a[84:87], v[196:199], v[16:31]
  s_add_u32 m0, s22, 32768
  v_exp_f32 v186, v170
  v_exp_f32 v187, v171
  v_cvt_pk_bf16_f32 v203, v182, v183
  v_cvt_pk_bf16_f32 v204, v184, v185
  v_mfma_f32_32x32x16_bf16 v[32:47], a[92:95], v[196:199], v[32:47]
  s_nop 0
  v_exp_f32 v188, v172
  v_exp_f32 v189, v173
  v_exp_f32 v190, v174
  v_exp_f32 v191, v175
  v_cvt_pk_bf16_f32 v205, v186, v187
  v_mfma_f32_32x32x16_bf16 v[160:175], a[36:39], v[208:211], 0
  ds_read_b128 a[0:3], v2 offset:0
  v_exp_f32 v176, v144
  v_exp_f32 v177, v145
  v_exp_f32 v178, v146
  v_mfma_f32_32x32x16_bf16 v[48:63], a[80:83], v[200:203], v[48:63]
  ds_read_b128 a[60:63], v2 offset:6144
  v_exp_f32 v179, v147
  v_exp_f32 v180, v148
  v_cvt_pk_bf16_f32 v192, v176, v177
  v_mfma_f32_32x32x16_bf16 v[160:175], a[40:43], v[212:215], v[160:175]
  ds_read_b128 a[24:27], v4 offset:0
  v_exp_f32 v181, v149
  v_cvt_pk_bf16_f32 v206, v188, v189
  v_cvt_pk_bf16_f32 v207, v190, v191
  v_cvt_pk_bf16_f32 v193, v178, v179
  v_mfma_f32_32x32x16_bf16 v[64:79], a[88:91], v[200:203], v[64:79]
  buffer_load_dwordx4 v1, s[12:15], s28 offen offset:0 lds
  v_exp_f32 v182, v150
  v_exp_f32 v183, v151
  v_mfma_f32_32x32x16_bf16 v[160:175], a[44:47], v[216:219], v[160:175]
  buffer_load_dwordx4 v1, s[12:15], s28 offen offset:1024 lds
  v_exp_f32 v184, v152
  v_cvt_pk_bf16_f32 v194, v180, v181
  v_cvt_pk_bf16_f32 v195, v182, v183
  v_mfma_f32_32x32x16_bf16 v[48:63], a[84:87], v[204:207], v[48:63]
  buffer_load_dwordx4 v1, s[12:15], s28 offen offset:2048 lds
  v_exp_f32 v185, v153
  v_exp_f32 v186, v154
  v_exp_f32 v187, v155
  v_mfma_f32_32x32x16_bf16 v[64:79], a[92:95], v[204:207], v[64:79]
  v_exp_f32 v188, v156
  v_exp_f32 v189, v157
  v_exp_f32 v190, v158
  v_exp_f32 v191, v159
  v_cvt_pk_bf16_f32 v196, v184, v185
  v_cvt_pk_bf16_f32 v197, v186, v187
  v_add_u32 v5, s23, v5
  v_mfma_f32_32x32x16_bf16 v[144:159], a[36:39], v[220:223], 0
  ds_read_b128 a[8:11], v2 offset:2048
  v_exp_f32 v176, v160
  v_exp_f32 v177, v161
  v_exp_f32 v178, v162
  v_mfma_f32_32x32x16_bf16 v[112:127], a[80:83], v[192:195], v[112:127]
  ds_read_b128 a[56:59], v2 offset:5120
  v_exp_f32 v179, v163
  v_exp_f32 v180, v164
  v_cvt_pk_bf16_f32 v200, v176, v177
  v_mfma_f32_32x32x16_bf16 v[144:159], a[40:43], v[224:227], v[144:159]
  ds_read_b128 a[72:75], v3 offset:5120
  v_exp_f32 v181, v165
  v_cvt_pk_bf16_f32 v198, v188, v189
  v_cvt_pk_bf16_f32 v199, v190, v191
  v_cvt_pk_bf16_f32 v201, v178, v179
  v_mfma_f32_32x32x16_bf16 v[128:143], a[88:91], v[192:195], v[128:143]
  v_exp_f32 v182, v166
  v_exp_f32 v183, v167
  v_exp_f32 v184, v168
  v_mfma_f32_32x32x16_bf16 v[144:159], a[44:47], v[228:231], v[144:159]
  v_exp_f32 v185, v169
  v_exp_f32 v186, v170
  v_cvt_pk_bf16_f32 v202, v180, v181
  v_cvt_pk_bf16_f32 v203, v182, v183
  v_mfma_f32_32x32x16_bf16 v[112:127], a[84:87], v[196:199], v[112:127]
  v_exp_f32 v187, v171
  v_exp_f32 v188, v172
  v_exp_f32 v189, v173
  v_mfma_f32_32x32x16_bf16 v[128:143], a[92:95], v[196:199], v[128:143]
  v_exp_f32 v190, v174
  v_exp_f32 v191, v175
  v_cvt_pk_bf16_f32 v204, v184, v185
  v_cvt_pk_bf16_f32 v205, v186, v187
  v_mfma_f32_32x32x16_bf16 v[160:175], a[36:39], v[232:235], 0
  s_nop 0
  v_exp_f32 v176, v144
  v_exp_f32 v177, v145
  v_mfma_f32_32x32x16_bf16 v[16:31], a[96:99], v[200:203], v[16:31]
  v_exp_f32 v178, v146
  v_exp_f32 v179, v147
  v_exp_f32 v180, v148
  v_mfma_f32_32x32x16_bf16 v[160:175], a[40:43], v[236:239], v[160:175]
  v_exp_f32 v181, v149
  v_cvt_pk_bf16_f32 v206, v188, v189
  v_cvt_pk_bf16_f32 v207, v190, v191
  v_cvt_pk_bf16_f32 v192, v176, v177
  v_cvt_pk_bf16_f32 v193, v178, v179
  v_mfma_f32_32x32x16_bf16 v[32:47], a[104:107], v[200:203], v[32:47]
  v_exp_f32 v182, v150
  v_exp_f32 v183, v151
  v_exp_f32 v184, v152
  v_mfma_f32_32x32x16_bf16 v[160:175], a[44:47], v[240:243], v[160:175]
  v_exp_f32 v185, v153
  v_exp_f32 v186, v154
  v_cvt_pk_bf16_f32 v194, v180, v181
  v_cvt_pk_bf16_f32 v195, v182, v183
  v_mfma_f32_32x32x16_bf16 v[16:31], a[100:103], v[204:207], v[16:31]
  v_exp_f32 v187, v155
  v_exp_f32 v188, v156
  v_exp_f32 v189, v157
  v_mfma_f32_32x32x16_bf16 v[32:47], a[108:111], v[204:207], v[32:47]
  s_waitcnt lgkmcnt(2)
  v_exp_f32 v190, v158
  v_exp_f32 v191, v159
  v_cvt_pk_bf16_f32 v196, v184, v185
  v_cvt_pk_bf16_f32 v197, v186, v187
  v_mfma_f32_32x32x16_bf16 v[144:159], a[0:3], v[208:211], 0
  ds_read_b128 a[16:19], v3 offset:1024
  v_exp_f32 v176, v160
  v_exp_f32 v177, v161
  v_exp_f32 v178, v162
  v_mfma_f32_32x32x16_bf16 v[48:63], a[96:99], v[192:195], v[48:63]
  ds_read_b128 a[20:23], v3 offset:2048
  v_exp_f32 v179, v163
  v_exp_f32 v180, v164
  v_cvt_pk_bf16_f32 v200, v176, v177
  v_mfma_f32_32x32x16_bf16 v[144:159], a[4:7], v[212:215], v[144:159]
  ds_read_b128 a[48:51], v2 offset:3072
  v_exp_f32 v181, v165
  v_cvt_pk_bf16_f32 v198, v188, v189
  v_cvt_pk_bf16_f32 v199, v190, v191
  v_cvt_pk_bf16_f32 v201, v178, v179
  v_mfma_f32_32x32x16_bf16 v[64:79], a[104:107], v[192:195], v[64:79]
  ds_read_b128 a[52:55], v2 offset:4096
  v_exp_f32 v182, v166
  v_exp_f32 v183, v167
  v_cvt_pk_bf16_f32 v202, v180, v181
  v_mfma_f32_32x32x16_bf16 v[144:159], a[8:11], v[216:219], v[144:159]
  v_exp_f32 v184, v168
  v_exp_f32 v185, v169
  v_exp_f32 v186, v170
  v_mfma_f32_32x32x16_bf16 v[48:63], a[100:103], v[196:199], v[48:63]
  v_exp_f32 v187, v171
  v_exp_f32 v188, v172
  v_cvt_pk_bf16_f32 v203, v182, v183
  v_cvt_pk_bf16_f32 v204, v184, v185
  v_mfma_f32_32x32x16_bf16 v[64:79], a[108:111], v[196:199], v[64:79]
  v_exp_f32 v189, v173
  v_exp_f32 v190, v174
  v_exp_f32 v191, v175
  v_cvt_pk_bf16_f32 v205, v186, v187
  s_sub_u32 s22, s22, s23
  s_sub_u32 s23, 0, s23
  s_add_u32 s24, s24, 2
  s_cmp_lt_u32 s24, 12
.p2align 6
L_loop_W:
  v_mfma_f32_32x32x16_bf16 v[160:175], a[0:3], v[220:223], 0
  ds_read_b128 a[64:67], v3 offset:3072
  v_exp_f32 v176, v144
  v_exp_f32 v177, v145
  v_exp_f32 v178, v146
  v_mfma_f32_32x32x16_bf16 v[80:95], a[96:99], v[200:203], v[80:95]
  ds_read_b128 a[84:87], v4 offset:4096
  v_exp_f32 v179, v147
  v_exp_f32 v180, v148
  v_cvt_pk_bf16_f32 v192, v176, v177
  v_mfma_f32_32x32x16_bf16 v[160:175], a[4:7], v[224:227], v[160:175]
  ds_read_b128 a[92:95], v4 offset:6144
  v_exp_f32 v181, v149
  v_cvt_pk_bf16_f32 v206, v188, v189
  v_cvt_pk_bf16_f32 v207, v190, v191
  v_cvt_pk_bf16_f32 v193, v178, v179
  v_mfma_f32_32x32x16_bf16 v[96:111], a[104:107], v[200:203], v[96:111]
  ds_read_b128 a[44:47], v5 offset:2048
  v_exp_f32 v182, v150
  v_exp_f32 v183, v151
  v_cvt_pk_bf16_f32 v194, v180, v181
  v_mfma_f32_32x32x16_bf16 v[160:175], a[8:11], v[228:231], v[160:175]
  v_exp_f32 v184, v152
  v_exp_f32 v185, v153
  v_exp_f32 v186, v154
  v_mfma_f32_32x32x16_bf16 v[80:95], a[100:103], v[204:207], v[80:95]
  v_exp_f32 v187, v155
  v_exp_f32 v188, v156
  v_cvt_pk_bf16_f32 v195, v182, v183
  v_cvt_pk_bf16_f32 v196, v184, v185
  v_mfma_f32_32x32x16_bf16 v[96:111], a[108:111], v[204:207], v[96:111]
  s_waitcnt lgkmcnt(6)
  v_exp_f32 v189, v157
  v_exp_f32 v190, v158
  v_exp_f32 v191, v159
  v_cvt_pk_bf16_f32 v197, v186, v187
  v_mfma_f32_32x32x16_bf16 v[144:159], a[12:15], v[208:211], 0
  s_waitcnt lgkmcnt(4)
  v_exp_f32 v176, v160
  v_exp_f32 v177, v161
  v_exp_f32 v178, v162
  v_mfma_f32_32x32x16_bf16 v[16:31], a[48:51], v[192:195], v[16:31]
  ds_read_b128 a[76:79], v3 offset:6144
  v_exp_f32 v179, v163
  v_exp_f32 v180, v164
  v_cvt_pk_bf16_f32 v200, v176, v177
  v_mfma_f32_32x32x16_bf16 v[144:159], a[16:19], v[212:215], v[144:159]
  ds_read_b128 a[28:31], v4 offset:1024
  v_exp_f32 v181, v165
  v_cvt_pk_bf16_f32 v198, v188, v189
  v_cvt_pk_bf16_f32 v199, v190, v191
  v_cvt_pk_bf16_f32 v201, v178, v179
  v_mfma_f32_32x32x16_bf16 v[32:47], a[56:59], v[192:195], v[32:47]
  ds_read_b128 a[40:43], v5 offset:1024
  v_exp_f32 v182, v166
  v_exp_f32 v183, v167
  v_cvt_pk_bf16_f32 v202, v180, v181
  v_mfma_f32_32x32x16_bf16 v[144:159], a[20:23], v[216:219], v[144:159]
  ds_read_b128 a[96:99], v5 offset:3072
  v_exp_f32 v184, v168
  v_exp_f32 v185, v169
  v_cvt_pk_bf16_f32 v203, v182, v183
  v_mfma_f32_32x32x16_bf16 v[16:31], a[52:55], v[196:199], v[16:31]
  v_exp_f32 v186, v170
  v_exp_f32 v187, v171
  v_exp_f32 v188, v172
  v_mfma_f32_32x32x16_bf16 v[32:47], a[60:63], v[196:199], v[32:47]
  v_exp_f32 v189, v173
  v_exp_f32 v190, v174
  v_exp_f32 v191, v175
  v_cvt_pk_bf16_f32 v204, v184, v185
  v_cvt_pk_bf16_f32 v205, v186, v187
  v_mfma_f32_32x32x16_bf16 v[160:175], a[12:15], v[220:223], 0
  ds_read_b128 a[32:35], v4 offset:2048
  v_exp_f32 v176, v144
  v_exp_f32 v177, v145
  v_exp_f32 v178, v146
  v_mfma_f32_32x32x16_bf16 v[48:63], a[48:51], v[200:203], v[48:63]
  ds_read_b128 a[88:91], v4 offset:5120
  v_exp_f32 v179, v147
  v_exp_f32 v180, v148
  v_cvt_pk_bf16_f32 v192, v176, v177
  v_mfma_f32_32x32x16_bf16 v[160:175], a[16:19], v[224:227], v[160:175]
  ds_read_b128 a[36:39], v5 offset:0
  v_exp_f32 v181, v149
  v_cvt_pk_bf16_f32 v206, v188, v189
  v_cvt_pk_bf16_f32 v207, v190, v191
  v_cvt_pk_bf16_f32 v193, v178, v179
  v_mfma_f32_32x32x16_bf16 v[64:79], a[56:59], v[200:203], v[64:79]
  ds_read_b128 a[108:111], v5 offset:6144
  v_exp_f32 v182, v150
  v_exp_f32 v183, v151
  v_cvt_pk_bf16_f32 v194, v180, v181
  v_mfma_f32_32x32x16_bf16 v[160:175], a[20:23], v[228:231], v[160:175]
  s_add_u32 s20, s20, 28672
  v_exp_f32 v184, v152
  v_exp_f32 v185, v153
  v_exp_f32 v186, v154
  v_mfma_f32_32x32x16_bf16 v[48:63], a[52:55], v[204:207], v[48:63]
  s_cmp_ge_u32 s20, s21
  s_cselect_b32 s25, 401408, 0
  v_exp_f32 v187, v155
  v_exp_f32 v188, v156
  v_cvt_pk_bf16_f32 v195, v182, v183
  v_mfma_f32_32x32x16_bf16 v[64:79], a[60:63], v[204:207], v[64:79]
  s_sub_u32 s20, s20, s25
  v_exp_f32 v189, v157
  v_exp_f32 v190, v158
  v_exp_f32 v191, v159
  v_cvt_pk_bf16_f32 v196, v184, v185
  v_cvt_pk_bf16_f32 v197, v186, v187
  v_mfma_f32_32x32x16_bf16 v[144:159], a[12:15], v[232:235], 0
  s_waitcnt lgkmcnt(7)
  v_exp_f32 v176, v160
  v_exp_f32 v177, v161
  v_exp_f32 v178, v162
  v_mfma_f32_32x32x16_bf16 v[16:31], a[64:67], v[192:195], v[16:31]
  ds_read_b128 a[80:83], v4 offset:3072
  v_exp_f32 v179, v163
  v_exp_f32 v180, v164
  v_cvt_pk_bf16_f32 v200, v176, v177
  v_mfma_f32_32x32x16_bf16 v[144:159], a[16:19], v[236:239], v[144:159]
  ds_read_b128 a[100:103], v5 offset:4096
  v_exp_f32 v181, v165
  v_cvt_pk_bf16_f32 v198, v188, v189
  v_cvt_pk_bf16_f32 v199, v190, v191
  v_cvt_pk_bf16_f32 v201, v178, v179
  v_mfma_f32_32x32x16_bf16 v[32:47], a[72:75], v[192:195], v[32:47]
  ds_read_b128 a[104:107], v5 offset:5120
  v_exp_f32 v182, v166
  v_exp_f32 v183, v167
  v_cvt_pk_bf16_f32 v202, v180, v181
  v_mfma_f32_32x32x16_bf16 v[144:159], a[20:23], v[240:243], v[144:159]
  s_add_u32 s28, s20, 4096
  v_exp_f32 v184, v168
  v_exp_f32 v185, v169
  v_exp_f32 v186, v170
  v_mfma_f32_32x32x16_bf16 v[16:31], a[68:71], v[196:199], v[16:31]
  v_exp_f32 v187, v171
  v_exp_f32 v188, v172
  v_cvt_pk_bf16_f32 v203, v182, v183
  v_cvt_pk_bf16_f32 v204, v184, v185
  v_mfma_f32_32x32x16_bf16 v[32:47], a[76:79], v[196:199], v[32:47]
  s_waitcnt lgkmcnt(6)
  v_exp_f32 v189, v173
  v_exp_f32 v190, v174
  v_exp_f32 v191, v175
  v_cvt_pk_bf16_f32 v205, v186, v187
  v_mfma_f32_32x32x16_bf16 v[160:175], a[24:27], v[208:211], 0
  v_exp_f32 v176, v144
  v_exp_f32 v177, v145
  v_mfma_f32_32x32x16_bf16 v[48:63], a[64:67], v[200:203], v[48:63]
  v_exp_f32 v178, v146
  v_exp_f32 v179, v147
  v_exp_f32 v180, v148
  v_mfma_f32_32x32x16_bf16 v[160:175], a[28:31], v[212:215], v[160:175]
  v_exp_f32 v181, v149
  v_cvt_pk_bf16_f32 v206, v188, v189
  v_cvt_pk_bf16_f32 v207, v190, v191
  v_cvt_pk_bf16_f32 v192, v176, v177
  v_cvt_pk_bf16_f32 v193, v178, v179
  v_mfma_f32_32x32x16_bf16 v[64:79], a[72:75], v[200:203], v[64:79]
  v_exp_f32 v182, v150
  v_exp_f32 v183, v151
  v_exp_f32 v184, v152
  v_mfma_f32_32x32x16_bf16 v[160:175], a[32:35], v[216:219], v[160:175]
  v_exp_f32 v185, v153
  v_exp_f32 v186, v154
  v_cvt_pk_bf16_f32 v194, v180, v181
  v_cvt_pk_bf16_f32 v195, v182, v183
  v_mfma_f32_32x32x16_bf16 v[48:63], a[68:71], v[204:207], v[48:63]
  v_exp_f32 v187, v155
  v_exp_f32 v188, v156
  v_exp_f32 v189, v157
  v_mfma_f32_32x32x16_bf16 v[64:79], a[76:79], v[204:207], v[64:79]
  v_exp_f32 v190, v158
  v_exp_f32 v191, v159
  v_cvt_pk_bf16_f32 v196, v184, v185
  v_cvt_pk_bf16_f32 v197, v186, v187
  v_mfma_f32_32x32x16_bf16 v[144:159], a[24:27], v[220:223], 0
  s_waitcnt vmcnt(0) lgkmcnt(0)
  v_exp_f32 v176, v160
  v_exp_f32 v177, v161
  v_exp_f32 v178, v162
  v_mfma_f32_32x32x16_bf16 v[80:95], a[64:67], v[192:195], v[80:95]
  s_barrier
  v_exp_f32 v179, v163
  v_exp_f32 v180, v164
  v_exp_f32 v181, v165
  v_mfma_f32_32x32x16_bf16 v[144:159], a[28:31], v[224:227], v[144:159]
  s_add_u32 m0, s22, 0
  v_exp_f32 v182, v166
  v_cvt_pk_bf16_f32 v198, v188, v189
  v_cvt_pk_bf16_f32 v199, v190, v191
  v_cvt_pk_bf16_f32 v200, v176, v177
  v_cvt_pk_bf16_f32 v201, v178, v179
  v_mfma_f32_32x32x16_bf16 v[96:111], a[72:75], v[192:195], v[96:111]
  buffer_load_dwordx4 v1, s[12:15], s20 offen offset:0 lds
  v_exp_f32 v183, v167
  v_exp_f32 v184, v168
  v_mfma_f32_32x32x16_bf16 v[144:159], a[32:35], v[228:231], v[144:159]
  buffer_load_dwordx4 v1, s[12:15], s20 offen offset:1024 lds
  v_exp_f32 v185, v169
  v_cvt_pk_bf16_f32 v202, v180, v181
  v_cvt_pk_bf16_f32 v203, v182, v183
  v_mfma_f32_32x32x16_bf16 v[80:95], a[68:71], v[196:199], v[80:95]
  v_exp_f32 v186, v170
  v_exp_f32 v187, v171
  v_exp_f32 v188, v172
  v_mfma_f32_32x32x16_bf16 v[96:111], a[76:79], v[196:199], v[96:111]
  v_exp_f32 v189, v173
  v_exp_f32 v190, v174
  v_exp_f32 v191, v175
  v_cvt_pk_bf16_f32 v204, v184, v185
  v_cvt_pk_bf16_f32 v205, v186, v187
  v_mfma_f32_32x32x16_bf16 v[160:175], a[24:27], v[244:247], 0
  s_nop 0
  v_exp_f32 v176, v144
  v_exp_f32 v177, v145
  v_exp_f32 v178, v146
  v_mfma_f32_32x32x16_bf16 v[16:31], a[80:83], v[200:203], v[16:31]
  ds_read_b128 a[4:7], v2 offset:29696
  v_exp_f32 v179, v147
  v_exp_f32 v180, v148
  v_cvt_pk_bf16_f32 v192, v176, v177
  v_mfma_f32_32x32x16_bf16 v[160:175], a[28:31], v[248:251], v[160:175]
  ds_read_b128 a[56:59], v2 offset:33792
  v_exp_f32 v181, v149
  v_cvt_pk_bf16_f32 v206, v188, v189
  v_cvt_pk_bf16_f32 v207, v190, v191
  v_cvt_pk_bf16_f32 v193, v178, v179
  v_mfma_f32_32x32x16_bf16 v[32:47], a[88:91], v[200:203], v[32:47]
  ds_read_b128 a[76:79], v3 offset:34816
  v_exp_f32 v182, v150
  v_exp_f32 v183, v151
  v_cvt_pk_bf16_f32 v194, v180, v181
  v_mfma_f32_32x32x16_bf16 v[160:175], a[32:35], v[252:255], v[160:175]
  buffer_load_dwordx4 v1, s[12:15], s20 offen offset:2048 lds
  v_exp_f32 v184, v152
  v_exp_f32 v185, v153
  v_mfma_f32_32x32x16_bf16 v[16:31], a[84:87], v[204:207], v[16:31]
  v_exp_f32 v186, v154
  v_exp_f32 v187, v155
  v_cvt_pk_bf16_f32 v195, v182, v183
  v_cvt_pk_bf16_f32 v196, v184, v185
  v_mfma_f32_32x32x16_bf16 v[32:47], a[92:95], v[204:207], v[32:47]
  s_nop 0
  v_exp_f32 v188, v156
  v_exp_f32 v189, v157
  v_exp_f32 v190, v158
  v_exp_f32 v191, v159
  v_cvt_pk_bf16_f32 v197, v186, v187
  v_mfma_f32_32x32x16_bf16 v[144:159], a[36:39], v[208:211], 0
  buffer_load_dwordx4 v1, s[12:15], s20 offen offset:3072 lds
  v_exp_f32 v176, v160
  v_exp_f32 v177, v161
  v_mfma_f32_32x32x16_bf16 v[48:63], a[80:83], v[192:195], v[48:63]
  s_add_u32 m0, s22, 4096
  v_exp_f32 v178, v162
  v_exp_f32 v179, v163
  v_exp_f32 v180, v164
  v_mfma_f32_32x32x16_bf16 v[144:159], a[40:43], v[212:215], v[144:159]
  buffer_load_dwordx4 v1, s[12:15], s28 offen offset:0 lds
  v_cvt_pk_bf16_f32 v198, v188, v189
  v_cvt_pk_bf16_f32 v199, v190, v191
  v_cvt_pk_bf16_f32 v200, v176, v177
  v_cvt_pk_bf16_f32 v201, v178, v179
  v_mfma_f32_32x32x16_bf16 v[64:79], a[88:91], v[192:195], v[64:79]
  v_exp_f32 v181, v165
  v_exp_f32 v182, v166
  v_exp_f32 v183, v167
  v_mfma_f32_32x32x16_bf16 v[144:159], a[44:47], v[216:219], v[144:159]
  v_exp_f32 v184, v168
  v_exp_f32 v185, v169
  v_cvt_pk_bf16_f32 v202, v180, v181
  v_cvt_pk_bf16_f32 v203, v182, v183
  v_mfma_f32_32x32x16_bf16 v[48:63], a[84:87], v[196:199], v[48:63]
  v_exp_f32 v186, v170
  v_exp_f32 v187, v171
  v_exp_f32 v188, v172
  v_mfma_f32_32x32x16_bf16 v[64:79], a[92:95], v[196:199], v[64:79]
  v_exp_f32 v189, v173
  v_exp_f32 v190, v174
  v_exp_f32 v191, v175
  v_cvt_pk_bf16_f32 v204, v184, v185
  v_cvt_pk_bf16_f32 v205, v186, v187
  v_mfma_f32_32x32x16_bf16 v[160:175], a[36:39], v[220:223], 0
  ds_read_b128 a[0:3], v2 offset:28672
  v_exp_f32 v176, v144
  v_exp_f32 v177, v145
  v_exp_f32 v178, v146
  v_mfma_f32_32x32x16_bf16 v[112:127], a[80:83], v[200:203], v[112:127]
  ds_read_b128 a[8:11], v2 offset:30720
  v_exp_f32 v179, v147
  v_exp_f32 v180, v148
  v_cvt_pk_bf16_f32 v192, v176, v177
  v_mfma_f32_32x32x16_bf16 v[160:175], a[40:43], v[224:227], v[160:175]
  ds_read_b128 a[24:27], v4 offset:28672
  v_exp_f32 v181, v149
  v_cvt_pk_bf16_f32 v206, v188, v189
  v_cvt_pk_bf16_f32 v207, v190, v191
  v_cvt_pk_bf16_f32 v193, v178, v179
  v_mfma_f32_32x32x16_bf16 v[128:143], a[88:91], v[200:203], v[128:143]
  buffer_load_dwordx4 v1, s[12:15], s28 offen offset:1024 lds
  v_exp_f32 v182, v150
  v_exp_f32 v183, v151
  v_mfma_f32_32x32x16_bf16 v[160:175], a[44:47], v[228:231], v[160:175]
  v_exp_f32 v184, v152
  v_exp_f32 v185, v153
  v_cvt_pk_bf16_f32 v194, v180, v181
  v_cvt_pk_bf16_f32 v195, v182, v183
  v_mfma_f32_32x32x16_bf16 v[112:127], a[84:87], v[204:207], v[112:127]
  v_exp_f32 v186, v154
  v_exp_f32 v187, v155
  v_exp_f32 v188, v156
  v_mfma_f32_32x32x16_bf16 v[128:143], a[92:95], v[204:207], v[128:143]
  v_exp_f32 v189, v157
  v_exp_f32 v190, v158
  v_exp_f32 v191, v159
  v_cvt_pk_bf16_f32 v196, v184, v185
  v_cvt_pk_bf16_f32 v197, v186, v187
  v_mfma_f32_32x32x16_bf16 v[144:159], a[36:39], v[232:235], 0
  s_nop 0
  v_exp_f32 v176, v160
  v_exp_f32 v177, v161
  v_exp_f32 v178, v162
  v_mfma_f32_32x32x16_bf16 v[16:31], a[96:99], v[192:195], v[16:31]
  ds_read_b128 a[20:23], v3 offset:30720
  v_exp_f32 v179, v163
  v_exp_f32 v180, v164
  v_cvt_pk_bf16_f32 v200, v176, v177
  v_mfma_f32_32x32x16_bf16 v[144:159], a[40:43], v[236:239], v[144:159]
  ds_read_b128 a[60:63], v2 offset:34816
  v_exp_f32 v181, v165
  v_cvt_pk_bf16_f32 v198, v188, v189
  v_cvt_pk_bf16_f32 v199, v190, v191
  v_cvt_pk_bf16_f32 v201, v178, v179
  v_mfma_f32_32x32x16_bf16 v[32:47], a[104:107], v[192:195], v[32:47]
  ds_read_b128 a[72:75], v3 offset:33792
  v_exp_f32 v182, v166
  v_exp_f32 v183, v167
  v_cvt_pk_bf16_f32 v202, v180, v181
  v_mfma_f32_32x32x16_bf16 v[144:159], a[44:47], v[240:243], v[144:159]
  buffer_load_dwordx4 v1, s[12:15], s28 offen offset:2048 lds
  v_exp_f32 v184, v168
  v_exp_f32 v185, v169
  v_mfma_f32_32x32x16_bf16 v[16:31], a[100:103], v[196:199], v[16:31]
  v_exp_f32 v186, v170
  v_exp_f32 v187, v171
  v_cvt_pk_bf16_f32 v203, v182, v183
  v_cvt_pk_bf16_f32 v204, v184, v185
  v_mfma_f32_32x32x16_bf16 v[32:47], a[108:111], v[196:199], v[32:47]
  s_waitcnt lgkmcnt(4)
  v_exp_f32 v188, v172
  v_exp_f32 v189, v173
  v_exp_f32 v190, v174
  v_exp_f32 v191, v175
  v_cvt_pk_bf16_f32 v205, v186, v187
  v_mfma_f32_32x32x16_bf16 v[160:175], a[0:3], v[208:211], 0
  ds_read_b128 a[12:15], v3 offset:28672
  v_exp_f32 v176, v144
  v_exp_f32 v177, v145
  v_exp_f32 v178, v146
  v_mfma_f32_32x32x16_bf16 v[48:63], a[96:99], v[200:203], v[48:63]
  ds_read_b128 a[16:19], v3 offset:29696
  v_exp_f32 v179, v147
  v_exp_f32 v180, v148
  v_cvt_pk_bf16_f32 v192, v176, v177
  v_mfma_f32_32x32x16_bf16 v[160:175], a[4:7], v[212:215], v[160:175]
  ds_read_b128 a[48:51], v2 offset:31744
  v_exp_f32 v181, v149
  v_cvt_pk_bf16_f32 v206, v188, v189
  v_cvt_pk_bf16_f32 v207, v190, v191
  v_cvt_pk_bf16_f32 v193, v178, v179
  v_mfma_f32_32x32x16_bf16 v[64:79], a[104:107], v[200:203], v[64:79]
  ds_read_b128 a[52:55], v2 offset:32768
  v_exp_f32 v182, v150
  v_exp_f32 v183, v151
  v_cvt_pk_bf16_f32 v194, v180, v181
  v_mfma_f32_32x32x16_bf16 v[160:175], a[8:11], v[216:219], v[160:175]
  v_exp_f32 v184, v152
  v_exp_f32 v185, v153
  v_exp_f32 v186, v154
  v_mfma_f32_32x32x16_bf16 v[48:63], a[100:103], v[204:207], v[48:63]
  v_exp_f32 v187, v155
  v_exp_f32 v188, v156
  v_cvt_pk_bf16_f32 v195, v182, v183
  v_cvt_pk_bf16_f32 v196, v184, v185
  v_mfma_f32_32x32x16_bf16 v[64:79], a[108:111], v[204:207], v[64:79]
  v_exp_f32 v189, v157
  v_exp_f32 v190, v158
  v_exp_f32 v191, v159
  v_cvt_pk_bf16_f32 v197, v186, v187
  v_mfma_f32_32x32x16_bf16 v[144:159], a[0:3], v[220:223], 0
  ds_read_b128 a[68:71], v3 offset:32768
  v_exp_f32 v176, v160
  v_exp_f32 v177, v161
  v_exp_f32 v178, v162
  v_mfma_f32_32x32x16_bf16 v[80:95], a[96:99], v[192:195], v[80:95]
  ds_read_b128 a[32:35], v4 offset:30720
  v_exp_f32 v179, v163
  v_exp_f32 v180, v164
  v_cvt_pk_bf16_f32 v200, v176, v177
  v_mfma_f32_32x32x16_bf16 v[144:159], a[4:7], v[224:227], v[144:159]
  ds_read_b128 a[84:87], v4 offset:32768
  v_exp_f32 v181, v165
  v_cvt_pk_bf16_f32 v198, v188, v189
  v_cvt_pk_bf16_f32 v199, v190, v191
  v_cvt_pk_bf16_f32 v201, v178, v179
  v_mfma_f32_32x32x16_bf16 v[96:111], a[104:107], v[192:195], v[96:111]
  ds_read_b128 a[40:43], v5 offset:29696
  v_exp_f32 v182, v166
  v_exp_f32 v183, v167
  v_cvt_pk_bf16_f32 v202, v180, v181
  v_mfma_f32_32x32x16_bf16 v[144:159], a[8:11], v[228:231], v[144:159]
  v_exp_f32 v184, v168
  v_exp_f32 v185, v169
  v_exp_f32 v186, v170
  v_mfma_f32_32x32x16_bf16 v[80:95], a[100:103], v[196:199], v[80:95]
  v_exp_f32 v187, v171
  v_exp_f32 v188, v172
  v_cvt_pk_bf16_f32 v203, v182, v183
  v_cvt_pk_bf16_f32 v204, v184, v185
  v_mfma_f32_32x32x16_bf16 v[96:111], a[108:111], v[196:199], v[96:111]
  s_waitcnt lgkmcnt(6)
  v_exp_f32 v189, v173
  v_exp_f32 v190, v174
  v_exp_f32 v191, v175
  v_cvt_pk_bf16_f32 v205, v186, v187
  v_mfma_f32_32x32x16_bf16 v[160:175], a[12:15], v[208:211], 0
  s_waitcnt lgkmcnt(4)
  v_exp_f32 v176, v144
  v_exp_f32 v177, v145
  v_exp_f32 v178, v146
  v_mfma_f32_32x32x16_bf16 v[16:31], a[48:51], v[200:203], v[16:31]
  ds_read_b128 a[64:67], v3 offset:31744
  v_exp_f32 v179, v147
  v_exp_f32 v180, v148
  v_cvt_pk_bf16_f32 v192, v176, v177
  v_mfma_f32_32x32x16_bf16 v[160:175], a[16:19], v[212:215], v[160:175]
  ds_read_b128 a[88:91], v4 offset:33792
  v_exp_f32 v181, v149
  v_cvt_pk_bf16_f32 v206, v188, v189
  v_cvt_pk_bf16_f32 v207, v190, v191
  v_cvt_pk_bf16_f32 v193, v178, v179
  v_mfma_f32_32x32x16_bf16 v[32:47], a[56:59], v[200:203], v[32:47]
  ds_read_b128 a[100:103], v5 offset:32768
  v_exp_f32 v182, v150
  v_exp_f32 v183, v151
  v_cvt_pk_bf16_f32 v194, v180, v181
  v_mfma_f32_32x32x16_bf16 v[160:175], a[20:23], v[216:219], v[160:175]
  ds_read_b128 a[108:111], v5 offset:34816
  v_exp_f32 v184, v152
  v_exp_f32 v185, v153
  v_cvt_pk_bf16_f32 v195, v182, v183
  v_mfma_f32_32x32x16_bf16 v[16:31], a[52:55], v[204:207], v[16:31]
  v_exp_f32 v186, v154
  v_exp_f32 v187, v155
  v_exp_f32 v188, v156
  v_mfma_f32_32x32x16_bf16 v[32:47], a[60:63], v[204:207], v[32:47]
  v_exp_f32 v189, v157
  v_exp_f32 v190, v158
  v_exp_f32 v191, v159
  v_cvt_pk_bf16_f32 v196, v184, v185
  v_cvt_pk_bf16_f32 v197, v186, v187
  v_mfma_f32_32x32x16_bf16 v[144:159], a[12:15], v[220:223], 0
  ds_read_b128 a[28:31], v4 offset:29696
  v_exp_f32 v176, v160
  v_exp_f32 v177, v161
  v_exp_f32 v178, v162
  v_mfma_f32_32x32x16_bf16 v[48:63], a[48:51], v[192:195], v[48:63]
  ds_read_b128 a[80:83], v4 offset:31744
  v_exp_f32 v179, v163
  v_exp_f32 v180, v164
  v_cvt_pk_bf16_f32 v200, v176, v177
  v_mfma_f32_32x32x16_bf16 v[144:159], a[16:19], v[224:227], v[144:159]
  ds_read_b128 a[44:47], v5 offset:30720
  v_exp_f32 v181, v165
  v_cvt_pk_bf16_f32 v198, v188, v189
  v_cvt_pk_bf16_f32 v199, v190, v191
  v_cvt_pk_bf16_f32 v201, v178, v179
  v_mfma_f32_32x32x16_bf16 v[64:79], a[56:59], v[192:195], v[64:79]
  ds_read_b128 a[104:107], v5 offset:33792
  v_exp_f32 v182, v166
  v_exp_f32 v183, v167
  v_cvt_pk_bf16_f32 v202, v180, v181
  v_mfma_f32_32x32x16_bf16 v[144:159], a[20:23], v[228:231], v[144:159]
  s_add_u32 s20, s20, 28672
  v_exp_f32 v184, v168
  v_exp_f32 v185, v169
  v_exp_f32 v186, v170
  v_mfma_f32_32x32x16_bf16 v[48:63], a[52:55], v[196:199], v[48:63]
  s_cmp_ge_u32 s20, s21
  s_cselect_b32 s25, 401408, 0
  v_exp_f32 v187, v171
  v_exp_f32 v188, v172
  v_cvt_pk_bf16_f32 v203, v182, v183
  v_mfma_f32_32x32x16_bf16 v[64:79], a[60:63], v[196:199], v[64:79]
  s_sub_u32 s20, s20, s25
  v_exp_f32 v189, v173
  v_exp_f32 v190, v174
  v_exp_f32 v191, v175
  v_cvt_pk_bf16_f32 v204, v184, v185
  v_cvt_pk_bf16_f32 v205, v186, v187
  v_mfma_f32_32x32x16_bf16 v[160:175], a[12:15], v[232:235], 0
  s_waitcnt lgkmcnt(7)
  v_exp_f32 v176, v144
  v_exp_f32 v177, v145
  v_exp_f32 v178, v146
  v_mfma_f32_32x32x16_bf16 v[16:31], a[64:67], v[200:203], v[16:31]
  ds_read_b128 a[92:95], v4 offset:34816
  v_exp_f32 v179, v147
  v_exp_f32 v180, v148
  v_cvt_pk_bf16_f32 v192, v176, v177
  v_mfma_f32_32x32x16_bf16 v[160:175], a[16:19], v[236:239], v[160:175]
  ds_read_b128 a[36:39], v5 offset:28672
  v_exp_f32 v181, v149
  v_cvt_pk_bf16_f32 v206, v188, v189
  v_cvt_pk_bf16_f32 v207, v190, v191
  v_cvt_pk_bf16_f32 v193, v178, v179
  v_mfma_f32_32x32x16_bf16 v[32:47], a[72:75], v[200:203], v[32:47]
  ds_read_b128 a[96:99], v5 offset:31744
  v_exp_f32 v182, v150
  v_exp_f32 v183, v151
  v_cvt_pk_bf16_f32 v194, v180, v181
  v_mfma_f32_32x32x16_bf16 v[160:175], a[20:23], v[240:243], v[160:175]
  s_add_u32 s28, s20, 4096
  v_exp_f32 v184, v152
  v_exp_f32 v185, v153
  v_exp_f32 v186, v154
  v_mfma_f32_32x32x16_bf16 v[16:31], a[68:71], v[204:207], v[16:31]
  v_exp_f32 v187, v155
  v_exp_f32 v188, v156
  v_cvt_pk_bf16_f32 v195, v182, v183
  v_cvt_pk_bf16_f32 v196, v184, v185
  v_mfma_f32_32x32x16_bf16 v[32:47], a[76:79], v[204:207], v[32:47]
  s_waitcnt lgkmcnt(6)
  v_exp_f32 v189, v157
  v_exp_f32 v190, v158
  v_exp_f32 v191, v159
  v_cvt_pk_bf16_f32 v197, v186, v187
  v_mfma_f32_32x32x16_bf16 v[144:159], a[24:27], v[208:211], 0
  v_exp_f32 v176, v160
  v_exp_f32 v177, v161
  v_exp_f32 v178, v162
  v_mfma_f32_32x32x16_bf16 v[48:63], a[64:67], v[192:195], v[48:63]
  v_exp_f32 v179, v163
  v_exp_f32 v180, v164
  v_exp_f32 v181, v165
  v_mfma_f32_32x32x16_bf16 v[144:159], a[28:31], v[212:215], v[144:159]
  v_exp_f32 v182, v166
  v_cvt_pk_bf16_f32 v198, v188, v189
  v_cvt_pk_bf16_f32 v199, v190, v191
  v_cvt_pk_bf16_f32 v200, v176, v177
  v_cvt_pk_bf16_f32 v201, v178, v179
  v_mfma_f32_32x32x16_bf16 v[64:79], a[72:75], v[192:195], v[64:79]
  v_exp_f32 v183, v167
  v_exp_f32 v184, v168
  v_exp_f32 v185, v169
  v_mfma_f32_32x32x16_bf16 v[144:159], a[32:35], v[216:219], v[144:159]
  v_exp_f32 v186, v170
  v_exp_f32 v187, v171
  v_cvt_pk_bf16_f32 v202, v180, v181
  v_cvt_pk_bf16_f32 v203, v182, v183
  v_mfma_f32_32x32x16_bf16 v[48:63], a[68:71], v[196:199], v[48:63]
  v_exp_f32 v188, v172
  v_exp_f32 v189, v173
  v_cvt_pk_bf16_f32 v204, v184, v185
  v_cvt_pk_bf16_f32 v205, v186, v187
  v_mfma_f32_32x32x16_bf16 v[64:79], a[76:79], v[196:199], v[64:79]
  v_exp_f32 v190, v174
  v_exp_f32 v191, v175
  v_add_u32 v3, s23, v3
  v_add_u32 v4, s23, v4
  v_mfma_f32_32x32x16_bf16 v[160:175], a[24:27], v[220:223], 0
  s_waitcnt vmcnt(0) lgkmcnt(0)
  v_exp_f32 v176, v144
  v_exp_f32 v177, v145
  v_exp_f32 v178, v146
  v_mfma_f32_32x32x16_bf16 v[80:95], a[64:67], v[200:203], v[80:95]
  s_barrier
  v_exp_f32 v179, v147
  v_exp_f32 v180, v148
  v_exp_f32 v181, v149
  v_mfma_f32_32x32x16_bf16 v[160:175], a[28:31], v[224:227], v[160:175]
  s_add_u32 m0, s22, 28672
  v_exp_f32 v182, v150
  v_cvt_pk_bf16_f32 v206, v188, v189
  v_cvt_pk_bf16_f32 v207, v190, v191
  v_cvt_pk_bf16_f32 v192, v176, v177
  v_cvt_pk_bf16_f32 v193, v178, v179
  v_mfma_f32_32x32x16_bf16 v[96:111], a[72:75], v[200:203], v[96:111]
  buffer_load_dwordx4 v1, s[12:15], s20 offen offset:0 lds
  v_exp_f32 v183, v151
  v_exp_f32 v184, v152
  v_mfma_f32_32x32x16_bf16 v[160:175], a[32:35], v[228:231], v[160:175]
  buffer_load_dwordx4 v1, s[12:15], s20 offen offset:1024 lds
  v_exp_f32 v185, v153
  v_cvt_pk_bf16_f32 v194, v180, v181
  v_cvt_pk_bf16_f32 v195, v182, v183
  v_mfma_f32_32x32x16_bf16 v[80:95], a[68:71], v[204:207], v[80:95]
  v_exp_f32 v186, v154
  v_exp_f32 v187, v155
  v_exp_f32 v188, v156
  v_mfma_f32_32x32x16_bf16 v[96:111], a[76:79], v[204:207], v[96:111]
  v_exp_f32 v189, v157
  v_exp_f32 v190, v158
  v_exp_f32 v191, v159
  v_cvt_pk_bf16_f32 v196, v184, v185
  v_cvt_pk_bf16_f32 v197, v186, v187
  v_add_u32 v2, s23, v2
  v_mfma_f32_32x32x16_bf16 v[144:159], a[24:27], v[244:247], 0
  s_nop 0
  v_exp_f32 v176, v160
  v_exp_f32 v177, v161
  v_exp_f32 v178, v162
  v_mfma_f32_32x32x16_bf16 v[16:31], a[80:83], v[192:195], v[16:31]
  ds_read_b128 a[4:7], v2 offset:1024
  v_exp_f32 v179, v163
  v_exp_f32 v180, v164
  v_cvt_pk_bf16_f32 v200, v176, v177
  v_mfma_f32_32x32x16_bf16 v[144:159], a[28:31], v[248:251], v[144:159]
  ds_read_b128 a[12:15], v3 offset:0
  v_exp_f32 v181, v165
  v_cvt_pk_bf16_f32 v198, v188, v189
  v_cvt_pk_bf16_f32 v199, v190, v191
  v_cvt_pk_bf16_f32 v201, v178, v179
  v_mfma_f32_32x32x16_bf16 v[32:47], a[88:91], v[192:195], v[32:47]
  ds_read_b128 a[68:71], v3 offset:4096
  v_exp_f32 v182, v166
  v_exp_f32 v183, v167
  v_cvt_pk_bf16_f32 v202, v180, v181
  v_mfma_f32_32x32x16_bf16 v[144:159], a[32:35], v[252:255], v[144:159]
  buffer_load_dwordx4 v1, s[12:15], s20 offen offset:2048 lds
  v_exp_f32 v184, v168
  v_exp_f32 v185, v169
  v_mfma_f32_32x32x16_bf16 v[16:31], a[84:87], v[196:199], v[16:31]
  v_exp_f32 v186, v170
  v_exp_f32 v187, v171
  v_cvt_pk_bf16_f32 v203, v182, v183
  v_cvt_pk_bf16_f32 v204, v184, v185
  v_mfma_f32_32x32x16_bf16 v[32:47], a[92:95], v[196:199], v[32:47]
  s_nop 0
  v_exp_f32 v188, v172
  v_exp_f32 v189, v173
  v_exp_f32 v190, v174
  v_exp_f32 v191, v175
  v_cvt_pk_bf16_f32 v205, v186, v187
  v_mfma_f32_32x32x16_bf16 v[160:175], a[36:39], v[208:211], 0
  ds_read_b128 a[0:3], v2 offset:0
  v_exp_f32 v176, v144
  v_exp_f32 v177, v145
  v_exp_f32 v178, v146
  v_mfma_f32_32x32x16_bf16 v[48:63], a[80:83], v[200:203], v[48:63]
  ds_read_b128 a[60:63], v2 offset:6144
  v_exp_f32 v179, v147
  v_exp_f32 v180, v148
  v_cvt_pk_bf16_f32 v192, v176, v177
  v_mfma_f32_32x32x16_bf16 v[160:175], a[40:43], v[212:215], v[160:175]
  ds_read_b128 a[24:27], v4 offset:0
  v_exp_f32 v181, v149
  v_cvt_pk_bf16_f32 v206, v188, v189
  v_cvt_pk_bf16_f32 v207, v190, v191
  v_cvt_pk_bf16_f32 v193, v178, v179
  v_mfma_f32_32x32x16_bf16 v[64:79], a[88:91], v[200:203], v[64:79]
  buffer_load_dwordx4 v1, s[12:15], s20 offen offset:3072 lds
  v_exp_f32 v182, v150
  v_exp_f32 v183, v151
  v_mfma_f32_32x32x16_bf16 v[160:175], a[44:47], v[216:219], v[160:175]
  v_exp_f32 v184, v152
  v_exp_f32 v185, v153
  v_cvt_pk_bf16_f32 v194, v180, v181
  v_cvt_pk_bf16_f32 v195, v182, v183
  v_mfma_f32_32x32x16_bf16 v[48:63], a[84:87], v[204:207], v[48:63]
  v_exp_f32 v186, v154
  v_exp_f32 v187, v155
  v_exp_f32 v188, v156
  v_mfma_f32_32x32x16_bf16 v[64:79], a[92:95], v[204:207], v[64:79]
  v_exp_f32 v189, v157
  v_exp_f32 v190, v158
  v_exp_f32 v191, v159
  v_cvt_pk_bf16_f32 v196, v184, v185
  v_cvt_pk_bf16_f32 v197, v186, v187
  v_add_u32 v5, s23, v5
  v_mfma_f32_32x32x16_bf16 v[144:159], a[36:39], v[220:223], 0
  ds_read_b128 a[8:11], v2 offset:2048
  v_exp_f32 v176, v160
  v_exp_f32 v177, v161
  v_exp_f32 v178, v162
  v_mfma_f32_32x32x16_bf16 v[112:127], a[80:83], v[192:195], v[112:127]
  ds_read_b128 a[56:59], v2 offset:5120
  v_exp_f32 v179, v163
  v_exp_f32 v180, v164
  v_cvt_pk_bf16_f32 v200, v176, v177
  v_mfma_f32_32x32x16_bf16 v[144:159], a[40:43], v[224:227], v[144:159]
  ds_read_b128 a[72:75], v3 offset:5120
  v_exp_f32 v181, v165
  v_cvt_pk_bf16_f32 v198, v188, v189
  v_cvt_pk_bf16_f32 v199, v190, v191
  v_cvt_pk_bf16_f32 v201, v178, v179
  v_mfma_f32_32x32x16_bf16 v[128:143], a[88:91], v[192:195], v[128:143]
  s_add_u32 m0, s22, 32768
  v_exp_f32 v182, v166
  v_exp_f32 v183, v167
  v_exp_f32 v184, v168
  v_mfma_f32_32x32x16_bf16 v[144:159], a[44:47], v[228:231], v[144:159]
  buffer_load_dwordx4 v1, s[12:15], s28 offen offset:0 lds
  v_exp_f32 v185, v169
  v_cvt_pk_bf16_f32 v202, v180, v181
  v_cvt_pk_bf16_f32 v203, v182, v183
  v_mfma_f32_32x32x16_bf16 v[112:127], a[84:87], v[196:199], v[112:127]
  v_exp_f32 v186, v170
  v_exp_f32 v187, v171
  v_exp_f32 v188, v172
  v_mfma_f32_32x32x16_bf16 v[128:143], a[92:95], v[196:199], v[128:143]
  v_exp_f32 v189, v173
  v_exp_f32 v190, v174
  v_exp_f32 v191, v175
  v_cvt_pk_bf16_f32 v204, v184, v185
  v_cvt_pk_bf16_f32 v205, v186, v187
  v_mfma_f32_32x32x16_bf16 v[160:175], a[36:39], v[232:235], 0
  s_nop 0
  v_exp_f32 v176, v144
  v_exp_f32 v177, v145
  v_exp_f32 v178, v146
  v_mfma_f32_32x32x16_bf16 v[16:31], a[96:99], v[200:203], v[16:31]
  buffer_load_dwordx4 v1, s[12:15], s28 offen offset:1024 lds
  v_exp_f32 v179, v147
  v_exp_f32 v180, v148
  v_mfma_f32_32x32x16_bf16 v[160:175], a[40:43], v[236:239], v[160:175]
  buffer_load_dwordx4 v1, s[12:15], s28 offen offset:2048 lds
  v_cvt_pk_bf16_f32 v206, v188, v189
  v_cvt_pk_bf16_f32 v207, v190, v191
  v_cvt_pk_bf16_f32 v192, v176, v177
  v_cvt_pk_bf16_f32 v193, v178, v179
  v_mfma_f32_32x32x16_bf16 v[32:47], a[104:107], v[200:203], v[32:47]
  v_exp_f32 v181, v149
  v_exp_f32 v182, v150
  v_exp_f32 v183, v151
  v_mfma_f32_32x32x16_bf16 v[160:175], a[44:47], v[240:243], v[160:175]
  v_exp_f32 v184, v152
  v_exp_f32 v185, v153
  v_cvt_pk_bf16_f32 v194, v180, v181
  v_cvt_pk_bf16_f32 v195, v182, v183
  v_mfma_f32_32x32x16_bf16 v[16:31], a[100:103], v[204:207], v[16:31]
  v_exp_f32 v186, v154
  v_exp_f32 v187, v155
  v_exp_f32 v188, v156
  v_mfma_f32_32x32x16_bf16 v[32:47], a[108:111], v[204:207], v[32:47]
  s_waitcnt lgkmcnt(2)
  v_exp_f32 v189, v157
  v_exp_f32 v190, v158
  v_exp_f32 v191, v159
  v_cvt_pk_bf16_f32 v196, v184, v185
  v_cvt_pk_bf16_f32 v197, v186, v187
  v_mfma_f32_32x32x16_bf16 v[144:159], a[0:3], v[208:211], 0
  ds_read_b128 a[16:19], v3 offset:1024
  v_exp_f32 v176, v160
  v_exp_f32 v177, v161
  v_exp_f32 v178, v162
  v_mfma_f32_32x32x16_bf16 v[48:63], a[96:99], v[192:195], v[48:63]
  ds_read_b128 a[20:23], v3 offset:2048
  v_exp_f32 v179, v163
  v_exp_f32 v180, v164
  v_cvt_pk_bf16_f32 v200, v176, v177
  v_mfma_f32_32x32x16_bf16 v[144:159], a[4:7], v[212:215], v[144:159]
  ds_read_b128 a[48:51], v2 offset:3072
  v_exp_f32 v181, v165
  v_cvt_pk_bf16_f32 v198, v188, v189
  v_cvt_pk_bf16_f32 v199, v190, v191
  v_cvt_pk_bf16_f32 v201, v178, v179
  v_mfma_f32_32x32x16_bf16 v[64:79], a[104:107], v[192:195], v[64:79]
  ds_read_b128 a[52:55], v2 offset:4096
  v_exp_f32 v182, v166
  v_exp_f32 v183, v167
  v_cvt_pk_bf16_f32 v202, v180, v181
  v_mfma_f32_32x32x16_bf16 v[144:159], a[8:11], v[216:219], v[144:159]
  v_exp_f32 v184, v168
  v_exp_f32 v185, v169
  v_exp_f32 v186, v170
  v_mfma_f32_32x32x16_bf16 v[48:63], a[100:103], v[196:199], v[48:63]
  v_exp_f32 v187, v171
  v_exp_f32 v188, v172
  v_cvt_pk_bf16_f32 v203, v182, v183
  v_cvt_pk_bf16_f32 v204, v184, v185
  v_mfma_f32_32x32x16_bf16 v[64:79], a[108:111], v[196:199], v[64:79]
  v_exp_f32 v189, v173
  v_exp_f32 v190, v174
  v_exp_f32 v191, v175
  v_cvt_pk_bf16_f32 v205, v186, v187
  s_sub_u32 s22, s22, s23
  s_sub_u32 s23, 0, s23
  s_add_u32 s24, s24, 2
  s_cmp_lt_u32 s24, 12
  s_cbranch_scc1 L_loop_W
  v_mfma_f32_32x32x16_bf16 v[160:175], a[0:3], v[220:223], 0
  ds_read_b128 a[64:67], v3 offset:3072
  v_exp_f32 v176, v144
  v_exp_f32 v177, v145
  v_exp_f32 v178, v146
  v_mfma_f32_32x32x16_bf16 v[80:95], a[96:99], v[200:203], v[80:95]
  ds_read_b128 a[84:87], v4 offset:4096
  v_exp_f32 v179, v147
  v_exp_f32 v180, v148
  v_cvt_pk_bf16_f32 v192, v176, v177
  v_mfma_f32_32x32x16_bf16 v[160:175], a[4:7], v[224:227], v[160:175]
  ds_read_b128 a[92:95], v4 offset:6144
  v_exp_f32 v181, v149
  v_cvt_pk_bf16_f32 v206, v188, v189
  v_cvt_pk_bf16_f32 v207, v190, v191
  v_cvt_pk_bf16_f32 v193, v178, v179
  v_mfma_f32_32x32x16_bf16 v[96:111], a[104:107], v[200:203], v[96:111]
  ds_read_b128 a[44:47], v5 offset:2048
  v_exp_f32 v182, v150
  v_exp_f32 v183, v151
  v_cvt_pk_bf16_f32 v194, v180, v181
  v_mfma_f32_32x32x16_bf16 v[160:175], a[8:11], v[228:231], v[160:175]
  v_exp_f32 v184, v152
  v_exp_f32 v185, v153
  v_exp_f32 v186, v154
  v_mfma_f32_32x32x16_bf16 v[80:95], a[100:103], v[204:207], v[80:95]
  v_exp_f32 v187, v155
  v_exp_f32 v188, v156
  v_cvt_pk_bf16_f32 v195, v182, v183
  v_cvt_pk_bf16_f32 v196, v184, v185
  v_mfma_f32_32x32x16_bf16 v[96:111], a[108:111], v[204:207], v[96:111]
  s_waitcnt lgkmcnt(0)
  v_exp_f32 v189, v157
  v_exp_f32 v190, v158
  v_exp_f32 v191, v159
  v_cvt_pk_bf16_f32 v197, v186, v187
  v_mfma_f32_32x32x16_bf16 v[144:159], a[12:15], v[208:211], 0
  s_waitcnt lgkmcnt(0)
  v_exp_f32 v176, v160
  v_exp_f32 v177, v161
  v_exp_f32 v178, v162
  v_mfma_f32_32x32x16_bf16 v[16:31], a[48:51], v[192:195], v[16:31]
  ds_read_b128 a[76:79], v3 offset:6144
  v_exp_f32 v179, v163
  v_exp_f32 v180, v164
  v_cvt_pk_bf16_f32 v200, v176, v177
  v_mfma_f32_32x32x16_bf16 v[144:159], a[16:19], v[212:215], v[144:159]
  ds_read_b128 a[28:31], v4 offset:1024
  v_exp_f32 v181, v165
  v_cvt_pk_bf16_f32 v198, v188, v189
  v_cvt_pk_bf16_f32 v199, v190, v191
  v_cvt_pk_bf16_f32 v201, v178, v179
  v_mfma_f32_32x32x16_bf16 v[32:47], a[56:59], v[192:195], v[32:47]
  ds_read_b128 a[40:43], v5 offset:1024
  v_exp_f32 v182, v166
  v_exp_f32 v183, v167
  v_cvt_pk_bf16_f32 v202, v180, v181
  v_mfma_f32_32x32x16_bf16 v[144:159], a[20:23], v[216:219], v[144:159]
  ds_read_b128 a[96:99], v5 offset:3072
  v_exp_f32 v184, v168
  v_exp_f32 v185, v169
  v_cvt_pk_bf16_f32 v203, v182, v183
  v_mfma_f32_32x32x16_bf16 v[16:31], a[52:55], v[196:199], v[16:31]
  v_exp_f32 v186, v170
  v_exp_f32 v187, v171
  v_exp_f32 v188, v172
  v_mfma_f32_32x32x16_bf16 v[32:47], a[60:63], v[196:199], v[32:47]
  v_exp_f32 v189, v173
  v_exp_f32 v190, v174
  v_exp_f32 v191, v175
  v_cvt_pk_bf16_f32 v204, v184, v185
  v_cvt_pk_bf16_f32 v205, v186, v187
  v_mfma_f32_32x32x16_bf16 v[160:175], a[12:15], v[220:223], 0
  ds_read_b128 a[32:35], v4 offset:2048
  v_exp_f32 v176, v144
  v_exp_f32 v177, v145
  v_exp_f32 v178, v146
  v_mfma_f32_32x32x16_bf16 v[48:63], a[48:51], v[200:203], v[48:63]
  ds_read_b128 a[88:91], v4 offset:5120
  v_exp_f32 v179, v147
  v_exp_f32 v180, v148
  v_cvt_pk_bf16_f32 v192, v176, v177
  v_mfma_f32_32x32x16_bf16 v[160:175], a[16:19], v[224:227], v[160:175]
  ds_read_b128 a[36:39], v5 offset:0
  v_exp_f32 v181, v149
  v_cvt_pk_bf16_f32 v206, v188, v189
  v_cvt_pk_bf16_f32 v207, v190, v191
  v_cvt_pk_bf16_f32 v193, v178, v179
  v_mfma_f32_32x32x16_bf16 v[64:79], a[56:59], v[200:203], v[64:79]
  ds_read_b128 a[108:111], v5 offset:6144
  v_exp_f32 v182, v150
  v_exp_f32 v183, v151
  v_cvt_pk_bf16_f32 v194, v180, v181
  v_mfma_f32_32x32x16_bf16 v[160:175], a[20:23], v[228:231], v[160:175]
  v_exp_f32 v184, v152
  v_exp_f32 v185, v153
  v_exp_f32 v186, v154
  v_mfma_f32_32x32x16_bf16 v[48:63], a[52:55], v[204:207], v[48:63]
  v_exp_f32 v187, v155
  v_exp_f32 v188, v156
  v_cvt_pk_bf16_f32 v195, v182, v183
  v_cvt_pk_bf16_f32 v196, v184, v185
  v_mfma_f32_32x32x16_bf16 v[64:79], a[60:63], v[204:207], v[64:79]
  v_exp_f32 v189, v157
  v_exp_f32 v190, v158
  v_exp_f32 v191, v159
  v_cvt_pk_bf16_f32 v197, v186, v187
  v_mfma_f32_32x32x16_bf16 v[144:159], a[12:15], v[232:235], 0
  s_waitcnt lgkmcnt(7)
  v_exp_f32 v176, v160
  v_exp_f32 v177, v161
  v_exp_f32 v178, v162
  v_mfma_f32_32x32x16_bf16 v[16:31], a[64:67], v[192:195], v[16:31]
  ds_read_b128 a[80:83], v4 offset:3072
  v_exp_f32 v179, v163
  v_exp_f32 v180, v164
  v_cvt_pk_bf16_f32 v200, v176, v177
  v_mfma_f32_32x32x16_bf16 v[144:159], a[16:19], v[236:239], v[144:159]
  ds_read_b128 a[100:103], v5 offset:4096
  v_exp_f32 v181, v165
  v_cvt_pk_bf16_f32 v198, v188, v189
  v_cvt_pk_bf16_f32 v199, v190, v191
  v_cvt_pk_bf16_f32 v201, v178, v179
  v_mfma_f32_32x32x16_bf16 v[32:47], a[72:75], v[192:195], v[32:47]
  ds_read_b128 a[104:107], v5 offset:5120
  v_exp_f32 v182, v166
  v_exp_f32 v183, v167
  v_cvt_pk_bf16_f32 v202, v180, v181
  v_mfma_f32_32x32x16_bf16 v[144:159], a[20:23], v[240:243], v[144:159]
  v_exp_f32 v184, v168
  v_exp_f32 v185, v169
  v_exp_f32 v186, v170
  v_mfma_f32_32x32x16_bf16 v[16:31], a[68:71], v[196:199], v[16:31]
  v_exp_f32 v187, v171
  v_exp_f32 v188, v172
  v_cvt_pk_bf16_f32 v203, v182, v183
  v_cvt_pk_bf16_f32 v204, v184, v185
  v_mfma_f32_32x32x16_bf16 v[32:47], a[76:79], v[196:199], v[32:47]
  s_waitcnt lgkmcnt(6)
  v_exp_f32 v189, v173
  v_exp_f32 v190, v174
  v_exp_f32 v191, v175
  v_cvt_pk_bf16_f32 v205, v186, v187
  v_mfma_f32_32x32x16_bf16 v[160:175], a[24:27], v[208:211], 0
  v_exp_f32 v176, v144
  v_exp_f32 v177, v145
  v_mfma_f32_32x32x16_bf16 v[48:63], a[64:67], v[200:203], v[48:63]
  v_exp_f32 v178, v146
  v_exp_f32 v179, v147
  v_exp_f32 v180, v148
  v_mfma_f32_32x32x16_bf16 v[160:175], a[28:31], v[212:215], v[160:175]
  v_exp_f32 v181, v149
  v_cvt_pk_bf16_f32 v206, v188, v189
  v_cvt_pk_bf16_f32 v207, v190, v191
  v_cvt_pk_bf16_f32 v192, v176, v177
  v_cvt_pk_bf16_f32 v193, v178, v179
  v_mfma_f32_32x32x16_bf16 v[64:79], a[72:75], v[200:203], v[64:79]
  v_exp_f32 v182, v150
  v_exp_f32 v183, v151
  v_exp_f32 v184, v152
  v_mfma_f32_32x32x16_bf16 v[160:175], a[32:35], v[216:219], v[160:175]
  v_exp_f32 v185, v153
  v_exp_f32 v186, v154
  v_cvt_pk_bf16_f32 v194, v180, v181
  v_cvt_pk_bf16_f32 v195, v182, v183
  v_mfma_f32_32x32x16_bf16 v[48:63], a[68:71], v[204:207], v[48:63]
  v_exp_f32 v187, v155
  v_exp_f32 v188, v156
  v_exp_f32 v189, v157
  v_mfma_f32_32x32x16_bf16 v[64:79], a[76:79], v[204:207], v[64:79]
  v_exp_f32 v190, v158
  v_exp_f32 v191, v159
  v_cvt_pk_bf16_f32 v196, v184, v185
  v_cvt_pk_bf16_f32 v197, v186, v187
  v_mfma_f32_32x32x16_bf16 v[144:159], a[24:27], v[220:223], 0
  s_waitcnt vmcnt(0) lgkmcnt(0)
  v_exp_f32 v176, v160
  v_exp_f32 v177, v161
  v_mfma_f32_32x32x16_bf16 v[80:95], a[64:67], v[192:195], v[80:95]
  s_barrier
  v_exp_f32 v178, v162
  v_exp_f32 v179, v163
  v_exp_f32 v180, v164
  v_mfma_f32_32x32x16_bf16 v[144:159], a[28:31], v[224:227], v[144:159]
  v_exp_f32 v181, v165
  v_cvt_pk_bf16_f32 v198, v188, v189
  v_cvt_pk_bf16_f32 v199, v190, v191
  v_cvt_pk_bf16_f32 v200, v176, v177
  v_cvt_pk_bf16_f32 v201, v178, v179
  v_mfma_f32_32x32x16_bf16 v[96:111], a[72:75], v[192:195], v[96:111]
  v_exp_f32 v182, v166
  v_exp_f32 v183, v167
  v_exp_f32 v184, v168
  v_mfma_f32_32x32x16_bf16 v[144:159], a[32:35], v[228:231], v[144:159]
  v_exp_f32 v185, v169
  v_exp_f32 v186, v170
  v_cvt_pk_bf16_f32 v202, v180, v181
  v_cvt_pk_bf16_f32 v203, v182, v183
  v_mfma_f32_32x32x16_bf16 v[80:95], a[68:71], v[196:199], v[80:95]
  v_exp_f32 v187, v171
  v_exp_f32 v188, v172
  v_exp_f32 v189, v173
  v_mfma_f32_32x32x16_bf16 v[96:111], a[76:79], v[196:199], v[96:111]
  v_exp_f32 v190, v174
  v_exp_f32 v191, v175
  v_cvt_pk_bf16_f32 v204, v184, v185
  v_cvt_pk_bf16_f32 v205, v186, v187
  v_mfma_f32_32x32x16_bf16 v[160:175], a[24:27], v[244:247], 0
  s_nop 0
  v_exp_f32 v176, v144
  v_exp_f32 v177, v145
  v_exp_f32 v178, v146
  v_mfma_f32_32x32x16_bf16 v[16:31], a[80:83], v[200:203], v[16:31]
  ds_read_b128 a[4:7], v2 offset:29696
  v_exp_f32 v179, v147
  v_exp_f32 v180, v148
  v_cvt_pk_bf16_f32 v192, v176, v177
  v_mfma_f32_32x32x16_bf16 v[160:175], a[28:31], v[248:251], v[160:175]
  ds_read_b128 a[56:59], v2 offset:33792
  v_exp_f32 v181, v149
  v_cvt_pk_bf16_f32 v206, v188, v189
  v_cvt_pk_bf16_f32 v207, v190, v191
  v_cvt_pk_bf16_f32 v193, v178, v179
  v_mfma_f32_32x32x16_bf16 v[32:47], a[88:91], v[200:203], v[32:47]
  ds_read_b128 a[76:79], v3 offset:34816
  v_exp_f32 v182, v150
  v_exp_f32 v183, v151
  v_cvt_pk_bf16_f32 v194, v180, v181
  v_mfma_f32_32x32x16_bf16 v[160:175], a[32:35], v[252:255], v[160:175]
  v_exp_f32 v184, v152
  v_exp_f32 v185, v153
  v_exp_f32 v186, v154
  v_mfma_f32_32x32x16_bf16 v[16:31], a[84:87], v[204:207], v[16:31]
  v_exp_f32 v187, v155
  v_exp_f32 v188, v156
  v_cvt_pk_bf16_f32 v195, v182, v183
  v_cvt_pk_bf16_f32 v196, v184, v185
  v_mfma_f32_32x32x16_bf16 v[32:47], a[92:95], v[204:207], v[32:47]
  s_nop 0
  v_exp_f32 v189, v157
  v_exp_f32 v190, v158
  v_exp_f32 v191, v159
  v_cvt_pk_bf16_f32 v197, v186, v187
  v_mfma_f32_32x32x16_bf16 v[144:159], a[36:39], v[208:211], 0
  v_exp_f32 v176, v160
  v_exp_f32 v177, v161
  v_mfma_f32_32x32x16_bf16 v[48:63], a[80:83], v[192:195], v[48:63]
  v_exp_f32 v178, v162
  v_exp_f32 v179, v163
  v_exp_f32 v180, v164
  v_mfma_f32_32x32x16_bf16 v[144:159], a[40:43], v[212:215], v[144:159]
  v_exp_f32 v181, v165
  v_cvt_pk_bf16_f32 v198, v188, v189
  v_cvt_pk_bf16_f32 v199, v190, v191
  v_cvt_pk_bf16_f32 v200, v176, v177
  v_cvt_pk_bf16_f32 v201, v178, v179
  v_mfma_f32_32x32x16_bf16 v[64:79], a[88:91], v[192:195], v[64:79]
  v_exp_f32 v182, v166
  v_exp_f32 v183, v167
  v_exp_f32 v184, v168
  v_mfma_f32_32x32x16_bf16 v[144:159], a[44:47], v[216:219], v[144:159]
  v_exp_f32 v185, v169
  v_exp_f32 v186, v170
  v_cvt_pk_bf16_f32 v202, v180, v181
  v_cvt_pk_bf16_f32 v203, v182, v183
  v_mfma_f32_32x32x16_bf16 v[48:63], a[84:87], v[196:199], v[48:63]
  v_exp_f32 v187, v171
  v_exp_f32 v188, v172
  v_exp_f32 v189, v173
  v_mfma_f32_32x32x16_bf16 v[64:79], a[92:95], v[196:199], v[64:79]
  v_exp_f32 v190, v174
  v_exp_f32 v191, v175
  v_cvt_pk_bf16_f32 v204, v184, v185
  v_cvt_pk_bf16_f32 v205, v186, v187
  v_mfma_f32_32x32x16_bf16 v[160:175], a[36:39], v[220:223], 0
  ds_read_b128 a[0:3], v2 offset:28672
  v_exp_f32 v176, v144
  v_exp_f32 v177, v145
  v_exp_f32 v178, v146
  v_mfma_f32_32x32x16_bf16 v[112:127], a[80:83], v[200:203], v[112:127]
  ds_read_b128 a[8:11], v2 offset:30720
  v_exp_f32 v179, v147
  v_exp_f32 v180, v148
  v_cvt_pk_bf16_f32 v192, v176, v177
  v_mfma_f32_32x32x16_bf16 v[160:175], a[40:43], v[224:227], v[160:175]
  ds_read_b128 a[24:27], v4 offset:28672
  v_exp_f32 v181, v149
  v_cvt_pk_bf16_f32 v206, v188, v189
  v_cvt_pk_bf16_f32 v207, v190, v191
  v_cvt_pk_bf16_f32 v193, v178, v179
  v_mfma_f32_32x32x16_bf16 v[128:143], a[88:91], v[200:203], v[128:143]
  v_exp_f32 v182, v150
  v_exp_f32 v183, v151
  v_exp_f32 v184, v152
  v_mfma_f32_32x32x16_bf16 v[160:175], a[44:47], v[228:231], v[160:175]
  v_exp_f32 v185, v153
  v_exp_f32 v186, v154
  v_cvt_pk_bf16_f32 v194, v180, v181
  v_cvt_pk_bf16_f32 v195, v182, v183
  v_mfma_f32_32x32x16_bf16 v[112:127], a[84:87], v[204:207], v[112:127]
  v_exp_f32 v187, v155
  v_exp_f32 v188, v156
  v_exp_f32 v189, v157
  v_mfma_f32_32x32x16_bf16 v[128:143], a[92:95], v[204:207], v[128:143]
  v_exp_f32 v190, v158
  v_exp_f32 v191, v159
  v_cvt_pk_bf16_f32 v196, v184, v185
  v_cvt_pk_bf16_f32 v197, v186, v187
  v_mfma_f32_32x32x16_bf16 v[144:159], a[36:39], v[232:235], 0
  s_nop 0
  v_exp_f32 v176, v160
  v_exp_f32 v177, v161
  v_exp_f32 v178, v162
  v_mfma_f32_32x32x16_bf16 v[16:31], a[96:99], v[192:195], v[16:31]
  ds_read_b128 a[20:23], v3 offset:30720
  v_exp_f32 v179, v163
  v_exp_f32 v180, v164
  v_cvt_pk_bf16_f32 v200, v176, v177
  v_mfma_f32_32x32x16_bf16 v[144:159], a[40:43], v[236:239], v[144:159]
  ds_read_b128 a[60:63], v2 offset:34816
  v_exp_f32 v181, v165
  v_cvt_pk_bf16_f32 v198, v188, v189
  v_cvt_pk_bf16_f32 v199, v190, v191
  v_cvt_pk_bf16_f32 v201, v178, v179
  v_mfma_f32_32x32x16_bf16 v[32:47], a[104:107], v[192:195], v[32:47]
  ds_read_b128 a[72:75], v3 offset:33792
  v_exp_f32 v182, v166
  v_exp_f32 v183, v167
  v_cvt_pk_bf16_f32 v202, v180, v181
  v_mfma_f32_32x32x16_bf16 v[144:159], a[44:47], v[240:243], v[144:159]
  v_exp_f32 v184, v168
  v_exp_f32 v185, v169
  v_exp_f32 v186, v170
  v_mfma_f32_32x32x16_bf16 v[16:31], a[100:103], v[196:199], v[16:31]
  v_exp_f32 v187, v171
  v_exp_f32 v188, v172
  v_cvt_pk_bf16_f32 v203, v182, v183
  v_cvt_pk_bf16_f32 v204, v184, v185
  v_mfma_f32_32x32x16_bf16 v[32:47], a[108:111], v[196:199], v[32:47]
  s_waitcnt lgkmcnt(4)
  v_exp_f32 v189, v173
  v_exp_f32 v190, v174
  v_exp_f32 v191, v175
  v_cvt_pk_bf16_f32 v205, v186, v187
  v_mfma_f32_32x32x16_bf16 v[160:175], a[0:3], v[208:211], 0
  ds_read_b128 a[12:15], v3 offset:28672
  v_exp_f32 v176, v144
  v_exp_f32 v177, v145
  v_exp_f32 v178, v146
  v_mfma_f32_32x32x16_bf16 v[48:63], a[96:99], v[200:203], v[48:63]
  ds_read_b128 a[16:19], v3 offset:29696
  v_exp_f32 v179, v147
  v_exp_f32 v180, v148
  v_cvt_pk_bf16_f32 v192, v176, v177
  v_mfma_f32_32x32x16_bf16 v[160:175], a[4:7], v[212:215], v[160:175]
  ds_read_b128 a[48:51], v2 offset:31744
  v_exp_f32 v181, v149
  v_cvt_pk_bf16_f32 v206, v188, v189
  v_cvt_pk_bf16_f32 v207, v190, v191
  v_cvt_pk_bf16_f32 v193, v178, v179
  v_mfma_f32_32x32x16_bf16 v[64:79], a[104:107], v[200:203], v[64:79]
  ds_read_b128 a[52:55], v2 offset:32768
  v_exp_f32 v182, v150
  v_exp_f32 v183, v151
  v_cvt_pk_bf16_f32 v194, v180, v181
  v_mfma_f32_32x32x16_bf16 v[160:175], a[8:11], v[216:219], v[160:175]
  v_exp_f32 v184, v152
  v_exp_f32 v185, v153
  v_exp_f32 v186, v154
  v_mfma_f32_32x32x16_bf16 v[48:63], a[100:103], v[204:207], v[48:63]
  v_exp_f32 v187, v155
  v_exp_f32 v188, v156
  v_cvt_pk_bf16_f32 v195, v182, v183
  v_cvt_pk_bf16_f32 v196, v184, v185
  v_mfma_f32_32x32x16_bf16 v[64:79], a[108:111], v[204:207], v[64:79]
  v_exp_f32 v189, v157
  v_exp_f32 v190, v158
  v_exp_f32 v191, v159
  v_cvt_pk_bf16_f32 v197, v186, v187
  v_mfma_f32_32x32x16_bf16 v[144:159], a[0:3], v[220:223], 0
  ds_read_b128 a[68:71], v3 offset:32768
  v_exp_f32 v176, v160
  v_exp_f32 v177, v161
  v_exp_f32 v178, v162
  v_mfma_f32_32x32x16_bf16 v[80:95], a[96:99], v[192:195], v[80:95]
  ds_read_b128 a[32:35], v4 offset:30720
  v_exp_f32 v179, v163
  v_exp_f32 v180, v164
  v_cvt_pk_bf16_f32 v200, v176, v177
  v_mfma_f32_32x32x16_bf16 v[144:159], a[4:7], v[224:227], v[144:159]
  ds_read_b128 a[84:87], v4 offset:32768
  v_exp_f32 v181, v165
  v_cvt_pk_bf16_f32 v198, v188, v189
  v_cvt_pk_bf16_f32 v199, v190, v191
  v_cvt_pk_bf16_f32 v201, v178, v179
  v_mfma_f32_32x32x16_bf16 v[96:111], a[104:107], v[192:195], v[96:111]
  ds_read_b128 a[40:43], v5 offset:29696
  v_exp_f32 v182, v166
  v_exp_f32 v183, v167
  v_cvt_pk_bf16_f32 v202, v180, v181
  v_mfma_f32_32x32x16_bf16 v[144:159], a[8:11], v[228:231], v[144:159]
  v_exp_f32 v184, v168
  v_exp_f32 v185, v169
  v_exp_f32 v186, v170
  v_mfma_f32_32x32x16_bf16 v[80:95], a[100:103], v[196:199], v[80:95]
  v_exp_f32 v187, v171
  v_exp_f32 v188, v172
  v_cvt_pk_bf16_f32 v203, v182, v183
  v_cvt_pk_bf16_f32 v204, v184, v185
  v_mfma_f32_32x32x16_bf16 v[96:111], a[108:111], v[196:199], v[96:111]
  s_waitcnt lgkmcnt(6)
  v_exp_f32 v189, v173
  v_exp_f32 v190, v174
  v_exp_f32 v191, v175
  v_cvt_pk_bf16_f32 v205, v186, v187
  v_mfma_f32_32x32x16_bf16 v[160:175], a[12:15], v[208:211], 0
  s_waitcnt lgkmcnt(4)
  v_exp_f32 v176, v144
  v_exp_f32 v177, v145
  v_exp_f32 v178, v146
  v_mfma_f32_32x32x16_bf16 v[16:31], a[48:51], v[200:203], v[16:31]
  ds_read_b128 a[64:67], v3 offset:31744
  v_exp_f32 v179, v147
  v_exp_f32 v180, v148
  v_cvt_pk_bf16_f32 v192, v176, v177
  v_mfma_f32_32x32x16_bf16 v[160:175], a[16:19], v[212:215], v[160:175]
  ds_read_b128 a[88:91], v4 offset:33792
  v_exp_f32 v181, v149
  v_cvt_pk_bf16_f32 v206, v188, v189
  v_cvt_pk_bf16_f32 v207, v190, v191
  v_cvt_pk_bf16_f32 v193, v178, v179
  v_mfma_f32_32x32x16_bf16 v[32:47], a[56:59], v[200:203], v[32:47]
  ds_read_b128 a[100:103], v5 offset:32768
  v_exp_f32 v182, v150
  v_exp_f32 v183, v151
  v_cvt_pk_bf16_f32 v194, v180, v181
  v_mfma_f32_32x32x16_bf16 v[160:175], a[20:23], v[216:219], v[160:175]
  ds_read_b128 a[108:111], v5 offset:34816
  v_exp_f32 v184, v152
  v_exp_f32 v185, v153
  v_cvt_pk_bf16_f32 v195, v182, v183
  v_mfma_f32_32x32x16_bf16 v[16:31], a[52:55], v[204:207], v[16:31]
  v_exp_f32 v186, v154
  v_exp_f32 v187, v155
  v_exp_f32 v188, v156
  v_mfma_f32_32x32x16_bf16 v[32:47], a[60:63], v[204:207], v[32:47]
  v_exp_f32 v189, v157
  v_exp_f32 v190, v158
  v_exp_f32 v191, v159
  v_cvt_pk_bf16_f32 v196, v184, v185
  v_cvt_pk_bf16_f32 v197, v186, v187
  v_mfma_f32_32x32x16_bf16 v[144:159], a[12:15], v[220:223], 0
  ds_read_b128 a[28:31], v4 offset:29696
  v_exp_f32 v176, v160
  v_exp_f32 v177, v161
  v_exp_f32 v178, v162
  v_mfma_f32_32x32x16_bf16 v[48:63], a[48:51], v[192:195], v[48:63]
  ds_read_b128 a[80:83], v4 offset:31744
  v_exp_f32 v179, v163
  v_exp_f32 v180, v164
  v_cvt_pk_bf16_f32 v200, v176, v177
  v_mfma_f32_32x32x16_bf16 v[144:159], a[16:19], v[224:227], v[144:159]
  ds_read_b128 a[44:47], v5 offset:30720
  v_exp_f32 v181, v165
  v_cvt_pk_bf16_f32 v198, v188, v189
  v_cvt_pk_bf16_f32 v199, v190, v191
  v_cvt_pk_bf16_f32 v201, v178, v179
  v_mfma_f32_32x32x16_bf16 v[64:79], a[56:59], v[192:195], v[64:79]
  ds_read_b128 a[104:107], v5 offset:33792
  v_exp_f32 v182, v166
  v_exp_f32 v183, v167
  v_cvt_pk_bf16_f32 v202, v180, v181
  v_mfma_f32_32x32x16_bf16 v[144:159], a[20:23], v[228:231], v[144:159]
  v_exp_f32 v184, v168
  v_exp_f32 v185, v169
  v_exp_f32 v186, v170
  v_mfma_f32_32x32x16_bf16 v[48:63], a[52:55], v[196:199], v[48:63]
  v_exp_f32 v187, v171
  v_exp_f32 v188, v172
  v_cvt_pk_bf16_f32 v203, v182, v183
  v_cvt_pk_bf16_f32 v204, v184, v185
  v_mfma_f32_32x32x16_bf16 v[64:79], a[60:63], v[196:199], v[64:79]
  v_exp_f32 v189, v173
  v_exp_f32 v190, v174
  v_exp_f32 v191, v175
  v_cvt_pk_bf16_f32 v205, v186, v187
  v_mfma_f32_32x32x16_bf16 v[160:175], a[12:15], v[232:235], 0
  s_waitcnt lgkmcnt(7)
  v_exp_f32 v176, v144
  v_exp_f32 v177, v145
  v_exp_f32 v178, v146
  v_mfma_f32_32x32x16_bf16 v[16:31], a[64:67], v[200:203], v[16:31]
  ds_read_b128 a[92:95], v4 offset:34816
  v_exp_f32 v179, v147
  v_exp_f32 v180, v148
  v_cvt_pk_bf16_f32 v192, v176, v177
  v_mfma_f32_32x32x16_bf16 v[160:175], a[16:19], v[236:239], v[160:175]
  ds_read_b128 a[36:39], v5 offset:28672
  v_exp_f32 v181, v149
  v_cvt_pk_bf16_f32 v206, v188, v189
  v_cvt_pk_bf16_f32 v207, v190, v191
  v_cvt_pk_bf16_f32 v193, v178, v179
  v_mfma_f32_32x32x16_bf16 v[32:47], a[72:75], v[200:203], v[32:47]
  ds_read_b128 a[96:99], v5 offset:31744
  v_exp_f32 v182, v150
  v_exp_f32 v183, v151
  v_cvt_pk_bf16_f32 v194, v180, v181
  v_mfma_f32_32x32x16_bf16 v[160:175], a[20:23], v[240:243], v[160:175]
  v_exp_f32 v184, v152
  v_exp_f32 v185, v153
  v_exp_f32 v186, v154
  v_mfma_f32_32x32x16_bf16 v[16:31], a[68:71], v[204:207], v[16:31]
  v_exp_f32 v187, v155
  v_exp_f32 v188, v156
  v_cvt_pk_bf16_f32 v195, v182, v183
  v_cvt_pk_bf16_f32 v196, v184, v185
  v_mfma_f32_32x32x16_bf16 v[32:47], a[76:79], v[204:207], v[32:47]
  s_waitcnt lgkmcnt(6)
  v_exp_f32 v189, v157
  v_exp_f32 v190, v158
  v_exp_f32 v191, v159
  v_cvt_pk_bf16_f32 v197, v186, v187
  v_mfma_f32_32x32x16_bf16 v[144:159], a[24:27], v[208:211], 0
  v_exp_f32 v176, v160
  v_exp_f32 v177, v161
  v_mfma_f32_32x32x16_bf16 v[48:63], a[64:67], v[192:195], v[48:63]
  v_exp_f32 v178, v162
  v_exp_f32 v179, v163
  v_exp_f32 v180, v164
  v_mfma_f32_32x32x16_bf16 v[144:159], a[28:31], v[212:215], v[144:159]
  v_exp_f32 v181, v165
  v_cvt_pk_bf16_f32 v198, v188, v189
  v_cvt_pk_bf16_f32 v199, v190, v191
  v_cvt_pk_bf16_f32 v200, v176, v177
  v_cvt_pk_bf16_f32 v201, v178, v179
  v_mfma_f32_32x32x16_bf16 v[64:79], a[72:75], v[192:195], v[64:79]
  v_exp_f32 v182, v166
  v_exp_f32 v183, v167
  v_exp_f32 v184, v168
  v_mfma_f32_32x32x16_bf16 v[144:159], a[32:35], v[216:219], v[144:159]
  v_exp_f32 v185, v169
  v_exp_f32 v186, v170
  v_cvt_pk_bf16_f32 v202, v180, v181
  v_cvt_pk_bf16_f32 v203, v182, v183
  v_mfma_f32_32x32x16_bf16 v[48:63], a[68:71], v[196:199], v[48:63]
  v_exp_f32 v187, v171
  v_exp_f32 v188, v172
  v_exp_f32 v189, v173
  v_mfma_f32_32x32x16_bf16 v[64:79], a[76:79], v[196:199], v[64:79]
  v_exp_f32 v190, v174
  v_exp_f32 v191, v175
  v_cvt_pk_bf16_f32 v204, v184, v185
  v_cvt_pk_bf16_f32 v205, v186, v187
  v_mfma_f32_32x32x16_bf16 v[160:175], a[24:27], v[220:223], 0
  v_exp_f32 v176, v144
  v_exp_f32 v177, v145
  v_mfma_f32_32x32x16_bf16 v[80:95], a[64:67], v[200:203], v[80:95]
  v_exp_f32 v178, v146
  v_exp_f32 v179, v147
  v_exp_f32 v180, v148
  v_mfma_f32_32x32x16_bf16 v[160:175], a[28:31], v[224:227], v[160:175]
  v_exp_f32 v181, v149
  v_cvt_pk_bf16_f32 v206, v188, v189
  v_cvt_pk_bf16_f32 v207, v190, v191
  v_cvt_pk_bf16_f32 v192, v176, v177
  v_cvt_pk_bf16_f32 v193, v178, v179
  v_mfma_f32_32x32x16_bf16 v[96:111], a[72:75], v[200:203], v[96:111]
  v_exp_f32 v182, v150
  v_exp_f32 v183, v151
  v_exp_f32 v184, v152
  v_mfma_f32_32x32x16_bf16 v[160:175], a[32:35], v[228:231], v[160:175]
  v_exp_f32 v185, v153
  v_exp_f32 v186, v154
  v_cvt_pk_bf16_f32 v194, v180, v181
  v_cvt_pk_bf16_f32 v195, v182, v183
  v_mfma_f32_32x32x16_bf16 v[80:95], a[68:71], v[204:207], v[80:95]
  v_exp_f32 v187, v155
  v_exp_f32 v188, v156
  v_exp_f32 v189, v157
  v_mfma_f32_32x32x16_bf16 v[96:111], a[76:79], v[204:207], v[96:111]
  v_exp_f32 v190, v158
  v_exp_f32 v191, v159
  v_cvt_pk_bf16_f32 v196, v184, v185
  v_cvt_pk_bf16_f32 v197, v186, v187
  v_mfma_f32_32x32x16_bf16 v[144:159], a[24:27], v[244:247], 0
  s_waitcnt lgkmcnt(2)
  v_exp_f32 v176, v160
  v_exp_f32 v177, v161
  v_mfma_f32_32x32x16_bf16 v[16:31], a[80:83], v[192:195], v[16:31]
  v_exp_f32 v178, v162
  v_exp_f32 v179, v163
  v_exp_f32 v180, v164
  v_mfma_f32_32x32x16_bf16 v[144:159], a[28:31], v[248:251], v[144:159]
  v_exp_f32 v181, v165
  v_cvt_pk_bf16_f32 v198, v188, v189
  v_cvt_pk_bf16_f32 v199, v190, v191
  v_cvt_pk_bf16_f32 v200, v176, v177
  v_cvt_pk_bf16_f32 v201, v178, v179
  v_mfma_f32_32x32x16_bf16 v[32:47], a[88:91], v[192:195], v[32:47]
  v_exp_f32 v182, v166
  v_exp_f32 v183, v167
  v_exp_f32 v184, v168
  v_mfma_f32_32x32x16_bf16 v[144:159], a[32:35], v[252:255], v[144:159]
  v_exp_f32 v185, v169
  v_exp_f32 v186, v170
  v_cvt_pk_bf16_f32 v202, v180, v181
  v_cvt_pk_bf16_f32 v203, v182, v183
  v_mfma_f32_32x32x16_bf16 v[16:31], a[84:87], v[196:199], v[16:31]
  v_exp_f32 v187, v171
  v_exp_f32 v188, v172
  v_exp_f32 v189, v173
  v_mfma_f32_32x32x16_bf16 v[32:47], a[92:95], v[196:199], v[32:47]
  s_waitcnt lgkmcnt(1)
  v_exp_f32 v190, v174
  v_exp_f32 v191, v175
  v_cvt_pk_bf16_f32 v204, v184, v185
  v_cvt_pk_bf16_f32 v205, v186, v187
  v_mfma_f32_32x32x16_bf16 v[160:175], a[36:39], v[208:211], 0
  v_exp_f32 v176, v144
  v_exp_f32 v177, v145
  v_mfma_f32_32x32x16_bf16 v[48:63], a[80:83], v[200:203], v[48:63]
  v_exp_f32 v178, v146
  v_exp_f32 v179, v147
  v_exp_f32 v180, v148
  v_mfma_f32_32x32x16_bf16 v[160:175], a[40:43], v[212:215], v[160:175]
  v_exp_f32 v181, v149
  v_cvt_pk_bf16_f32 v206, v188, v189
  v_cvt_pk_bf16_f32 v207, v190, v191
  v_cvt_pk_bf16_f32 v192, v176, v177
  v_cvt_pk_bf16_f32 v193, v178, v179
  v_mfma_f32_32x32x16_bf16 v[64:79], a[88:91], v[200:203], v[64:79]
  v_exp_f32 v182, v150
  v_exp_f32 v183, v151
  v_exp_f32 v184, v152
  v_mfma_f32_32x32x16_bf16 v[160:175], a[44:47], v[216:219], v[160:175]
  v_exp_f32 v185, v153
  v_exp_f32 v186, v154
  v_cvt_pk_bf16_f32 v194, v180, v181
  v_cvt_pk_bf16_f32 v195, v182, v183
  v_mfma_f32_32x32x16_bf16 v[48:63], a[84:87], v[204:207], v[48:63]
  v_exp_f32 v187, v155
  v_exp_f32 v188, v156
  v_exp_f32 v189, v157
  v_mfma_f32_32x32x16_bf16 v[64:79], a[92:95], v[204:207], v[64:79]
  v_exp_f32 v190, v158
  v_exp_f32 v191, v159
  v_cvt_pk_bf16_f32 v196, v184, v185
  v_cvt_pk_bf16_f32 v197, v186, v187
  v_mfma_f32_32x32x16_bf16 v[144:159], a[36:39], v[220:223], 0
  v_exp_f32 v176, v160
  v_exp_f32 v177, v161
  v_mfma_f32_32x32x16_bf16 v[112:127], a[80:83], v[192:195], v[112:127]
  v_exp_f32 v178, v162
  v_exp_f32 v179, v163
  v_exp_f32 v180, v164
  v_mfma_f32_32x32x16_bf16 v[144:159], a[40:43], v[224:227], v[144:159]
  v_exp_f32 v181, v165
  v_cvt_pk_bf16_f32 v198, v188, v189
  v_cvt_pk_bf16_f32 v199, v190, v191
  v_cvt_pk_bf16_f32 v200, v176, v177
  v_cvt_pk_bf16_f32 v201, v178, v179
  v_mfma_f32_32x32x16_bf16 v[128:143], a[88:91], v[192:195], v[128:143]
  v_exp_f32 v182, v166
  v_exp_f32 v183, v167
  v_exp_f32 v184, v168
  v_mfma_f32_32x32x16_bf16 v[144:159], a[44:47], v[228:231], v[144:159]
  v_exp_f32 v185, v169
  v_exp_f32 v186, v170
  v_cvt_pk_bf16_f32 v202, v180, v181
  v_cvt_pk_bf16_f32 v203, v182, v183
  v_mfma_f32_32x32x16_bf16 v[112:127], a[84:87], v[196:199], v[112:127]
  v_exp_f32 v187, v171
  v_exp_f32 v188, v172
  v_exp_f32 v189, v173
  v_mfma_f32_32x32x16_bf16 v[128:143], a[92:95], v[196:199], v[128:143]
  v_exp_f32 v190, v174
  v_exp_f32 v191, v175
  v_cvt_pk_bf16_f32 v204, v184, v185
  v_cvt_pk_bf16_f32 v205, v186, v187
  v_mfma_f32_32x32x16_bf16 v[160:175], a[36:39], v[232:235], 0
  s_waitcnt lgkmcnt(0)
  v_exp_f32 v176, v144
  v_exp_f32 v177, v145
  v_mfma_f32_32x32x16_bf16 v[16:31], a[96:99], v[200:203], v[16:31]
  v_exp_f32 v178, v146
  v_exp_f32 v179, v147
  v_exp_f32 v180, v148
  v_mfma_f32_32x32x16_bf16 v[160:175], a[40:43], v[236:239], v[160:175]
  v_exp_f32 v181, v149
  v_cvt_pk_bf16_f32 v206, v188, v189
  v_cvt_pk_bf16_f32 v207, v190, v191
  v_cvt_pk_bf16_f32 v192, v176, v177
  v_cvt_pk_bf16_f32 v193, v178, v179
  v_mfma_f32_32x32x16_bf16 v[32:47], a[104:107], v[200:203], v[32:47]
  v_exp_f32 v182, v150
  v_exp_f32 v183, v151
  v_exp_f32 v184, v152
  v_mfma_f32_32x32x16_bf16 v[160:175], a[44:47], v[240:243], v[160:175]
  v_exp_f32 v185, v153
  v_exp_f32 v186, v154
  v_cvt_pk_bf16_f32 v194, v180, v181
  v_cvt_pk_bf16_f32 v195, v182, v183
  v_mfma_f32_32x32x16_bf16 v[16:31], a[100:103], v[204:207], v[16:31]
  v_exp_f32 v187, v155
  v_exp_f32 v188, v156
  v_exp_f32 v189, v157
  v_mfma_f32_32x32x16_bf16 v[32:47], a[108:111], v[204:207], v[32:47]
  v_exp_f32 v190, v158
  v_exp_f32 v191, v159
  v_cvt_pk_bf16_f32 v196, v184, v185
  v_cvt_pk_bf16_f32 v197, v186, v187
  v_exp_f32 v176, v160
  v_exp_f32 v177, v161
  v_mfma_f32_32x32x16_bf16 v[48:63], a[96:99], v[192:195], v[48:63]
  v_exp_f32 v178, v162
  v_exp_f32 v179, v163
  v_exp_f32 v180, v164
  v_exp_f32 v181, v165
  v_cvt_pk_bf16_f32 v198, v188, v189
  v_cvt_pk_bf16_f32 v199, v190, v191
  v_cvt_pk_bf16_f32 v200, v176, v177
  v_cvt_pk_bf16_f32 v201, v178, v179
  v_mfma_f32_32x32x16_bf16 v[64:79], a[104:107], v[192:195], v[64:79]
  v_exp_f32 v182, v166
  v_exp_f32 v183, v167
  v_exp_f32 v184, v168
  v_exp_f32 v185, v169
  v_exp_f32 v186, v170
  v_cvt_pk_bf16_f32 v202, v180, v181
  v_cvt_pk_bf16_f32 v203, v182, v183
  v_mfma_f32_32x32x16_bf16 v[48:63], a[100:103], v[196:199], v[48:63]
  v_exp_f32 v187, v171
  v_exp_f32 v188, v172
  v_exp_f32 v189, v173
  v_mfma_f32_32x32x16_bf16 v[64:79], a[108:111], v[196:199], v[64:79]
  v_exp_f32 v190, v174
  v_exp_f32 v191, v175
  v_cvt_pk_bf16_f32 v204, v184, v185
  v_cvt_pk_bf16_f32 v205, v186, v187
  v_cvt_pk_bf16_f32 v206, v188, v189
  v_cvt_pk_bf16_f32 v207, v190, v191
  s_nop 1
  v_mfma_f32_32x32x16_bf16 v[80:95], a[96:99], v[200:203], v[80:95]
  v_mfma_f32_32x32x16_bf16 v[96:111], a[104:107], v[200:203], v[96:111]
  v_mfma_f32_32x32x16_bf16 v[80:95], a[100:103], v[204:207], v[80:95]
  v_mfma_f32_32x32x16_bf16 v[96:111], a[108:111], v[204:207], v[96:111]
  s_branch L_epiW
L_startV:
  ds_read_b128 a[0:3], v2 offset:0
  ds_read_b128 a[4:7], v2 offset:1024
  ds_read_b128 a[8:11], v2 offset:2048
  ds_read_b128 a[76:79], v3 offset:6144
  ds_read_b128 a[72:75], v3 offset:5120
  ds_read_b128 a[20:23], v3 offset:2048
  ds_read_b128 a[32:35], v4 offset:2048
  s_waitcnt lgkmcnt(4)
  v_mfma_f32_32x32x16_bf16 v[144:159], a[0:3], v[208:211], 0
  ds_read_b128 a[52:55], v2 offset:4096
  ds_read_b128 a[60:63], v2 offset:6144
  ds_read_b128 a[28:31], v4 offset:1024
  ds_read_b128 a[48:51], v2 offset:3072
  v_mfma_f32_32x32x16_bf16 v[144:159], a[4:7], v[212:215], v[144:159]
  ds_read_b128 a[56:59], v2 offset:5120
  ds_read_b128 a[24:27], v4 offset:0
  v_mfma_f32_32x32x16_bf16 v[144:159], a[8:11], v[216:219], v[144:159]
  s_waitcnt lgkmcnt(0)
  s_nop 7
  s_nop 3
  v_mfma_f32_32x32x16_bf16 v[160:175], a[0:3], v[220:223], 0
  ds_read_b128 a[12:15], v3 offset:0
  v_exp_f32 v176, v144
  v_exp_f32 v177, v145
  v_exp_f32 v178, v146
  ds_read_b128 a[16:19], v3 offset:1024
  v_exp_f32 v179, v147
  v_exp_f32 v180, v148
  v_cvt_pk_bf16_f32 v192, v176, v177
  v_mfma_f32_32x32x16_bf16 v[160:175], a[4:7], v[224:227], v[160:175]
  ds_read_b128 a[36:39], v5 offset:0
  v_exp_f32 v181, v149
  v_cvt_pk_bf16_f32 v206, v188, v189
  v_cvt_pk_bf16_f32 v207, v190, v191
  v_cvt_pk_bf16_f32 v193, v178, v179
  v_exp_f32 v182, v150
  v_exp_f32 v183, v151
  v_exp_f32 v184, v152
  v_mfma_f32_32x32x16_bf16 v[160:175], a[8:11], v[228:231], v[160:175]
  v_exp_f32 v185, v153
  v_exp_f32 v186, v154
  v_cvt_pk_bf16_f32 v194, v180, v181
  v_cvt_pk_bf16_f32 v195, v182, v183
  v_exp_f32 v187, v155
  v_exp_f32 v188, v156
  v_exp_f32 v189, v157
  v_exp_f32 v190, v158
  v_exp_f32 v191, v159
  v_cvt_pk_bf16_f32 v196, v184, v185
  v_cvt_pk_bf16_f32 v197, v186, v187
  v_mfma_f32_32x32x16_bf16 v[144:159], a[0:3], v[232:235], 0
  s_nop 0
  v_exp_f32 v176, v160
  v_exp_f32 v177, v161
  v_exp_f32 v178, v162
  v_mfma_f32_32x32x16_bf16 v[16:31], a[48:51], v[192:195], 0
  ds_read_b128 a[68:71], v3 offset:4096
  v_exp_f32 v179, v163
  v_exp_f32 v180, v164
  v_cvt_pk_bf16_f32 v200, v176, v177
  v_mfma_f32_32x32x16_bf16 v[144:159], a[4:7], v[236:239], v[144:159]
  ds_read_b128 a[84:87], v4 offset:4096
  v_exp_f32 v181, v165
  v_cvt_pk_bf16_f32 v198, v188, v189
  v_cvt_pk_bf16_f32 v199, v190, v191
  v_cvt_pk_bf16_f32 v201, v178, v179
  v_mfma_f32_32x32x16_bf16 v[32:47], a[56:59], v[192:195], 0
  ds_read_b128 a[108:111], v5 offset:6144
  v_exp_f32 v182, v166
  v_exp_f32 v183, v167
  v_cvt_pk_bf16_f32 v202, v180, v181
  v_mfma_f32_32x32x16_bf16 v[144:159], a[8:11], v[240:243], v[144:159]
  v_exp_f32 v184, v168
  v_exp_f32 v185, v169
  v_exp_f32 v186, v170
  v_mfma_f32_32x32x16_bf16 v[16:31], a[52:55], v[196:199], v[16:31]
  v_exp_f32 v187, v171
  v_exp_f32 v188, v172
  v_cvt_pk_bf16_f32 v203, v182, v183
  v_cvt_pk_bf16_f32 v204, v184, v185
  v_mfma_f32_32x32x16_bf16 v[32:47], a[60:63], v[196:199], v[32:47]
  s_waitcnt lgkmcnt(4)
  v_exp_f32 v189, v173
  v_exp_f32 v190, v174
  v_exp_f32 v191, v175
  v_cvt_pk_bf16_f32 v205, v186, v187
  v_mfma_f32_32x32x16_bf16 v[160:175], a[12:15], v[208:211], 0
  ds_read_b128 a[64:67], v3 offset:3072
  v_exp_f32 v176, v144
  v_exp_f32 v177, v145
  v_exp_f32 v178, v146
  v_mfma_f32_32x32x16_bf16 v[48:63], a[48:51], v[200:203], 0
  ds_read_b128 a[80:83], v4 offset:3072
  v_exp_f32 v179, v147
  v_exp_f32 v180, v148
  v_cvt_pk_bf16_f32 v192, v176, v177
  v_mfma_f32_32x32x16_bf16 v[160:175], a[16:19], v[212:215], v[160:175]
  ds_read_b128 a[104:107], v5 offset:5120
  v_exp_f32 v181, v149
  v_cvt_pk_bf16_f32 v206, v188, v189
  v_cvt_pk_bf16_f32 v207, v190, v191
  v_cvt_pk_bf16_f32 v193, v178, v179
  v_mfma_f32_32x32x16_bf16 v[64:79], a[56:59], v[200:203], 0
  v_exp_f32 v182, v150
  v_exp_f32 v183, v151
  v_exp_f32 v184, v152
  v_mfma_f32_32x32x16_bf16 v[160:175], a[20:23], v[216:219], v[160:175]
  v_exp_f32 v185, v153
  v_exp_f32 v186, v154
  v_cvt_pk_bf16_f32 v194, v180, v181
  v_cvt_pk_bf16_f32 v195, v182, v183
  v_mfma_f32_32x32x16_bf16 v[48:63], a[52:55], v[204:207], v[48:63]
  v_exp_f32 v187, v155
  v_exp_f32 v188, v156
  v_exp_f32 v189, v157
  v_mfma_f32_32x32x16_bf16 v[64:79], a[60:63], v[204:207], v[64:79]
  v_exp_f32 v190, v158
  v_exp_f32 v191, v159
  v_cvt_pk_bf16_f32 v196, v184, v185
  v_cvt_pk_bf16_f32 v197, v186, v187
  v_mfma_f32_32x32x16_bf16 v[144:159], a[12:15], v[220:223], 0
  ds_read_b128 a[92:95], v4 offset:6144
  v_exp_f32 v176, v160
  v_exp_f32 v177, v161
  v_exp_f32 v178, v162
  v_mfma_f32_32x32x16_bf16 v[80:95], a[48:51], v[192:195], 0
  ds_read_b128 a[44:47], v5 offset:2048
  v_exp_f32 v179, v163
  v_exp_f32 v180, v164
  v_cvt_pk_bf16_f32 v200, v176, v177
  v_mfma_f32_32x32x16_bf16 v[144:159], a[16:19], v[224:227], v[144:159]
  ds_read_b128 a[100:103], v5 offset:4096
  v_exp_f32 v181, v165
  v_cvt_pk_bf16_f32 v198, v188, v189
  v_cvt_pk_bf16_f32 v199, v190, v191
  v_cvt_pk_bf16_f32 v201, v178, v179
  v_mfma_f32_32x32x16_bf16 v[96:111], a[56:59], v[192:195], 0
  v_exp_f32 v182, v166
  v_exp_f32 v183, v167
  v_exp_f32 v184, v168
  v_mfma_f32_32x32x16_bf16 v[144:159], a[20:23], v[228:231], v[144:159]
  v_exp_f32 v185, v169
  v_exp_f32 v186, v170
  v_cvt_pk_bf16_f32 v202, v180, v181
  v_cvt_pk_bf16_f32 v203, v182, v183
  v_mfma_f32_32x32x16_bf16 v[80:95], a[52:55], v[196:199], v[80:95]
  v_exp_f32 v187, v171
  v_exp_f32 v188, v172
  v_exp_f32 v189, v173
  v_mfma_f32_32x32x16_bf16 v[96:111], a[60:63], v[196:199], v[96:111]
  v_exp_f32 v190, v174
  v_exp_f32 v191, v175
  v_cvt_pk_bf16_f32 v204, v184, v185
  v_cvt_pk_bf16_f32 v205, v186, v187
  v_mfma_f32_32x32x16_bf16 v[160:175], a[12:15], v[232:235], 0
  s_waitcnt lgkmcnt(5)
  v_exp_f32 v176, v144
  v_exp_f32 v177, v145
  v_exp_f32 v178, v146
  v_mfma_f32_32x32x16_bf16 v[16:31], a[64:67], v[200:203], v[16:31]
  ds_read_b128 a[88:91], v4 offset:5120
  v_exp_f32 v179, v147
  v_exp_f32 v180, v148
  v_cvt_pk_bf16_f32 v192, v176, v177
  v_mfma_f32_32x32x16_bf16 v[160:175], a[16:19], v[236:239], v[160:175]
  ds_read_b128 a[40:43], v5 offset:1024
  v_exp_f32 v181, v149
  v_cvt_pk_bf16_f32 v206, v188, v189
  v_cvt_pk_bf16_f32 v207, v190, v191
  v_cvt_pk_bf16_f32 v193, v178, v179
  v_mfma_f32_32x32x16_bf16 v[32:47], a[72:75], v[200:203], v[32:47]
  ds_read_b128 a[96:99], v5 offset:3072
  v_exp_f32 v182, v150
  v_exp_f32 v183, v151
  v_cvt_pk_bf16_f32 v194, v180, v181
  v_mfma_f32_32x32x16_bf16 v[160:175], a[20:23], v[240:243], v[160:175]
  v_exp_f32 v184, v152
  v_exp_f32 v185, v153
  v_exp_f32 v186, v154
  v_mfma_f32_32x32x16_bf16 v[16:31], a[68:71], v[204:207], v[16:31]
  v_exp_f32 v187, v155
  v_exp_f32 v188, v156
  v_cvt_pk_bf16_f32 v195, v182, v183
  v_cvt_pk_bf16_f32 v196, v184, v185
  v_mfma_f32_32x32x16_bf16 v[32:47], a[76:79], v[204:207], v[32:47]
  s_nop 0
  v_exp_f32 v189, v157
  v_exp_f32 v190, v158
  v_exp_f32 v191, v159
  v_cvt_pk_bf16_f32 v197, v186, v187
  v_mfma_f32_32x32x16_bf16 v[144:159], a[24:27], v[208:211], 0
  v_exp_f32 v176, v160
  v_exp_f32 v177, v161
  v_mfma_f32_32x32x16_bf16 v[48:63], a[64:67], v[192:195], v[48:63]
  v_exp_f32 v178, v162
  v_exp_f32 v179, v163
  v_exp_f32 v180, v164
  v_mfma_f32_32x32x16_bf16 v[144:159], a[28:31], v[212:215], v[144:159]
  v_exp_f32 v181, v165
  v_cvt_pk_bf16_f32 v198, v188, v189
  v_cvt_pk_bf16_f32 v199, v190, v191
  v_cvt_pk_bf16_f32 v200, v176, v177
  v_cvt_pk_bf16_f32 v201, v178, v179
  v_mfma_f32_32x32x16_bf16 v[64:79], a[72:75], v[192:195], v[64:79]
  v_exp_f32 v182, v166
  v_exp_f32 v183, v167
  v_exp_f32 v184, v168
  v_mfma_f32_32x32x16_bf16 v[144:159], a[32:35], v[216:219], v[144:159]
  v_exp_f32 v185, v169
  v_exp_f32 v186, v170
  v_cvt_pk_bf16_f32 v202, v180, v181
  v_cvt_pk_bf16_f32 v203, v182, v183
  v_mfma_f32_32x32x16_bf16 v[48:63], a[68:71], v[196:199], v[48:63]
  v_exp_f32 v187, v171
  v_exp_f32 v188, v172
  v_exp_f32 v189, v173
  v_mfma_f32_32x32x16_bf16 v[64:79], a[76:79], v[196:199], v[64:79]
  v_exp_f32 v190, v174
  v_exp_f32 v191, v175
  v_cvt_pk_bf16_f32 v204, v184, v185
  v_cvt_pk_bf16_f32 v205, v186, v187
  v_mfma_f32_32x32x16_bf16 v[160:175], a[24:27], v[220:223], 0
  s_waitcnt vmcnt(0) lgkmcnt(0)
  v_exp_f32 v176, v144
  v_exp_f32 v177, v145
  v_exp_f32 v178, v146
  v_mfma_f32_32x32x16_bf16 v[80:95], a[64:67], v[200:203], v[80:95]
  s_barrier
  s_cmp_eq_u32 s30, 0
  s_cbranch_scc0 L_f0_V
  v_readfirstlane_b32 s36, v12
  s_nop 3
  s_bfe_u32 s36, s36, 0x150008
  s_cmp_eq_u32 s36, s95
  s_cbranch_scc1 L_f0w_V
  buffer_wbl2 sc1
  s_waitcnt vmcnt(0)
L_f0w_V:
  v_mov_b32 v10, 1
  s_nop 1
  s_mov_b64 s[92:93], exec
  s_mov_b64 exec, 1
  global_atomic_add v13, v10, s[44:45] sc1
  s_mov_b64 exec, s[92:93]
L_f0_V:
  v_mfma_f32_32x32x16_bf16 v[160:175], a[28:31], v[224:227], v[160:175]
  v_exp_f32 v179, v147
  v_exp_f32 v180, v148
  v_cvt_pk_bf16_f32 v206, v188, v189
  v_cvt_pk_bf16_f32 v207, v190, v191
  v_mfma_f32_32x32x16_bf16 v[96:111], a[72:75], v[200:203], v[96:111]
  v_exp_f32 v181, v149
  v_exp_f32 v182, v150
  v_cvt_pk_bf16_f32 v192, v176, v177
  v_cvt_pk_bf16_f32 v193, v178, v179
  v_mfma_f32_32x32x16_bf16 v[160:175], a[32:35], v[228:231], v[160:175]
  v_exp_f32 v183, v151
  v_exp_f32 v184, v152
  v_exp_f32 v185, v153
  v_mfma_f32_32x32x16_bf16 v[80:95], a[68:71], v[204:207], v[80:95]
  v_exp_f32 v186, v154
  v_exp_f32 v187, v155
  v_cvt_pk_bf16_f32 v194, v180, v181
  v_cvt_pk_bf16_f32 v195, v182, v183
  v_mfma_f32_32x32x16_bf16 v[96:111], a[76:79], v[204:207], v[96:111]
  v_exp_f32 v188, v156
  v_exp_f32 v189, v157
  v_exp_f32 v190, v158
  v_exp_f32 v191, v159
  v_cvt_pk_bf16_f32 v196, v184, v185
  v_cvt_pk_bf16_f32 v197, v186, v187
  v_mfma_f32_32x32x16_bf16 v[144:159], a[24:27], v[232:235], 0
  s_nop 0
  v_exp_f32 v176, v160
  v_exp_f32 v177, v161
  v_exp_f32 v178, v162
  v_mfma_f32_32x32x16_bf16 v[16:31], a[80:83], v[192:195], v[16:31]
  ds_read_b128 a[8:11], v2 offset:30720
  v_exp_f32 v179, v163
  v_exp_f32 v180, v164
  v_cvt_pk_bf16_f32 v200, v176, v177
  v_mfma_f32_32x32x16_bf16 v[144:159], a[28:31], v[236:239], v[144:159]
  ds_read_b128 a[76:79], v3 offset:34816
  v_exp_f32 v181, v165
  v_cvt_pk_bf16_f32 v198, v188, v189
  v_cvt_pk_bf16_f32 v199, v190, v191
  v_cvt_pk_bf16_f32 v201, v178, v179
  v_mfma_f32_32x32x16_bf16 v[32:47], a[88:91], v[192:195], v[32:47]
  v_exp_f32 v182, v166
  v_exp_f32 v183, v167
  v_exp_f32 v184, v168
  v_mfma_f32_32x32x16_bf16 v[144:159], a[32:35], v[240:243], v[144:159]
  v_exp_f32 v185, v169
  v_exp_f32 v186, v170
  v_cvt_pk_bf16_f32 v202, v180, v181
  v_cvt_pk_bf16_f32 v203, v182, v183
  v_mfma_f32_32x32x16_bf16 v[16:31], a[84:87], v[196:199], v[16:31]
  v_exp_f32 v187, v171
  v_exp_f32 v188, v172
  v_exp_f32 v189, v173
  v_mfma_f32_32x32x16_bf16 v[32:47], a[92:95], v[196:199], v[32:47]
  s_nop 0
  v_exp_f32 v190, v174
  v_exp_f32 v191, v175
  v_cvt_pk_bf16_f32 v204, v184, v185
  v_cvt_pk_bf16_f32 v205, v186, v187
  v_mfma_f32_32x32x16_bf16 v[160:175], a[36:39], v[208:211], 0
  ds_read_b128 a[4:7], v2 offset:29696
  v_exp_f32 v176, v144
  v_exp_f32 v177, v145
  v_cvt_pk_bf16_f32 v206, v188, v189
  v_mfma_f32_32x32x16_bf16 v[48:63], a[80:83], v[200:203], v[48:63]
  ds_read_b128 a[72:75], v3 offset:33792
  v_exp_f32 v178, v146
  v_exp_f32 v179, v147
  v_cvt_pk_bf16_f32 v192, v176, v177
  v_mfma_f32_32x32x16_bf16 v[160:175], a[40:43], v[212:215], v[160:175]
  v_exp_f32 v180, v148
  v_exp_f32 v181, v149
  v_cvt_pk_bf16_f32 v207, v190, v191
  v_cvt_pk_bf16_f32 v193, v178, v179
  v_mfma_f32_32x32x16_bf16 v[64:79], a[88:91], v[200:203], v[64:79]
  v_exp_f32 v182, v150
  v_exp_f32 v183, v151
  v_exp_f32 v184, v152
  v_mfma_f32_32x32x16_bf16 v[160:175], a[44:47], v[216:219], v[160:175]
  v_exp_f32 v185, v153
  v_exp_f32 v186, v154
  v_cvt_pk_bf16_f32 v194, v180, v181
  v_cvt_pk_bf16_f32 v195, v182, v183
  v_mfma_f32_32x32x16_bf16 v[48:63], a[84:87], v[204:207], v[48:63]
  v_exp_f32 v187, v155
  v_exp_f32 v188, v156
  v_exp_f32 v189, v157
  v_mfma_f32_32x32x16_bf16 v[64:79], a[92:95], v[204:207], v[64:79]
  v_exp_f32 v190, v158
  v_exp_f32 v191, v159
  v_cvt_pk_bf16_f32 v196, v184, v185
  v_cvt_pk_bf16_f32 v197, v186, v187
  v_mfma_f32_32x32x16_bf16 v[144:159], a[36:39], v[220:223], 0
  ds_read_b128 a[0:3], v2 offset:28672
  v_exp_f32 v176, v160
  v_exp_f32 v177, v161
  v_exp_f32 v178, v162
  v_mfma_f32_32x32x16_bf16 v[80:95], a[80:83], v[192:195], v[80:95]
  ds_read_b128 a[20:23], v3 offset:30720
  v_exp_f32 v179, v163
  v_exp_f32 v180, v164
  v_cvt_pk_bf16_f32 v200, v176, v177
  v_mfma_f32_32x32x16_bf16 v[144:159], a[40:43], v[224:227], v[144:159]
  ds_read_b128 a[32:35], v4 offset:30720
  v_exp_f32 v181, v165
  v_cvt_pk_bf16_f32 v198, v188, v189
  v_cvt_pk_bf16_f32 v199, v190, v191
  v_cvt_pk_bf16_f32 v201, v178, v179
  v_mfma_f32_32x32x16_bf16 v[96:111], a[88:91], v[192:195], v[96:111]
  v_exp_f32 v182, v166
  v_exp_f32 v183, v167
  v_exp_f32 v184, v168
  v_mfma_f32_32x32x16_bf16 v[144:159], a[44:47], v[228:231], v[144:159]
  v_exp_f32 v185, v169
  v_exp_f32 v186, v170
  v_cvt_pk_bf16_f32 v202, v180, v181
  v_cvt_pk_bf16_f32 v203, v182, v183
  v_mfma_f32_32x32x16_bf16 v[80:95], a[84:87], v[196:199], v[80:95]
  v_exp_f32 v187, v171
  v_exp_f32 v188, v172
  v_exp_f32 v189, v173
  v_mfma_f32_32x32x16_bf16 v[96:111], a[92:95], v[196:199], v[96:111]
  v_exp_f32 v190, v174
  v_exp_f32 v191, v175
  v_cvt_pk_bf16_f32 v204, v184, v185
  v_cvt_pk_bf16_f32 v205, v186, v187
  v_mfma_f32_32x32x16_bf16 v[160:175], a[36:39], v[232:235], 0
  s_nop 0
  v_exp_f32 v176, v144
  v_exp_f32 v177, v145
  v_exp_f32 v178, v146
  v_mfma_f32_32x32x16_bf16 v[16:31], a[96:99], v[200:203], v[16:31]
  ds_read_b128 a[52:55], v2 offset:32768
  v_exp_f32 v179, v147
  v_exp_f32 v180, v148
  v_cvt_pk_bf16_f32 v192, v176, v177
  v_mfma_f32_32x32x16_bf16 v[160:175], a[40:43], v[236:239], v[160:175]
  ds_read_b128 a[60:63], v2 offset:34816
  v_exp_f32 v181, v149
  v_cvt_pk_bf16_f32 v206, v188, v189
  v_cvt_pk_bf16_f32 v207, v190, v191
  v_cvt_pk_bf16_f32 v193, v178, v179
  v_mfma_f32_32x32x16_bf16 v[32:47], a[104:107], v[200:203], v[32:47]
  ds_read_b128 a[28:31], v4 offset:29696
  v_exp_f32 v182, v150
  v_exp_f32 v183, v151
  v_cvt_pk_bf16_f32 v194, v180, v181
  v_mfma_f32_32x32x16_bf16 v[160:175], a[44:47], v[240:243], v[160:175]
  v_exp_f32 v184, v152
  v_exp_f32 v185, v153
  v_exp_f32 v186, v154
  v_mfma_f32_32x32x16_bf16 v[16:31], a[100:103], v[204:207], v[16:31]
  v_exp_f32 v187, v155
  v_exp_f32 v188, v156
  v_cvt_pk_bf16_f32 v195, v182, v183
  v_cvt_pk_bf16_f32 v196, v184, v185
  v_mfma_f32_32x32x16_bf16 v[32:47], a[108:111], v[204:207], v[32:47]
  s_waitcnt lgkmcnt(5)
  v_exp_f32 v189, v157
  v_exp_f32 v190, v158
  v_exp_f32 v191, v159
  v_cvt_pk_bf16_f32 v197, v186, v187
  v_mfma_f32_32x32x16_bf16 v[144:159], a[0:3], v[208:211], 0
  ds_read_b128 a[48:51], v2 offset:31744
  v_exp_f32 v176, v160
  v_exp_f32 v177, v161
  v_exp_f32 v178, v162
  v_mfma_f32_32x32x16_bf16 v[48:63], a[96:99], v[192:195], v[48:63]
  ds_read_b128 a[56:59], v2 offset:33792
  v_exp_f32 v179, v163
  v_exp_f32 v180, v164
  v_cvt_pk_bf16_f32 v200, v176, v177
  v_mfma_f32_32x32x16_bf16 v[144:159], a[4:7], v[212:215], v[144:159]
  ds_read_b128 a[24:27], v4 offset:28672
  v_exp_f32 v181, v165
  v_cvt_pk_bf16_f32 v198, v188, v189
  v_cvt_pk_bf16_f32 v199, v190, v191
  v_cvt_pk_bf16_f32 v201, v178, v179
  v_mfma_f32_32x32x16_bf16 v[64:79], a[104:107], v[192:195], v[64:79]
  v_exp_f32 v182, v166
  v_exp_f32 v183, v167
  v_exp_f32 v184, v168
  v_mfma_f32_32x32x16_bf16 v[144:159], a[8:11], v[216:219], v[144:159]
  v_exp_f32 v185, v169
  v_exp_f32 v186, v170
  v_cvt_pk_bf16_f32 v202, v180, v181
  v_cvt_pk_bf16_f32 v203, v182, v183
  v_mfma_f32_32x32x16_bf16 v[48:63], a[100:103], v[196:199], v[48:63]
  v_exp_f32 v187, v171
  v_exp_f32 v188, v172
  v_exp_f32 v189, v173
  v_mfma_f32_32x32x16_bf16 v[64:79], a[108:111], v[196:199], v[64:79]
  v_exp_f32 v190, v174
  v_exp_f32 v191, v175
  v_cvt_pk_bf16_f32 v204, v184, v185
  v_cvt_pk_bf16_f32 v205, v186, v187
  v_mfma_f32_32x32x16_bf16 v[160:175], a[0:3], v[220:223], 0
  ds_read_b128 a[12:15], v3 offset:28672
  v_exp_f32 v176, v144
  v_exp_f32 v177, v145
  v_exp_f32 v178, v146
  v_mfma_f32_32x32x16_bf16 v[80:95], a[96:99], v[200:203], v[80:95]
  ds_read_b128 a[16:19], v3 offset:29696
  v_exp_f32 v179, v147
  v_exp_f32 v180, v148
  v_cvt_pk_bf16_f32 v192, v176, v177
  v_mfma_f32_32x32x16_bf16 v[160:175], a[4:7], v[224:227], v[160:175]
  ds_read_b128 a[36:39], v5 offset:28672
  v_exp_f32 v181, v149
  v_cvt_pk_bf16_f32 v206, v188, v189
  v_cvt_pk_bf16_f32 v207, v190, v191
  v_cvt_pk_bf16_f32 v193, v178, v179
  v_mfma_f32_32x32x16_bf16 v[96:111], a[104:107], v[200:203], v[96:111]
  v_exp_f32 v182, v150
  v_exp_f32 v183, v151
  v_exp_f32 v184, v152
  v_mfma_f32_32x32x16_bf16 v[160:175], a[8:11], v[228:231], v[160:175]
  v_exp_f32 v185, v153
  v_exp_f32 v186, v154
  v_cvt_pk_bf16_f32 v194, v180, v181
  v_cvt_pk_bf16_f32 v195, v182, v183
  v_mfma_f32_32x32x16_bf16 v[80:95], a[100:103], v[204:207], v[80:95]
  v_exp_f32 v187, v155
  v_exp_f32 v188, v156
  v_exp_f32 v189, v157
  v_mfma_f32_32x32x16_bf16 v[96:111], a[108:111], v[204:207], v[96:111]
  v_exp_f32 v190, v158
  v_exp_f32 v191, v159
  v_cvt_pk_bf16_f32 v196, v184, v185
  v_cvt_pk_bf16_f32 v197, v186, v187
  v_mfma_f32_32x32x16_bf16 v[144:159], a[0:3], v[232:235], 0
  s_waitcnt lgkmcnt(4)
  v_exp_f32 v176, v160
  v_exp_f32 v177, v161
  v_exp_f32 v178, v162
  v_mfma_f32_32x32x16_bf16 v[16:31], a[48:51], v[192:195], v[16:31]
  ds_read_b128 a[68:71], v3 offset:32768
  v_exp_f32 v179, v163
  v_exp_f32 v180, v164
  v_cvt_pk_bf16_f32 v200, v176, v177
  v_mfma_f32_32x32x16_bf16 v[144:159], a[4:7], v[236:239], v[144:159]
  ds_read_b128 a[84:87], v4 offset:32768
  v_exp_f32 v181, v165
  v_cvt_pk_bf16_f32 v198, v188, v189
  v_cvt_pk_bf16_f32 v199, v190, v191
  v_cvt_pk_bf16_f32 v201, v178, v179
  v_mfma_f32_32x32x16_bf16 v[32:47], a[56:59], v[192:195], v[32:47]
  ds_read_b128 a[108:111], v5 offset:34816
  v_exp_f32 v182, v166
  v_exp_f32 v183, v167
  v_cvt_pk_bf16_f32 v202, v180, v181
  v_mfma_f32_32x32x16_bf16 v[144:159], a[8:11], v[240:243], v[144:159]
  v_exp_f32 v184, v168
  v_exp_f32 v185, v169
  v_exp_f32 v186, v170
  v_mfma_f32_32x32x16_bf16 v[16:31], a[52:55], v[196:199], v[16:31]
  v_exp_f32 v187, v171
  v_exp_f32 v188, v172
  v_cvt_pk_bf16_f32 v203, v182, v183
  v_cvt_pk_bf16_f32 v204, v184, v185
  v_mfma_f32_32x32x16_bf16 v[32:47], a[60:63], v[196:199], v[32:47]
  s_waitcnt lgkmcnt(4)
  v_exp_f32 v189, v173
  v_exp_f32 v190, v174
  v_exp_f32 v191, v175
  v_cvt_pk_bf16_f32 v205, v186, v187
  v_mfma_f32_32x32x16_bf16 v[160:175], a[12:15], v[208:211], 0
  ds_read_b128 a[64:67], v3 offset:31744
  v_exp_f32 v176, v144
  v_exp_f32 v177, v145
  v_exp_f32 v178, v146
  v_mfma_f32_32x32x16_bf16 v[48:63], a[48:51], v[200:203], v[48:63]
  ds_read_b128 a[80:83], v4 offset:31744
  v_exp_f32 v179, v147
  v_exp_f32 v180, v148
  v_cvt_pk_bf16_f32 v192, v176, v177
  v_mfma_f32_32x32x16_bf16 v[160:175], a[16:19], v[212:215], v[160:175]
  ds_read_b128 a[104:107], v5 offset:33792
  v_exp_f32 v181, v149
  v_cvt_pk_bf16_f32 v206, v188, v189
  v_cvt_pk_bf16_f32 v207, v190, v191
  v_cvt_pk_bf16_f32 v193, v178, v179
  v_mfma_f32_32x32x16_bf16 v[64:79], a[56:59], v[200:203], v[64:79]
  v_exp_f32 v182, v150
  v_exp_f32 v183, v151
  v_exp_f32 v184, v152
  v_mfma_f32_32x32x16_bf16 v[160:175], a[20:23], v[216:219], v[160:175]
  v_exp_f32 v185, v153
  v_exp_f32 v186, v154
  v_cvt_pk_bf16_f32 v194, v180, v181
  v_cvt_pk_bf16_f32 v195, v182, v183
  v_mfma_f32_32x32x16_bf16 v[48:63], a[52:55], v[204:207], v[48:63]
  v_exp_f32 v187, v155
  v_exp_f32 v188, v156
  v_exp_f32 v189, v157
  v_mfma_f32_32x32x16_bf16 v[64:79], a[60:63], v[204:207], v[64:79]
  v_exp_f32 v190, v158
  v_exp_f32 v191, v159
  v_cvt_pk_bf16_f32 v196, v184, v185
  v_cvt_pk_bf16_f32 v197, v186, v187
  v_mfma_f32_32x32x16_bf16 v[144:159], a[12:15], v[220:223], 0
  ds_read_b128 a[92:95], v4 offset:34816
  v_exp_f32 v176, v160
  v_exp_f32 v177, v161
  v_exp_f32 v178, v162
  v_mfma_f32_32x32x16_bf16 v[80:95], a[48:51], v[192:195], v[80:95]
  ds_read_b128 a[44:47], v5 offset:30720
  v_exp_f32 v179, v163
  v_exp_f32 v180, v164
  v_cvt_pk_bf16_f32 v200, v176, v177
  v_mfma_f32_32x32x16_bf16 v[144:159], a[16:19], v[224:227], v[144:159]
  ds_read_b128 a[100:103], v5 offset:32768
  v_exp_f32 v181, v165
  v_cvt_pk_bf16_f32 v198, v188, v189
  v_cvt_pk_bf16_f32 v199, v190, v191
  v_cvt_pk_bf16_f32 v201, v178, v179
  v_mfma_f32_32x32x16_bf16 v[96:111], a[56:59], v[192:195], v[96:111]
  global_load_dword v12, v13, s[44:45] sc1
  v_exp_f32 v182, v166
  v_exp_f32 v183, v167
  v_mfma_f32_32x32x16_bf16 v[144:159], a[20:23], v[228:231], v[144:159]
  s_add_u32 s20, s20, 28672
  v_exp_f32 v184, v168
  v_exp_f32 v185, v169
  v_cvt_pk_bf16_f32 v202, v180, v181
  v_cvt_pk_bf16_f32 v203, v182, v183
  v_mfma_f32_32x32x16_bf16 v[80:95], a[52:55], v[196:199], v[80:95]
  s_cmp_ge_u32 s20, s21
  s_cselect_b32 s25, 401408, 0
  v_exp_f32 v186, v170
  v_exp_f32 v187, v171
  v_cvt_pk_bf16_f32 v204, v184, v185
  v_mfma_f32_32x32x16_bf16 v[96:111], a[60:63], v[196:199], v[96:111]
  s_sub_u32 s20, s20, s25
  v_exp_f32 v188, v172
  v_exp_f32 v189, v173
  v_exp_f32 v190, v174
  v_exp_f32 v191, v175
  v_cvt_pk_bf16_f32 v205, v186, v187
  v_mfma_f32_32x32x16_bf16 v[160:175], a[12:15], v[232:235], 0
  s_waitcnt lgkmcnt(5)
  v_exp_f32 v176, v144
  v_exp_f32 v177, v145
  v_exp_f32 v178, v146
  v_mfma_f32_32x32x16_bf16 v[16:31], a[64:67], v[200:203], v[16:31]
  ds_read_b128 a[88:91], v4 offset:33792
  v_exp_f32 v179, v147
  v_exp_f32 v180, v148
  v_cvt_pk_bf16_f32 v192, v176, v177
  v_mfma_f32_32x32x16_bf16 v[160:175], a[16:19], v[236:239], v[160:175]
  ds_read_b128 a[40:43], v5 offset:29696
  v_exp_f32 v181, v149
  v_cvt_pk_bf16_f32 v206, v188, v189
  v_cvt_pk_bf16_f32 v207, v190, v191
  v_cvt_pk_bf16_f32 v193, v178, v179
  v_mfma_f32_32x32x16_bf16 v[32:47], a[72:75], v[200:203], v[32:47]
  ds_read_b128 a[96:99], v5 offset:31744
  v_exp_f32 v182, v150
  v_exp_f32 v183, v151
  v_cvt_pk_bf16_f32 v194, v180, v181
  v_mfma_f32_32x32x16_bf16 v[160:175], a[20:23], v[240:243], v[160:175]
  s_add_u32 s28, s20, 4096
  v_exp_f32 v184, v152
  v_exp_f32 v185, v153
  v_exp_f32 v186, v154
  v_mfma_f32_32x32x16_bf16 v[16:31], a[68:71], v[204:207], v[16:31]
  v_exp_f32 v187, v155
  v_exp_f32 v188, v156
  v_cvt_pk_bf16_f32 v195, v182, v183
  v_cvt_pk_bf16_f32 v196, v184, v185
  v_mfma_f32_32x32x16_bf16 v[32:47], a[76:79], v[204:207], v[32:47]
  s_waitcnt lgkmcnt(15)
  v_exp_f32 v189, v157
  v_exp_f32 v190, v158
  v_exp_f32 v191, v159
  v_cvt_pk_bf16_f32 v197, v186, v187
  v_mfma_f32_32x32x16_bf16 v[144:159], a[24:27], v[208:211], 0
  v_exp_f32 v176, v160
  v_exp_f32 v177, v161
  v_exp_f32 v178, v162
  v_mfma_f32_32x32x16_bf16 v[48:63], a[64:67], v[192:195], v[48:63]
  v_exp_f32 v179, v163
  v_exp_f32 v180, v164
  v_cvt_pk_bf16_f32 v200, v176, v177
  v_mfma_f32_32x32x16_bf16 v[144:159], a[28:31], v[212:215], v[144:159]
  v_exp_f32 v181, v165
  v_exp_f32 v182, v166
  v_cvt_pk_bf16_f32 v198, v188, v189
  v_cvt_pk_bf16_f32 v199, v190, v191
  v_mfma_f32_32x32x16_bf16 v[64:79], a[72:75], v[192:195], v[64:79]
  v_exp_f32 v183, v167
  v_exp_f32 v184, v168
  v_cvt_pk_bf16_f32 v201, v178, v179
  v_cvt_pk_bf16_f32 v202, v180, v181
  v_mfma_f32_32x32x16_bf16 v[144:159], a[32:35], v[216:219], v[144:159]
  v_exp_f32 v185, v169
  v_exp_f32 v186, v170
  v_exp_f32 v187, v171
  v_mfma_f32_32x32x16_bf16 v[48:63], a[68:71], v[196:199], v[48:63]
  v_exp_f32 v188, v172
  v_exp_f32 v189, v173
  v_cvt_pk_bf16_f32 v203, v182, v183
  v_cvt_pk_bf16_f32 v204, v184, v185
  v_mfma_f32_32x32x16_bf16 v[64:79], a[76:79], v[196:199], v[64:79]
  v_exp_f32 v190, v174
  v_exp_f32 v191, v175
  v_cvt_pk_bf16_f32 v205, v186, v187
  v_add_u32 v3, s23, v3
  v_mfma_f32_32x32x16_bf16 v[160:175], a[24:27], v[220:223], 0
  s_waitcnt vmcnt(0) lgkmcnt(0)
  v_exp_f32 v176, v144
  v_exp_f32 v177, v145
  v_exp_f32 v178, v146
  v_mfma_f32_32x32x16_bf16 v[80:95], a[64:67], v[200:203], v[80:95]
  s_barrier
  s_mov_b32 s94, 0x40000
L_f1_V:
  v_readfirstlane_b32 s36, v12
  s_nop 3
  s_and_b32 s36, s36, 7
  s_cmp_ge_u32 s36, s29
  s_cbranch_scc1 L_f1ok_V
  global_load_dword v12, v13, s[44:45] sc1
  s_waitcnt vmcnt(0)
  s_sub_u32 s94, s94, 1
  s_cmp_lg_u32 s94, 0
  s_cbranch_scc1 L_f1_V
L_f1ok_V:
  v_readfirstlane_b32 s36, v12
  s_nop 3
  s_bfe_u32 s36, s36, 0x150008
  s_cmp_eq_u32 s36, s95
  s_cbranch_scc1 L_f1s_V
  buffer_inv sc1
  s_waitcnt vmcnt(0)
L_f1s_V:
  v_mfma_f32_32x32x16_bf16 v[160:175], a[28:31], v[224:227], v[160:175]
  s_add_u32 m0, s22, 28672
  v_exp_f32 v179, v147
  v_exp_f32 v180, v148
  v_cvt_pk_bf16_f32 v206, v188, v189
  v_cvt_pk_bf16_f32 v207, v190, v191
  v_mfma_f32_32x32x16_bf16 v[96:111], a[72:75], v[200:203], v[96:111]
  buffer_load_dwordx4 v1, s[12:15], s20 offen offset:0 lds
  v_exp_f32 v181, v149
  v_cvt_pk_bf16_f32 v192, v176, v177
  v_cvt_pk_bf16_f32 v193, v178, v179
  v_mfma_f32_32x32x16_bf16 v[160:175], a[32:35], v[228:231], v[160:175]
  buffer_load_dwordx4 v1, s[12:15], s20 offen offset:1024 lds
  v_exp_f32 v182, v150
  v_exp_f32 v183, v151
  v_mfma_f32_32x32x16_bf16 v[80:95], a[68:71], v[204:207], v[80:95]
  buffer_load_dwordx4 v1, s[12:15], s20 offen offset:2048 lds
  v_exp_f32 v184, v152
  v_exp_f32 v185, v153
  v_exp_f32 v186, v154
  v_exp_f32 v187, v155
  v_mfma_f32_32x32x16_bf16 v[96:111], a[76:79], v[204:207], v[96:111]
  v_exp_f32 v188, v156
  v_exp_f32 v189, v157
  v_exp_f32 v190, v158
  v_exp_f32 v191, v159
  v_cvt_pk_bf16_f32 v194, v180, v181
  v_cvt_pk_bf16_f32 v195, v182, v183
  v_cvt_pk_bf16_f32 v196, v184, v185
  v_cvt_pk_bf16_f32 v197, v186, v187
  v_add_u32 v2, s23, v2
  v_add_u32 v4, s23, v4
  v_mfma_f32_32x32x16_bf16 v[144:159], a[24:27], v[232:235], 0
  s_nop 0
  v_exp_f32 v176, v160
  v_exp_f32 v177, v161
  v_exp_f32 v178, v162
  v_mfma_f32_32x32x16_bf16 v[16:31], a[80:83], v[192:195], v[16:31]
  ds_read_b128 a[8:11], v2 offset:2048
  v_exp_f32 v179, v163
  v_exp_f32 v180, v164
  v_cvt_pk_bf16_f32 v200, v176, v177
  v_mfma_f32_32x32x16_bf16 v[144:159], a[28:31], v[236:239], v[144:159]
  ds_read_b128 a[76:79], v3 offset:6144
  v_exp_f32 v181, v165
  v_cvt_pk_bf16_f32 v198, v188, v189
  v_cvt_pk_bf16_f32 v199, v190, v191
  v_cvt_pk_bf16_f32 v201, v178, v179
  v_mfma_f32_32x32x16_bf16 v[32:47], a[88:91], v[192:195], v[32:47]
  buffer_load_dwordx4 v1, s[12:15], s20 offen offset:3072 lds
  v_exp_f32 v182, v166
  v_exp_f32 v183, v167
  v_mfma_f32_32x32x16_bf16 v[144:159], a[32:35], v[240:243], v[144:159]
  s_add_u32 m0, s22, 32768
  v_exp_f32 v184, v168
  v_exp_f32 v185, v169
  v_cvt_pk_bf16_f32 v202, v180, v181
  v_cvt_pk_bf16_f32 v203, v182, v183
  v_mfma_f32_32x32x16_bf16 v[16:31], a[84:87], v[196:199], v[16:31]
  buffer_load_dwordx4 v1, s[12:15], s28 offen offset:0 lds
  v_exp_f32 v186, v170
  v_exp_f32 v187, v171
  v_mfma_f32_32x32x16_bf16 v[32:47], a[92:95], v[196:199], v[32:47]
  s_nop 0
  v_exp_f32 v188, v172
  v_exp_f32 v189, v173
  v_exp_f32 v190, v174
  v_exp_f32 v191, v175
  v_cvt_pk_bf16_f32 v204, v184, v185
  v_cvt_pk_bf16_f32 v205, v186, v187
  v_mfma_f32_32x32x16_bf16 v[160:175], a[36:39], v[208:211], 0
  ds_read_b128 a[4:7], v2 offset:1024
  v_exp_f32 v176, v144
  v_exp_f32 v177, v145
  v_exp_f32 v178, v146
  v_mfma_f32_32x32x16_bf16 v[48:63], a[80:83], v[200:203], v[48:63]
  ds_read_b128 a[72:75], v3 offset:5120
  v_exp_f32 v179, v147
  v_exp_f32 v180, v148
  v_cvt_pk_bf16_f32 v192, v176, v177
  v_mfma_f32_32x32x16_bf16 v[160:175], a[40:43], v[212:215], v[160:175]
  buffer_load_dwordx4 v1, s[12:15], s28 offen offset:1024 lds
  v_exp_f32 v181, v149
  v_cvt_pk_bf16_f32 v206, v188, v189
  v_cvt_pk_bf16_f32 v207, v190, v191
  v_mfma_f32_32x32x16_bf16 v[64:79], a[88:91], v[200:203], v[64:79]
  buffer_load_dwordx4 v1, s[12:15], s28 offen offset:2048 lds
  v_exp_f32 v182, v150
  v_cvt_pk_bf16_f32 v193, v178, v179
  v_cvt_pk_bf16_f32 v194, v180, v181
  v_mfma_f32_32x32x16_bf16 v[160:175], a[44:47], v[216:219], v[160:175]
  v_exp_f32 v183, v151
  v_exp_f32 v184, v152
  v_exp_f32 v185, v153
  v_mfma_f32_32x32x16_bf16 v[48:63], a[84:87], v[204:207], v[48:63]
  v_exp_f32 v186, v154
  v_exp_f32 v187, v155
  v_cvt_pk_bf16_f32 v195, v182, v183
  v_cvt_pk_bf16_f32 v196, v184, v185
  v_mfma_f32_32x32x16_bf16 v[64:79], a[92:95], v[204:207], v[64:79]
  v_exp_f32 v188, v156
  v_exp_f32 v189, v157
  v_exp_f32 v190, v158
  v_exp_f32 v191, v159
  v_cvt_pk_bf16_f32 v197, v186, v187
  v_add_u32 v5, s23, v5
  v_mfma_f32_32x32x16_bf16 v[144:159], a[36:39], v[220:223], 0
  ds_read_b128 a[0:3], v2 offset:0
  v_exp_f32 v176, v160
  v_exp_f32 v177, v161
  v_exp_f32 v178, v162
  v_mfma_f32_32x32x16_bf16 v[80:95], a[80:83], v[192:195], v[80:95]
  ds_read_b128 a[20:23], v3 offset:2048
  v_exp_f32 v179, v163
  v_exp_f32 v180, v164
  v_cvt_pk_bf16_f32 v200, v176, v177
  v_mfma_f32_32x32x16_bf16 v[144:159], a[40:43], v[224:227], v[144:159]
  ds_read_b128 a[32:35], v4 offset:2048
  v_exp_f32 v181, v165
  v_cvt_pk_bf16_f32 v198, v188, v189
  v_cvt_pk_bf16_f32 v199, v190, v191
  v_cvt_pk_bf16_f32 v201, v178, v179
  v_mfma_f32_32x32x16_bf16 v[96:111], a[88:91], v[192:195], v[96:111]
  v_exp_f32 v182, v166
  v_exp_f32 v183, v167
  v_exp_f32 v184, v168
  v_mfma_f32_32x32x16_bf16 v[144:159], a[44:47], v[228:231], v[144:159]
  v_exp_f32 v185, v169
  v_exp_f32 v186, v170
  v_cvt_pk_bf16_f32 v202, v180, v181
  v_cvt_pk_bf16_f32 v203, v182, v183
  v_mfma_f32_32x32x16_bf16 v[80:95], a[84:87], v[196:199], v[80:95]
  v_exp_f32 v187, v171
  v_exp_f32 v188, v172
  v_exp_f32 v189, v173
  v_mfma_f32_32x32x16_bf16 v[96:111], a[92:95], v[196:199], v[96:111]
  v_exp_f32 v190, v174
  v_exp_f32 v191, v175
  v_cvt_pk_bf16_f32 v204, v184, v185
  v_cvt_pk_bf16_f32 v205, v186, v187
  v_mfma_f32_32x32x16_bf16 v[160:175], a[36:39], v[232:235], 0
  s_nop 0
  v_exp_f32 v176, v144
  v_exp_f32 v177, v145
  v_exp_f32 v178, v146
  v_mfma_f32_32x32x16_bf16 v[16:31], a[96:99], v[200:203], v[16:31]
  ds_read_b128 a[52:55], v2 offset:4096
  v_exp_f32 v179, v147
  v_exp_f32 v180, v148
  v_cvt_pk_bf16_f32 v192, v176, v177
  v_mfma_f32_32x32x16_bf16 v[160:175], a[40:43], v[236:239], v[160:175]
  ds_read_b128 a[60:63], v2 offset:6144
  v_exp_f32 v181, v149
  v_cvt_pk_bf16_f32 v206, v188, v189
  v_cvt_pk_bf16_f32 v207, v190, v191
  v_cvt_pk_bf16_f32 v193, v178, v179
  v_mfma_f32_32x32x16_bf16 v[32:47], a[104:107], v[200:203], v[32:47]
  ds_read_b128 a[28:31], v4 offset:1024
  v_exp_f32 v182, v150
  v_exp_f32 v183, v151
  v_cvt_pk_bf16_f32 v194, v180, v181
  v_mfma_f32_32x32x16_bf16 v[160:175], a[44:47], v[240:243], v[160:175]
  v_exp_f32 v184, v152
  v_exp_f32 v185, v153
  v_exp_f32 v186, v154
  v_mfma_f32_32x32x16_bf16 v[16:31], a[100:103], v[204:207], v[16:31]
  v_exp_f32 v187, v155
  v_exp_f32 v188, v156
  v_cvt_pk_bf16_f32 v195, v182, v183
  v_cvt_pk_bf16_f32 v196, v184, v185
  v_mfma_f32_32x32x16_bf16 v[32:47], a[108:111], v[204:207], v[32:47]
  s_waitcnt lgkmcnt(5)
  v_exp_f32 v189, v157
  v_exp_f32 v190, v158
  v_exp_f32 v191, v159
  v_cvt_pk_bf16_f32 v197, v186, v187
  v_mfma_f32_32x32x16_bf16 v[144:159], a[0:3], v[208:211], 0
  ds_read_b128 a[48:51], v2 offset:3072
  v_exp_f32 v176, v160
  v_exp_f32 v177, v161
  v_exp_f32 v178, v162
  v_mfma_f32_32x32x16_bf16 v[48:63], a[96:99], v[192:195], v[48:63]
  ds_read_b128 a[56:59], v2 offset:5120
  v_exp_f32 v179, v163
  v_exp_f32 v180, v164
  v_cvt_pk_bf16_f32 v200, v176, v177
  v_mfma_f32_32x32x16_bf16 v[144:159], a[4:7], v[212:215], v[144:159]
  ds_read_b128 a[24:27], v4 offset:0
  v_exp_f32 v181, v165
  v_cvt_pk_bf16_f32 v198, v188, v189
  v_cvt_pk_bf16_f32 v199, v190, v191
  v_cvt_pk_bf16_f32 v201, v178, v179
  v_mfma_f32_32x32x16_bf16 v[64:79], a[104:107], v[192:195], v[64:79]
  v_exp_f32 v182, v166
  v_exp_f32 v183, v167
  v_exp_f32 v184, v168
  v_mfma_f32_32x32x16_bf16 v[144:159], a[8:11], v[216:219], v[144:159]
  v_exp_f32 v185, v169
  v_exp_f32 v186, v170
  v_cvt_pk_bf16_f32 v202, v180, v181
  v_cvt_pk_bf16_f32 v203, v182, v183
  v_mfma_f32_32x32x16_bf16 v[48:63], a[100:103], v[196:199], v[48:63]
  v_exp_f32 v187, v171
  v_exp_f32 v188, v172
  v_exp_f32 v189, v173
  v_mfma_f32_32x32x16_bf16 v[64:79], a[108:111], v[196:199], v[64:79]
  v_exp_f32 v190, v174
  v_exp_f32 v191, v175
  v_cvt_pk_bf16_f32 v204, v184, v185
  v_cvt_pk_bf16_f32 v205, v186, v187
  s_sub_u32 s22, s22, s23
  s_sub_u32 s23, 0, s23
  s_add_u32 s24, s24, 2
  s_cmp_lt_u32 s24, 12
.p2align 6
L_loop_V:
  v_mfma_f32_32x32x16_bf16 v[160:175], a[0:3], v[220:223], 0
  ds_read_b128 a[12:15], v3 offset:0
  v_exp_f32 v176, v144
  v_exp_f32 v177, v145
  v_exp_f32 v178, v146
  v_mfma_f32_32x32x16_bf16 v[80:95], a[96:99], v[200:203], v[80:95]
  ds_read_b128 a[16:19], v3 offset:1024
  v_exp_f32 v179, v147
  v_exp_f32 v180, v148
  v_cvt_pk_bf16_f32 v192, v176, v177
  v_mfma_f32_32x32x16_bf16 v[160:175], a[4:7], v[224:227], v[160:175]
  ds_read_b128 a[36:39], v5 offset:0
  v_exp_f32 v181, v149
  v_cvt_pk_bf16_f32 v206, v188, v189
  v_cvt_pk_bf16_f32 v207, v190, v191
  v_cvt_pk_bf16_f32 v193, v178, v179
  v_mfma_f32_32x32x16_bf16 v[96:111], a[104:107], v[200:203], v[96:111]
  v_exp_f32 v182, v150
  v_exp_f32 v183, v151
  v_exp_f32 v184, v152
  v_mfma_f32_32x32x16_bf16 v[160:175], a[8:11], v[228:231], v[160:175]
  v_exp_f32 v185, v153
  v_exp_f32 v186, v154
  v_cvt_pk_bf16_f32 v194, v180, v181
  v_cvt_pk_bf16_f32 v195, v182, v183
  v_mfma_f32_32x32x16_bf16 v[80:95], a[100:103], v[204:207], v[80:95]
  v_exp_f32 v187, v155
  v_exp_f32 v188, v156
  v_exp_f32 v189, v157
  v_mfma_f32_32x32x16_bf16 v[96:111], a[108:111], v[204:207], v[96:111]
  v_exp_f32 v190, v158
  v_exp_f32 v191, v159
  v_cvt_pk_bf16_f32 v196, v184, v185
  v_cvt_pk_bf16_f32 v197, v186, v187
  v_mfma_f32_32x32x16_bf16 v[144:159], a[0:3], v[232:235], 0
  s_waitcnt lgkmcnt(4)
  v_exp_f32 v176, v160
  v_exp_f32 v177, v161
  v_exp_f32 v178, v162
  v_mfma_f32_32x32x16_bf16 v[16:31], a[48:51], v[192:195], v[16:31]
  ds_read_b128 a[68:71], v3 offset:4096
  v_exp_f32 v179, v163
  v_exp_f32 v180, v164
  v_cvt_pk_bf16_f32 v200, v176, v177
  v_mfma_f32_32x32x16_bf16 v[144:159], a[4:7], v[236:239], v[144:159]
  ds_read_b128 a[84:87], v4 offset:4096
  v_exp_f32 v181, v165
  v_cvt_pk_bf16_f32 v198, v188, v189
  v_cvt_pk_bf16_f32 v199, v190, v191
  v_cvt_pk_bf16_f32 v201, v178, v179
  v_mfma_f32_32x32x16_bf16 v[32:47], a[56:59], v[192:195], v[32:47]
  ds_read_b128 a[108:111], v5 offset:6144
  v_exp_f32 v182, v166
  v_exp_f32 v183, v167
  v_cvt_pk_bf16_f32 v202, v180, v181
  v_mfma_f32_32x32x16_bf16 v[144:159], a[8:11], v[240:243], v[144:159]
  v_exp_f32 v184, v168
  v_exp_f32 v185, v169
  v_exp_f32 v186, v170
  v_mfma_f32_32x32x16_bf16 v[16:31], a[52:55], v[196:199], v[16:31]
  v_exp_f32 v187, v171
  v_exp_f32 v188, v172
  v_cvt_pk_bf16_f32 v203, v182, v183
  v_cvt_pk_bf16_f32 v204, v184, v185
  v_mfma_f32_32x32x16_bf16 v[32:47], a[60:63], v[196:199], v[32:47]
  s_waitcnt lgkmcnt(4)
  v_exp_f32 v189, v173
  v_exp_f32 v190, v174
  v_exp_f32 v191, v175
  v_cvt_pk_bf16_f32 v205, v186, v187
  v_mfma_f32_32x32x16_bf16 v[160:175], a[12:15], v[208:211], 0
  ds_read_b128 a[64:67], v3 offset:3072
  v_exp_f32 v176, v144
  v_exp_f32 v177, v145
  v_exp_f32 v178, v146
  v_mfma_f32_32x32x16_bf16 v[48:63], a[48:51], v[200:203], v[48:63]
  ds_read_b128 a[80:83], v4 offset:3072
  v_exp_f32 v179, v147
  v_exp_f32 v180, v148
  v_cvt_pk_bf16_f32 v192, v176, v177
  v_mfma_f32_32x32x16_bf16 v[160:175], a[16:19], v[212:215], v[160:175]
  ds_read_b128 a[104:107], v5 offset:5120
  v_exp_f32 v181, v149
  v_cvt_pk_bf16_f32 v206, v188, v189
  v_cvt_pk_bf16_f32 v207, v190, v191
  v_cvt_pk_bf16_f32 v193, v178, v179
  v_mfma_f32_32x32x16_bf16 v[64:79], a[56:59], v[200:203], v[64:79]
  v_exp_f32 v182, v150
  v_exp_f32 v183, v151
  v_exp_f32 v184, v152
  v_mfma_f32_32x32x16_bf16 v[160:175], a[20:23], v[216:219], v[160:175]
  v_exp_f32 v185, v153
  v_exp_f32 v186, v154
  v_cvt_pk_bf16_f32 v194, v180, v181
  v_cvt_pk_bf16_f32 v195, v182, v183
  v_mfma_f32_32x32x16_bf16 v[48:63], a[52:55], v[204:207], v[48:63]
  v_exp_f32 v187, v155
  v_exp_f32 v188, v156
  v_exp_f32 v189, v157
  v_mfma_f32_32x32x16_bf16 v[64:79], a[60:63], v[204:207], v[64:79]
  v_exp_f32 v190, v158
  v_exp_f32 v191, v159
  v_cvt_pk_bf16_f32 v196, v184, v185
  v_cvt_pk_bf16_f32 v197, v186, v187
  v_mfma_f32_32x32x16_bf16 v[144:159], a[12:15], v[220:223], 0
  ds_read_b128 a[92:95], v4 offset:6144
  v_exp_f32 v176, v160
  v_exp_f32 v177, v161
  v_exp_f32 v178, v162
  v_mfma_f32_32x32x16_bf16 v[80:95], a[48:51], v[192:195], v[80:95]
  ds_read_b128 a[44:47], v5 offset:2048
  v_exp_f32 v179, v163
  v_exp_f32 v180, v164
  v_cvt_pk_bf16_f32 v200, v176, v177
  v_mfma_f32_32x32x16_bf16 v[144:159], a[16:19], v[224:227], v[144:159]
  ds_read_b128 a[100:103], v5 offset:4096
  v_exp_f32 v181, v165
  v_cvt_pk_bf16_f32 v198, v188, v189
  v_cvt_pk_bf16_f32 v199, v190, v191
  v_cvt_pk_bf16_f32 v201, v178, v179
  v_mfma_f32_32x32x16_bf16 v[96:111], a[56:59], v[192:195], v[96:111]
  s_add_u32 s20, s20, 28672
  v_exp_f32 v182, v166
  v_exp_f32 v183, v167
  v_exp_f32 v184, v168
  v_mfma_f32_32x32x16_bf16 v[144:159], a[20:23], v[228:231], v[144:159]
  s_cmp_ge_u32 s20, s21
  s_cselect_b32 s25, 401408, 0
  v_exp_f32 v185, v169
  v_exp_f32 v186, v170
  v_cvt_pk_bf16_f32 v202, v180, v181
  v_mfma_f32_32x32x16_bf16 v[80:95], a[52:55], v[196:199], v[80:95]
  s_sub_u32 s20, s20, s25
  v_exp_f32 v187, v171
  v_exp_f32 v188, v172
  v_cvt_pk_bf16_f32 v203, v182, v183
  v_cvt_pk_bf16_f32 v204, v184, v185
  v_mfma_f32_32x32x16_bf16 v[96:111], a[60:63], v[196:199], v[96:111]
  s_add_u32 s28, s20, 4096
  v_exp_f32 v189, v173
  v_exp_f32 v190, v174
  v_exp_f32 v191, v175
  v_cvt_pk_bf16_f32 v205, v186, v187
  v_mfma_f32_32x32x16_bf16 v[160:175], a[12:15], v[232:235], 0
  s_waitcnt lgkmcnt(5)
  v_exp_f32 v176, v144
  v_exp_f32 v177, v145
  v_exp_f32 v178, v146
  v_mfma_f32_32x32x16_bf16 v[16:31], a[64:67], v[200:203], v[16:31]
  ds_read_b128 a[88:91], v4 offset:5120
  v_exp_f32 v179, v147
  v_exp_f32 v180, v148
  v_cvt_pk_bf16_f32 v192, v176, v177
  v_mfma_f32_32x32x16_bf16 v[160:175], a[16:19], v[236:239], v[160:175]
  ds_read_b128 a[40:43], v5 offset:1024
  v_exp_f32 v181, v149
  v_cvt_pk_bf16_f32 v206, v188, v189
  v_cvt_pk_bf16_f32 v207, v190, v191
  v_cvt_pk_bf16_f32 v193, v178, v179
  v_mfma_f32_32x32x16_bf16 v[32:47], a[72:75], v[200:203], v[32:47]
  ds_read_b128 a[96:99], v5 offset:3072
  v_exp_f32 v182, v150
  v_exp_f32 v183, v151
  v_cvt_pk_bf16_f32 v194, v180, v181
  v_mfma_f32_32x32x16_bf16 v[160:175], a[20:23], v[240:243], v[160:175]
  v_exp_f32 v184, v152
  v_exp_f32 v185, v153
  v_exp_f32 v186, v154
  v_mfma_f32_32x32x16_bf16 v[16:31], a[68:71], v[204:207], v[16:31]
  v_exp_f32 v187, v155
  v_exp_f32 v188, v156
  v_cvt_pk_bf16_f32 v195, v182, v183
  v_cvt_pk_bf16_f32 v196, v184, v185
  v_mfma_f32_32x32x16_bf16 v[32:47], a[76:79], v[204:207], v[32:47]
  s_waitcnt lgkmcnt(15)
  v_exp_f32 v189, v157
  v_exp_f32 v190, v158
  v_exp_f32 v191, v159
  v_cvt_pk_bf16_f32 v197, v186, v187
  v_mfma_f32_32x32x16_bf16 v[144:159], a[24:27], v[208:211], 0
  v_exp_f32 v176, v160
  v_exp_f32 v177, v161
  v_mfma_f32_32x32x16_bf16 v[48:63], a[64:67], v[192:195], v[48:63]
  v_exp_f32 v178, v162
  v_exp_f32 v179, v163
  v_exp_f32 v180, v164
  v_mfma_f32_32x32x16_bf16 v[144:159], a[28:31], v[212:215], v[144:159]
  v_exp_f32 v181, v165
  v_cvt_pk_bf16_f32 v198, v188, v189
  v_cvt_pk_bf16_f32 v199, v190, v191
  v_cvt_pk_bf16_f32 v200, v176, v177
  v_cvt_pk_bf16_f32 v201, v178, v179
  v_mfma_f32_32x32x16_bf16 v[64:79], a[72:75], v[192:195], v[64:79]
  v_exp_f32 v182, v166
  v_exp_f32 v183, v167
  v_exp_f32 v184, v168
  v_mfma_f32_32x32x16_bf16 v[144:159], a[32:35], v[216:219], v[144:159]
  v_exp_f32 v185, v169
  v_exp_f32 v186, v170
  v_cvt_pk_bf16_f32 v202, v180, v181
  v_cvt_pk_bf16_f32 v203, v182, v183
  v_mfma_f32_32x32x16_bf16 v[48:63], a[68:71], v[196:199], v[48:63]
  v_exp_f32 v187, v171
  v_exp_f32 v188, v172
  v_exp_f32 v189, v173
  v_mfma_f32_32x32x16_bf16 v[64:79], a[76:79], v[196:199], v[64:79]
  v_exp_f32 v190, v174
  v_exp_f32 v191, v175
  v_cvt_pk_bf16_f32 v204, v184, v185
  v_cvt_pk_bf16_f32 v205, v186, v187
  v_mfma_f32_32x32x16_bf16 v[160:175], a[24:27], v[220:223], 0
  s_waitcnt vmcnt(0) lgkmcnt(0)
  v_exp_f32 v176, v144
  v_exp_f32 v177, v145
  v_exp_f32 v178, v146
  v_mfma_f32_32x32x16_bf16 v[80:95], a[64:67], v[200:203], v[80:95]
  s_barrier
  v_exp_f32 v179, v147
  v_exp_f32 v180, v148
  v_exp_f32 v181, v149
  v_mfma_f32_32x32x16_bf16 v[160:175], a[28:31], v[224:227], v[160:175]
  s_add_u32 m0, s22, 0
  v_exp_f32 v182, v150
  v_cvt_pk_bf16_f32 v206, v188, v189
  v_cvt_pk_bf16_f32 v207, v190, v191
  v_cvt_pk_bf16_f32 v192, v176, v177
  v_cvt_pk_bf16_f32 v193, v178, v179
  v_mfma_f32_32x32x16_bf16 v[96:111], a[72:75], v[200:203], v[96:111]
  buffer_load_dwordx4 v1, s[12:15], s20 offen offset:0 lds
  v_exp_f32 v183, v151
  v_exp_f32 v184, v152
  v_mfma_f32_32x32x16_bf16 v[160:175], a[32:35], v[228:231], v[160:175]
  buffer_load_dwordx4 v1, s[12:15], s20 offen offset:1024 lds
  v_exp_f32 v185, v153
  v_cvt_pk_bf16_f32 v194, v180, v181
  v_cvt_pk_bf16_f32 v195, v182, v183
  v_mfma_f32_32x32x16_bf16 v[80:95], a[68:71], v[204:207], v[80:95]
  v_exp_f32 v186, v154
  v_exp_f32 v187, v155
  v_exp_f32 v188, v156
  v_mfma_f32_32x32x16_bf16 v[96:111], a[76:79], v[204:207], v[96:111]
  v_exp_f32 v189, v157
  v_exp_f32 v190, v158
  v_exp_f32 v191, v159
  v_cvt_pk_bf16_f32 v196, v184, v185
  v_cvt_pk_bf16_f32 v197, v186, v187
  v_mfma_f32_32x32x16_bf16 v[144:159], a[24:27], v[232:235], 0
  s_nop 0
  v_exp_f32 v176, v160
  v_exp_f32 v177, v161
  v_exp_f32 v178, v162
  v_mfma_f32_32x32x16_bf16 v[16:31], a[80:83], v[192:195], v[16:31]
  ds_read_b128 a[8:11], v2 offset:30720
  v_exp_f32 v179, v163
  v_exp_f32 v180, v164
  v_cvt_pk_bf16_f32 v200, v176, v177
  v_mfma_f32_32x32x16_bf16 v[144:159], a[28:31], v[236:239], v[144:159]
  ds_read_b128 a[76:79], v3 offset:34816
  v_exp_f32 v181, v165
  v_cvt_pk_bf16_f32 v198, v188, v189
  v_cvt_pk_bf16_f32 v199, v190, v191
  v_cvt_pk_bf16_f32 v201, v178, v179
  v_mfma_f32_32x32x16_bf16 v[32:47], a[88:91], v[192:195], v[32:47]
  buffer_load_dwordx4 v1, s[12:15], s20 offen offset:2048 lds
  v_exp_f32 v182, v166
  v_exp_f32 v183, v167
  v_mfma_f32_32x32x16_bf16 v[144:159], a[32:35], v[240:243], v[144:159]
  v_exp_f32 v184, v168
  v_exp_f32 v185, v169
  v_cvt_pk_bf16_f32 v202, v180, v181
  v_cvt_pk_bf16_f32 v203, v182, v183
  v_mfma_f32_32x32x16_bf16 v[16:31], a[84:87], v[196:199], v[16:31]
  v_exp_f32 v186, v170
  v_exp_f32 v187, v171
  v_exp_f32 v188, v172
  v_mfma_f32_32x32x16_bf16 v[32:47], a[92:95], v[196:199], v[32:47]
  s_nop 0
  v_exp_f32 v189, v173
  v_exp_f32 v190, v174
  v_exp_f32 v191, v175
  v_cvt_pk_bf16_f32 v204, v184, v185
  v_cvt_pk_bf16_f32 v205, v186, v187
  v_mfma_f32_32x32x16_bf16 v[160:175], a[36:39], v[208:211], 0
  ds_read_b128 a[4:7], v2 offset:29696
  v_exp_f32 v176, v144
  v_exp_f32 v177, v145
  v_exp_f32 v178, v146
  v_mfma_f32_32x32x16_bf16 v[48:63], a[80:83], v[200:203], v[48:63]
  ds_read_b128 a[72:75], v3 offset:33792
  v_exp_f32 v179, v147
  v_exp_f32 v180, v148
  v_cvt_pk_bf16_f32 v192, v176, v177
  v_mfma_f32_32x32x16_bf16 v[160:175], a[40:43], v[212:215], v[160:175]
  buffer_load_dwordx4 v1, s[12:15], s20 offen offset:3072 lds
  v_exp_f32 v181, v149
  v_cvt_pk_bf16_f32 v206, v188, v189
  v_cvt_pk_bf16_f32 v207, v190, v191
  v_mfma_f32_32x32x16_bf16 v[64:79], a[88:91], v[200:203], v[64:79]
  v_exp_f32 v182, v150
  v_exp_f32 v183, v151
  v_cvt_pk_bf16_f32 v193, v178, v179
  v_cvt_pk_bf16_f32 v194, v180, v181
  v_mfma_f32_32x32x16_bf16 v[160:175], a[44:47], v[216:219], v[160:175]
  v_exp_f32 v184, v152
  v_exp_f32 v185, v153
  v_exp_f32 v186, v154
  v_mfma_f32_32x32x16_bf16 v[48:63], a[84:87], v[204:207], v[48:63]
  v_exp_f32 v187, v155
  v_exp_f32 v188, v156
  v_cvt_pk_bf16_f32 v195, v182, v183
  v_cvt_pk_bf16_f32 v196, v184, v185
  v_mfma_f32_32x32x16_bf16 v[64:79], a[92:95], v[204:207], v[64:79]
  v_exp_f32 v189, v157
  v_exp_f32 v190, v158
  v_exp_f32 v191, v159
  v_cvt_pk_bf16_f32 v197, v186, v187
  v_mfma_f32_32x32x16_bf16 v[144:159], a[36:39], v[220:223], 0
  ds_read_b128 a[0:3], v2 offset:28672
  v_exp_f32 v176, v160
  v_exp_f32 v177, v161
  v_exp_f32 v178, v162
  v_mfma_f32_32x32x16_bf16 v[80:95], a[80:83], v[192:195], v[80:95]
  ds_read_b128 a[20:23], v3 offset:30720
  v_exp_f32 v179, v163
  v_exp_f32 v180, v164
  v_cvt_pk_bf16_f32 v200, v176, v177
  v_mfma_f32_32x32x16_bf16 v[144:159], a[40:43], v[224:227], v[144:159]
  ds_read_b128 a[32:35], v4 offset:30720
  v_exp_f32 v181, v165
  v_cvt_pk_bf16_f32 v198, v188, v189
  v_cvt_pk_bf16_f32 v199, v190, v191
  v_cvt_pk_bf16_f32 v201, v178, v179
  v_mfma_f32_32x32x16_bf16 v[96:111], a[88:91], v[192:195], v[96:111]
  s_add_u32 m0, s22, 4096
  v_exp_f32 v182, v166
  v_exp_f32 v183, v167
  v_exp_f32 v184, v168
  v_mfma_f32_32x32x16_bf16 v[144:159], a[44:47], v[228:231], v[144:159]
  buffer_load_dwordx4 v1, s[12:15], s28 offen offset:0 lds
  v_exp_f32 v185, v169
  v_cvt_pk_bf16_f32 v202, v180, v181
  v_cvt_pk_bf16_f32 v203, v182, v183
  v_mfma_f32_32x32x16_bf16 v[80:95], a[84:87], v[196:199], v[80:95]
  v_exp_f32 v186, v170
  v_exp_f32 v187, v171
  v_exp_f32 v188, v172
  v_mfma_f32_32x32x16_bf16 v[96:111], a[92:95], v[196:199], v[96:111]
  v_exp_f32 v189, v173
  v_exp_f32 v190, v174
  v_exp_f32 v191, v175
  v_cvt_pk_bf16_f32 v204, v184, v185
  v_cvt_pk_bf16_f32 v205, v186, v187
  v_mfma_f32_32x32x16_bf16 v[160:175], a[36:39], v[232:235], 0
  s_nop 0
  v_exp_f32 v176, v144
  v_exp_f32 v177, v145
  v_exp_f32 v178, v146
  v_mfma_f32_32x32x16_bf16 v[16:31], a[96:99], v[200:203], v[16:31]
  ds_read_b128 a[52:55], v2 offset:32768
  v_exp_f32 v179, v147
  v_exp_f32 v180, v148
  v_cvt_pk_bf16_f32 v192, v176, v177
  v_mfma_f32_32x32x16_bf16 v[160:175], a[40:43], v[236:239], v[160:175]
  ds_read_b128 a[60:63], v2 offset:34816
  v_exp_f32 v181, v149
  v_cvt_pk_bf16_f32 v206, v188, v189
  v_cvt_pk_bf16_f32 v207, v190, v191
  v_cvt_pk_bf16_f32 v193, v178, v179
  v_mfma_f32_32x32x16_bf16 v[32:47], a[104:107], v[200:203], v[32:47]
  ds_read_b128 a[28:31], v4 offset:29696
  v_exp_f32 v182, v150
  v_exp_f32 v183, v151
  v_cvt_pk_bf16_f32 v194, v180, v181
  v_mfma_f32_32x32x16_bf16 v[160:175], a[44:47], v[240:243], v[160:175]
  buffer_load_dwordx4 v1, s[12:15], s28 offen offset:1024 lds
  v_exp_f32 v184, v152
  v_exp_f32 v185, v153
  v_mfma_f32_32x32x16_bf16 v[16:31], a[100:103], v[204:207], v[16:31]
  v_exp_f32 v186, v154
  v_exp_f32 v187, v155
  v_cvt_pk_bf16_f32 v195, v182, v183
  v_cvt_pk_bf16_f32 v196, v184, v185
  v_mfma_f32_32x32x16_bf16 v[32:47], a[108:111], v[204:207], v[32:47]
  s_waitcnt lgkmcnt(5)
  v_exp_f32 v188, v156
  v_exp_f32 v189, v157
  v_exp_f32 v190, v158
  v_exp_f32 v191, v159
  v_cvt_pk_bf16_f32 v197, v186, v187
  v_mfma_f32_32x32x16_bf16 v[144:159], a[0:3], v[208:211], 0
  ds_read_b128 a[48:51], v2 offset:31744
  v_exp_f32 v176, v160
  v_exp_f32 v177, v161
  v_exp_f32 v178, v162
  v_mfma_f32_32x32x16_bf16 v[48:63], a[96:99], v[192:195], v[48:63]
  ds_read_b128 a[56:59], v2 offset:33792
  v_exp_f32 v179, v163
  v_exp_f32 v180, v164
  v_cvt_pk_bf16_f32 v200, v176, v177
  v_mfma_f32_32x32x16_bf16 v[144:159], a[4:7], v[212:215], v[144:159]
  ds_read_b128 a[24:27], v4 offset:28672
  v_exp_f32 v181, v165
  v_cvt_pk_bf16_f32 v198, v188, v189
  v_cvt_pk_bf16_f32 v199, v190, v191
  v_cvt_pk_bf16_f32 v201, v178, v179
  v_mfma_f32_32x32x16_bf16 v[64:79], a[104:107], v[192:195], v[64:79]
  buffer_load_dwordx4 v1, s[12:15], s28 offen offset:2048 lds
  v_exp_f32 v182, v166
  v_exp_f32 v183, v167
  v_mfma_f32_32x32x16_bf16 v[144:159], a[8:11], v[216:219], v[144:159]
  v_exp_f32 v184, v168
  v_exp_f32 v185, v169
  v_cvt_pk_bf16_f32 v202, v180, v181
  v_cvt_pk_bf16_f32 v203, v182, v183
  v_mfma_f32_32x32x16_bf16 v[48:63], a[100:103], v[196:199], v[48:63]
  v_exp_f32 v186, v170
  v_exp_f32 v187, v171
  v_exp_f32 v188, v172
  v_mfma_f32_32x32x16_bf16 v[64:79], a[108:111], v[196:199], v[64:79]
  v_exp_f32 v189, v173
  v_exp_f32 v190, v174
  v_exp_f32 v191, v175
  v_cvt_pk_bf16_f32 v204, v184, v185
  v_cvt_pk_bf16_f32 v205, v186, v187
  v_mfma_f32_32x32x16_bf16 v[160:175], a[0:3], v[220:223], 0
  ds_read_b128 a[12:15], v3 offset:28672
  v_exp_f32 v176, v144
  v_exp_f32 v177, v145
  v_exp_f32 v178, v146
  v_mfma_f32_32x32x16_bf16 v[80:95], a[96:99], v[200:203], v[80:95]
  ds_read_b128 a[16:19], v3 offset:29696
  v_exp_f32 v179, v147
  v_exp_f32 v180, v148
  v_cvt_pk_bf16_f32 v192, v176, v177
  v_mfma_f32_32x32x16_bf16 v[160:175], a[4:7], v[224:227], v[160:175]
  ds_read_b128 a[36:39], v5 offset:28672
  v_exp_f32 v181, v149
  v_cvt_pk_bf16_f32 v206, v188, v189
  v_cvt_pk_bf16_f32 v207, v190, v191
  v_cvt_pk_bf16_f32 v193, v178, v179
  v_mfma_f32_32x32x16_bf16 v[96:111], a[104:107], v[200:203], v[96:111]
  v_exp_f32 v182, v150
  v_exp_f32 v183, v151
  v_exp_f32 v184, v152
  v_mfma_f32_32x32x16_bf16 v[160:175], a[8:11], v[228:231], v[160:175]
  v_exp_f32 v185, v153
  v_exp_f32 v186, v154
  v_cvt_pk_bf16_f32 v194, v180, v181
  v_cvt_pk_bf16_f32 v195, v182, v183
  v_mfma_f32_32x32x16_bf16 v[80:95], a[100:103], v[204:207], v[80:95]
  v_exp_f32 v187, v155
  v_exp_f32 v188, v156
  v_exp_f32 v189, v157
  v_mfma_f32_32x32x16_bf16 v[96:111], a[108:111], v[204:207], v[96:111]
  v_exp_f32 v190, v158
  v_exp_f32 v191, v159
  v_cvt_pk_bf16_f32 v196, v184, v185
  v_cvt_pk_bf16_f32 v197, v186, v187
  v_mfma_f32_32x32x16_bf16 v[144:159], a[0:3], v[232:235], 0
  s_waitcnt lgkmcnt(4)
  v_exp_f32 v176, v160
  v_exp_f32 v177, v161
  v_exp_f32 v178, v162
  v_mfma_f32_32x32x16_bf16 v[16:31], a[48:51], v[192:195], v[16:31]
  ds_read_b128 a[68:71], v3 offset:32768
  v_exp_f32 v179, v163
  v_exp_f32 v180, v164
  v_cvt_pk_bf16_f32 v200, v176, v177
  v_mfma_f32_32x32x16_bf16 v[144:159], a[4:7], v[236:239], v[144:159]
  ds_read_b128 a[84:87], v4 offset:32768
  v_exp_f32 v181, v165
  v_cvt_pk_bf16_f32 v198, v188, v189
  v_cvt_pk_bf16_f32 v199, v190, v191
  v_cvt_pk_bf16_f32 v201, v178, v179
  v_mfma_f32_32x32x16_bf16 v[32:47], a[56:59], v[192:195], v[32:47]
  ds_read_b128 a[108:111], v5 offset:34816
  v_exp_f32 v182, v166
  v_exp_f32 v183, v167
  v_cvt_pk_bf16_f32 v202, v180, v181
  v_mfma_f32_32x32x16_bf16 v[144:159], a[8:11], v[240:243], v[144:159]
  v_exp_f32 v184, v168
  v_exp_f32 v185, v169
  v_exp_f32 v186, v170
  v_mfma_f32_32x32x16_bf16 v[16:31], a[52:55], v[196:199], v[16:31]
  v_exp_f32 v187, v171
  v_exp_f32 v188, v172
  v_cvt_pk_bf16_f32 v203, v182, v183
  v_cvt_pk_bf16_f32 v204, v184, v185
  v_mfma_f32_32x32x16_bf16 v[32:47], a[60:63], v[196:199], v[32:47]
  s_waitcnt lgkmcnt(4)
  v_exp_f32 v189, v173
  v_exp_f32 v190, v174
  v_exp_f32 v191, v175
  v_cvt_pk_bf16_f32 v205, v186, v187
  v_mfma_f32_32x32x16_bf16 v[160:175], a[12:15], v[208:211], 0
  ds_read_b128 a[64:67], v3 offset:31744
  v_exp_f32 v176, v144
  v_exp_f32 v177, v145
  v_exp_f32 v178, v146
  v_mfma_f32_32x32x16_bf16 v[48:63], a[48:51], v[200:203], v[48:63]
  ds_read_b128 a[80:83], v4 offset:31744
  v_exp_f32 v179, v147
  v_exp_f32 v180, v148
  v_cvt_pk_bf16_f32 v192, v176, v177
  v_mfma_f32_32x32x16_bf16 v[160:175], a[16:19], v[212:215], v[160:175]
  ds_read_b128 a[104:107], v5 offset:33792
  v_exp_f32 v181, v149
  v_cvt_pk_bf16_f32 v206, v188, v189
  v_cvt_pk_bf16_f32 v207, v190, v191
  v_cvt_pk_bf16_f32 v193, v178, v179
  v_mfma_f32_32x32x16_bf16 v[64:79], a[56:59], v[200:203], v[64:79]
  v_exp_f32 v182, v150
  v_exp_f32 v183, v151
  v_exp_f32 v184, v152
  v_mfma_f32_32x32x16_bf16 v[160:175], a[20:23], v[216:219], v[160:175]
  v_exp_f32 v185, v153
  v_exp_f32 v186, v154
  v_cvt_pk_bf16_f32 v194, v180, v181
  v_cvt_pk_bf16_f32 v195, v182, v183
  v_mfma_f32_32x32x16_bf16 v[48:63], a[52:55], v[204:207], v[48:63]
  v_exp_f32 v187, v155
  v_exp_f32 v188, v156
  v_exp_f32 v189, v157
  v_mfma_f32_32x32x16_bf16 v[64:79], a[60:63], v[204:207], v[64:79]
  v_exp_f32 v190, v158
  v_exp_f32 v191, v159
  v_cvt_pk_bf16_f32 v196, v184, v185
  v_cvt_pk_bf16_f32 v197, v186, v187
  v_mfma_f32_32x32x16_bf16 v[144:159], a[12:15], v[220:223], 0
  ds_read_b128 a[92:95], v4 offset:34816
  v_exp_f32 v176, v160
  v_exp_f32 v177, v161
  v_exp_f32 v178, v162
  v_mfma_f32_32x32x16_bf16 v[80:95], a[48:51], v[192:195], v[80:95]
  ds_read_b128 a[44:47], v5 offset:30720
  v_exp_f32 v179, v163
  v_exp_f32 v180, v164
  v_cvt_pk_bf16_f32 v200, v176, v177
  v_mfma_f32_32x32x16_bf16 v[144:159], a[16:19], v[224:227], v[144:159]
  ds_read_b128 a[100:103], v5 offset:32768
  v_exp_f32 v181, v165
  v_cvt_pk_bf16_f32 v198, v188, v189
  v_cvt_pk_bf16_f32 v199, v190, v191
  v_cvt_pk_bf16_f32 v201, v178, v179
  v_mfma_f32_32x32x16_bf16 v[96:111], a[56:59], v[192:195], v[96:111]
  s_add_u32 s20, s20, 28672
  v_exp_f32 v182, v166
  v_exp_f32 v183, v167
  v_exp_f32 v184, v168
  v_mfma_f32_32x32x16_bf16 v[144:159], a[20:23], v[228:231], v[144:159]
  s_cmp_ge_u32 s20, s21
  s_cselect_b32 s25, 401408, 0
  v_exp_f32 v185, v169
  v_exp_f32 v186, v170
  v_cvt_pk_bf16_f32 v202, v180, v181
  v_mfma_f32_32x32x16_bf16 v[80:95], a[52:55], v[196:199], v[80:95]
  s_sub_u32 s20, s20, s25
  v_exp_f32 v187, v171
  v_exp_f32 v188, v172
  v_cvt_pk_bf16_f32 v203, v182, v183
  v_cvt_pk_bf16_f32 v204, v184, v185
  v_mfma_f32_32x32x16_bf16 v[96:111], a[60:63], v[196:199], v[96:111]
  s_add_u32 s28, s20, 4096
  v_exp_f32 v189, v173
  v_exp_f32 v190, v174
  v_exp_f32 v191, v175
  v_cvt_pk_bf16_f32 v205, v186, v187
  v_mfma_f32_32x32x16_bf16 v[160:175], a[12:15], v[232:235], 0
  s_waitcnt lgkmcnt(5)
  v_exp_f32 v176, v144
  v_exp_f32 v177, v145
  v_exp_f32 v178, v146
  v_mfma_f32_32x32x16_bf16 v[16:31], a[64:67], v[200:203], v[16:31]
  ds_read_b128 a[88:91], v4 offset:33792
  v_exp_f32 v179, v147
  v_exp_f32 v180, v148
  v_cvt_pk_bf16_f32 v192, v176, v177
  v_mfma_f32_32x32x16_bf16 v[160:175], a[16:19], v[236:239], v[160:175]
  ds_read_b128 a[40:43], v5 offset:29696
  v_exp_f32 v181, v149
  v_cvt_pk_bf16_f32 v206, v188, v189
  v_cvt_pk_bf16_f32 v207, v190, v191
  v_cvt_pk_bf16_f32 v193, v178, v179
  v_mfma_f32_32x32x16_bf16 v[32:47], a[72:75], v[200:203], v[32:47]
  ds_read_b128 a[96:99], v5 offset:31744
  v_exp_f32 v182, v150
  v_exp_f32 v183, v151
  v_cvt_pk_bf16_f32 v194, v180, v181
  v_mfma_f32_32x32x16_bf16 v[160:175], a[20:23], v[240:243], v[160:175]
  v_exp_f32 v184, v152
  v_exp_f32 v185, v153
  v_exp_f32 v186, v154
  v_mfma_f32_32x32x16_bf16 v[16:31], a[68:71], v[204:207], v[16:31]
  v_exp_f32 v187, v155
  v_exp_f32 v188, v156
  v_cvt_pk_bf16_f32 v195, v182, v183
  v_cvt_pk_bf16_f32 v196, v184, v185
  v_mfma_f32_32x32x16_bf16 v[32:47], a[76:79], v[204:207], v[32:47]
  s_waitcnt lgkmcnt(15)
  v_exp_f32 v189, v157
  v_exp_f32 v190, v158
  v_exp_f32 v191, v159
  v_cvt_pk_bf16_f32 v197, v186, v187
  v_mfma_f32_32x32x16_bf16 v[144:159], a[24:27], v[208:211], 0
  v_exp_f32 v176, v160
  v_exp_f32 v177, v161
  v_exp_f32 v178, v162
  v_mfma_f32_32x32x16_bf16 v[48:63], a[64:67], v[192:195], v[48:63]
  v_exp_f32 v179, v163
  v_exp_f32 v180, v164
  v_cvt_pk_bf16_f32 v200, v176, v177
  v_mfma_f32_32x32x16_bf16 v[144:159], a[28:31], v[212:215], v[144:159]
  v_exp_f32 v181, v165
  v_exp_f32 v182, v166
  v_cvt_pk_bf16_f32 v198, v188, v189
  v_cvt_pk_bf16_f32 v199, v190, v191
  v_mfma_f32_32x32x16_bf16 v[64:79], a[72:75], v[192:195], v[64:79]
  v_exp_f32 v183, v167
  v_exp_f32 v184, v168
  v_cvt_pk_bf16_f32 v201, v178, v179
  v_cvt_pk_bf16_f32 v202, v180, v181
  v_mfma_f32_32x32x16_bf16 v[144:159], a[32:35], v[216:219], v[144:159]
  v_exp_f32 v185, v169
  v_exp_f32 v186, v170
  v_exp_f32 v187, v171
  v_mfma_f32_32x32x16_bf16 v[48:63], a[68:71], v[196:199], v[48:63]
  v_exp_f32 v188, v172
  v_exp_f32 v189, v173
  v_cvt_pk_bf16_f32 v203, v182, v183
  v_cvt_pk_bf16_f32 v204, v184, v185
  v_mfma_f32_32x32x16_bf16 v[64:79], a[76:79], v[196:199], v[64:79]
  v_exp_f32 v190, v174
  v_exp_f32 v191, v175
  v_cvt_pk_bf16_f32 v205, v186, v187
  v_add_u32 v3, s23, v3
  v_mfma_f32_32x32x16_bf16 v[160:175], a[24:27], v[220:223], 0
  s_waitcnt vmcnt(0) lgkmcnt(0)
  v_exp_f32 v176, v144
  v_exp_f32 v177, v145
  v_exp_f32 v178, v146
  v_mfma_f32_32x32x16_bf16 v[80:95], a[64:67], v[200:203], v[80:95]
  s_barrier
  v_exp_f32 v179, v147
  v_exp_f32 v180, v148
  v_exp_f32 v181, v149
  v_mfma_f32_32x32x16_bf16 v[160:175], a[28:31], v[224:227], v[160:175]
  s_add_u32 m0, s22, 28672
  v_exp_f32 v182, v150
  v_cvt_pk_bf16_f32 v206, v188, v189
  v_cvt_pk_bf16_f32 v207, v190, v191
  v_cvt_pk_bf16_f32 v192, v176, v177
  v_cvt_pk_bf16_f32 v193, v178, v179
  v_mfma_f32_32x32x16_bf16 v[96:111], a[72:75], v[200:203], v[96:111]
  buffer_load_dwordx4 v1, s[12:15], s20 offen offset:0 lds
  v_exp_f32 v183, v151
  v_exp_f32 v184, v152
  v_mfma_f32_32x32x16_bf16 v[160:175], a[32:35], v[228:231], v[160:175]
  buffer_load_dwordx4 v1, s[12:15], s20 offen offset:1024 lds
  v_exp_f32 v185, v153
  v_cvt_pk_bf16_f32 v194, v180, v181
  v_cvt_pk_bf16_f32 v195, v182, v183
  v_mfma_f32_32x32x16_bf16 v[80:95], a[68:71], v[204:207], v[80:95]
  v_exp_f32 v186, v154
  v_exp_f32 v187, v155
  v_exp_f32 v188, v156
  v_mfma_f32_32x32x16_bf16 v[96:111], a[76:79], v[204:207], v[96:111]
  v_exp_f32 v189, v157
  v_exp_f32 v190, v158
  v_exp_f32 v191, v159
  v_cvt_pk_bf16_f32 v196, v184, v185
  v_cvt_pk_bf16_f32 v197, v186, v187
  v_add_u32 v2, s23, v2
  v_add_u32 v4, s23, v4
  v_mfma_f32_32x32x16_bf16 v[144:159], a[24:27], v[232:235], 0
  s_nop 0
  v_exp_f32 v176, v160
  v_exp_f32 v177, v161
  v_exp_f32 v178, v162
  v_mfma_f32_32x32x16_bf16 v[16:31], a[80:83], v[192:195], v[16:31]
  ds_read_b128 a[8:11], v2 offset:2048
  v_exp_f32 v179, v163
  v_exp_f32 v180, v164
  v_cvt_pk_bf16_f32 v200, v176, v177
  v_mfma_f32_32x32x16_bf16 v[144:159], a[28:31], v[236:239], v[144:159]
  ds_read_b128 a[76:79], v3 offset:6144
  v_exp_f32 v181, v165
  v_cvt_pk_bf16_f32 v198, v188, v189
  v_cvt_pk_bf16_f32 v199, v190, v191
  v_cvt_pk_bf16_f32 v201, v178, v179
  v_mfma_f32_32x32x16_bf16 v[32:47], a[88:91], v[192:195], v[32:47]
  buffer_load_dwordx4 v1, s[12:15], s20 offen offset:2048 lds
  v_exp_f32 v182, v166
  v_exp_f32 v183, v167
  v_mfma_f32_32x32x16_bf16 v[144:159], a[32:35], v[240:243], v[144:159]
  v_exp_f32 v184, v168
  v_exp_f32 v185, v169
  v_cvt_pk_bf16_f32 v202, v180, v181
  v_cvt_pk_bf16_f32 v203, v182, v183
  v_mfma_f32_32x32x16_bf16 v[16:31], a[84:87], v[196:199], v[16:31]
  v_exp_f32 v186, v170
  v_exp_f32 v187, v171
  v_exp_f32 v188, v172
  v_mfma_f32_32x32x16_bf16 v[32:47], a[92:95], v[196:199], v[32:47]
  s_nop 0
  v_exp_f32 v189, v173
  v_exp_f32 v190, v174
  v_exp_f32 v191, v175
  v_cvt_pk_bf16_f32 v204, v184, v185
  v_cvt_pk_bf16_f32 v205, v186, v187
  v_mfma_f32_32x32x16_bf16 v[160:175], a[36:39], v[208:211], 0
  ds_read_b128 a[4:7], v2 offset:1024
  v_exp_f32 v176, v144
  v_exp_f32 v177, v145
  v_exp_f32 v178, v146
  v_mfma_f32_32x32x16_bf16 v[48:63], a[80:83], v[200:203], v[48:63]
  ds_read_b128 a[72:75], v3 offset:5120
  v_exp_f32 v179, v147
  v_exp_f32 v180, v148
  v_cvt_pk_bf16_f32 v192, v176, v177
  v_mfma_f32_32x32x16_bf16 v[160:175], a[40:43], v[212:215], v[160:175]
  buffer_load_dwordx4 v1, s[12:15], s20 offen offset:3072 lds
  v_exp_f32 v181, v149
  v_cvt_pk_bf16_f32 v206, v188, v189
  v_cvt_pk_bf16_f32 v207, v190, v191
  v_mfma_f32_32x32x16_bf16 v[64:79], a[88:91], v[200:203], v[64:79]
  v_exp_f32 v182, v150
  v_exp_f32 v183, v151
  v_cvt_pk_bf16_f32 v193, v178, v179
  v_cvt_pk_bf16_f32 v194, v180, v181
  v_mfma_f32_32x32x16_bf16 v[160:175], a[44:47], v[216:219], v[160:175]
  v_exp_f32 v184, v152
  v_exp_f32 v185, v153
  v_exp_f32 v186, v154
  v_mfma_f32_32x32x16_bf16 v[48:63], a[84:87], v[204:207], v[48:63]
  v_exp_f32 v187, v155
  v_exp_f32 v188, v156
  v_cvt_pk_bf16_f32 v195, v182, v183
  v_cvt_pk_bf16_f32 v196, v184, v185
  v_mfma_f32_32x32x16_bf16 v[64:79], a[92:95], v[204:207], v[64:79]
  v_exp_f32 v189, v157
  v_exp_f32 v190, v158
  v_exp_f32 v191, v159
  v_cvt_pk_bf16_f32 v197, v186, v187
  v_add_u32 v5, s23, v5
  v_mfma_f32_32x32x16_bf16 v[144:159], a[36:39], v[220:223], 0
  ds_read_b128 a[0:3], v2 offset:0
  v_exp_f32 v176, v160
  v_exp_f32 v177, v161
  v_exp_f32 v178, v162
  v_mfma_f32_32x32x16_bf16 v[80:95], a[80:83], v[192:195], v[80:95]
  ds_read_b128 a[20:23], v3 offset:2048
  v_exp_f32 v179, v163
  v_exp_f32 v180, v164
  v_cvt_pk_bf16_f32 v200, v176, v177
  v_mfma_f32_32x32x16_bf16 v[144:159], a[40:43], v[224:227], v[144:159]
  ds_read_b128 a[32:35], v4 offset:2048
  v_exp_f32 v181, v165
  v_cvt_pk_bf16_f32 v198, v188, v189
  v_cvt_pk_bf16_f32 v199, v190, v191
  v_cvt_pk_bf16_f32 v201, v178, v179
  v_mfma_f32_32x32x16_bf16 v[96:111], a[88:91], v[192:195], v[96:111]
  s_add_u32 m0, s22, 32768
  v_exp_f32 v182, v166
  v_exp_f32 v183, v167
  v_exp_f32 v184, v168
  v_mfma_f32_32x32x16_bf16 v[144:159], a[44:47], v[228:231], v[144:159]
  buffer_load_dwordx4 v1, s[12:15], s28 offen offset:0 lds
  v_exp_f32 v185, v169
  v_cvt_pk_bf16_f32 v202, v180, v181
  v_cvt_pk_bf16_f32 v203, v182, v183
  v_mfma_f32_32x32x16_bf16 v[80:95], a[84:87], v[196:199], v[80:95]
  v_exp_f32 v186, v170
  v_exp_f32 v187, v171
  v_exp_f32 v188, v172
  v_mfma_f32_32x32x16_bf16 v[96:111], a[92:95], v[196:199], v[96:111]
  v_exp_f32 v189, v173
  v_exp_f32 v190, v174
  v_exp_f32 v191, v175
  v_cvt_pk_bf16_f32 v204, v184, v185
  v_cvt_pk_bf16_f32 v205, v186, v187
  v_mfma_f32_32x32x16_bf16 v[160:175], a[36:39], v[232:235], 0
  s_nop 0
  v_exp_f32 v176, v144
  v_exp_f32 v177, v145
  v_exp_f32 v178, v146
  v_mfma_f32_32x32x16_bf16 v[16:31], a[96:99], v[200:203], v[16:31]
  ds_read_b128 a[52:55], v2 offset:4096
  v_exp_f32 v179, v147
  v_exp_f32 v180, v148
  v_cvt_pk_bf16_f32 v192, v176, v177
  v_mfma_f32_32x32x16_bf16 v[160:175], a[40:43], v[236:239], v[160:175]
  ds_read_b128 a[60:63], v2 offset:6144
  v_exp_f32 v181, v149
  v_cvt_pk_bf16_f32 v206, v188, v189
  v_cvt_pk_bf16_f32 v207, v190, v191
  v_cvt_pk_bf16_f32 v193, v178, v179
  v_mfma_f32_32x32x16_bf16 v[32:47], a[104:107], v[200:203], v[32:47]
  ds_read_b128 a[28:31], v4 offset:1024
  v_exp_f32 v182, v150
  v_exp_f32 v183, v151
  v_cvt_pk_bf16_f32 v194, v180, v181
  v_mfma_f32_32x32x16_bf16 v[160:175], a[44:47], v[240:243], v[160:175]
  buffer_load_dwordx4 v1, s[12:15], s28 offen offset:1024 lds
  v_exp_f32 v184, v152
  v_exp_f32 v185, v153
  v_mfma_f32_32x32x16_bf16 v[16:31], a[100:103], v[204:207], v[16:31]
  v_exp_f32 v186, v154
  v_exp_f32 v187, v155
  v_cvt_pk_bf16_f32 v195, v182, v183
  v_cvt_pk_bf16_f32 v196, v184, v185
  v_mfma_f32_32x32x16_bf16 v[32:47], a[108:111], v[204:207], v[32:47]
  s_waitcnt lgkmcnt(5)
  v_exp_f32 v188, v156
  v_exp_f32 v189, v157
  v_exp_f32 v190, v158
  v_exp_f32 v191, v159
  v_cvt_pk_bf16_f32 v197, v186, v187
  v_mfma_f32_32x32x16_bf16 v[144:159], a[0:3], v[208:211], 0
  ds_read_b128 a[48:51], v2 offset:3072
  v_exp_f32 v176, v160
  v_exp_f32 v177, v161
  v_exp_f32 v178, v162
  v_mfma_f32_32x32x16_bf16 v[48:63], a[96:99], v[192:195], v[48:63]
  ds_read_b128 a[56:59], v2 offset:5120
  v_exp_f32 v179, v163
  v_exp_f32 v180, v164
  v_cvt_pk_bf16_f32 v200, v176, v177
  v_mfma_f32_32x32x16_bf16 v[144:159], a[4:7], v[212:215], v[144:159]
  ds_read_b128 a[24:27], v4 offset:0
  v_exp_f32 v181, v165
  v_cvt_pk_bf16_f32 v198, v188, v189
  v_cvt_pk_bf16_f32 v199, v190, v191
  v_cvt_pk_bf16_f32 v201, v178, v179
  v_mfma_f32_32x32x16_bf16 v[64:79], a[104:107], v[192:195], v[64:79]
  buffer_load_dwordx4 v1, s[12:15], s28 offen offset:2048 lds
  v_exp_f32 v182, v166
  v_exp_f32 v183, v167
  v_mfma_f32_32x32x16_bf16 v[144:159], a[8:11], v[216:219], v[144:159]
  v_exp_f32 v184, v168
  v_exp_f32 v185, v169
  v_cvt_pk_bf16_f32 v202, v180, v181
  v_cvt_pk_bf16_f32 v203, v182, v183
  v_mfma_f32_32x32x16_bf16 v[48:63], a[100:103], v[196:199], v[48:63]
  v_exp_f32 v186, v170
  v_exp_f32 v187, v171
  v_exp_f32 v188, v172
  v_mfma_f32_32x32x16_bf16 v[64:79], a[108:111], v[196:199], v[64:79]
  v_exp_f32 v189, v173
  v_exp_f32 v190, v174
  v_exp_f32 v191, v175
  v_cvt_pk_bf16_f32 v204, v184, v185
  v_cvt_pk_bf16_f32 v205, v186, v187
  s_sub_u32 s22, s22, s23
  s_sub_u32 s23, 0, s23
  s_add_u32 s24, s24, 2
  s_cmp_lt_u32 s24, 12
  s_cbranch_scc1 L_loop_V
  v_mfma_f32_32x32x16_bf16 v[160:175], a[0:3], v[220:223], 0
  ds_read_b128 a[12:15], v3 offset:0
  v_exp_f32 v176, v144
  v_exp_f32 v177, v145
  v_exp_f32 v178, v146
  v_mfma_f32_32x32x16_bf16 v[80:95], a[96:99], v[200:203], v[80:95]
  ds_read_b128 a[16:19], v3 offset:1024
  v_exp_f32 v179, v147
  v_exp_f32 v180, v148
  v_cvt_pk_bf16_f32 v192, v176, v177
  v_mfma_f32_32x32x16_bf16 v[160:175], a[4:7], v[224:227], v[160:175]
  ds_read_b128 a[36:39], v5 offset:0
  v_exp_f32 v181, v149
  v_cvt_pk_bf16_f32 v206, v188, v189
  v_cvt_pk_bf16_f32 v207, v190, v191
  v_cvt_pk_bf16_f32 v193, v178, v179
  v_mfma_f32_32x32x16_bf16 v[96:111], a[104:107], v[200:203], v[96:111]
  v_exp_f32 v182, v150
  v_exp_f32 v183, v151
  v_exp_f32 v184, v152
  v_mfma_f32_32x32x16_bf16 v[160:175], a[8:11], v[228:231], v[160:175]
  v_exp_f32 v185, v153
  v_exp_f32 v186, v154
  v_cvt_pk_bf16_f32 v194, v180, v181
  v_cvt_pk_bf16_f32 v195, v182, v183
  v_mfma_f32_32x32x16_bf16 v[80:95], a[100:103], v[204:207], v[80:95]
  v_exp_f32 v187, v155
  v_exp_f32 v188, v156
  v_exp_f32 v189, v157
  v_mfma_f32_32x32x16_bf16 v[96:111], a[108:111], v[204:207], v[96:111]
  v_exp_f32 v190, v158
  v_exp_f32 v191, v159
  v_cvt_pk_bf16_f32 v196, v184, v185
  v_cvt_pk_bf16_f32 v197, v186, v187
  v_mfma_f32_32x32x16_bf16 v[144:159], a[0:3], v[232:235], 0
  s_waitcnt lgkmcnt(0)
  v_exp_f32 v176, v160
  v_exp_f32 v177, v161
  v_exp_f32 v178, v162
  v_mfma_f32_32x32x16_bf16 v[16:31], a[48:51], v[192:195], v[16:31]
  ds_read_b128 a[68:71], v3 offset:4096
  v_exp_f32 v179, v163
  v_exp_f32 v180, v164
  v_cvt_pk_bf16_f32 v200, v176, v177
  v_mfma_f32_32x32x16_bf16 v[144:159], a[4:7], v[236:239], v[144:159]
  ds_read_b128 a[84:87], v4 offset:4096
  v_exp_f32 v181, v165
  v_cvt_pk_bf16_f32 v198, v188, v189
  v_cvt_pk_bf16_f32 v199, v190, v191
  v_cvt_pk_bf16_f32 v201, v178, v179
  v_mfma_f32_32x32x16_bf16 v[32:47], a[56:59], v[192:195], v[32:47]
  ds_read_b128 a[108:111], v5 offset:6144
  v_exp_f32 v182, v166
  v_exp_f32 v183, v167
  v_cvt_pk_bf16_f32 v202, v180, v181
  v_mfma_f32_32x32x16_bf16 v[144:159], a[8:11], v[240:243], v[144:159]
  v_exp_f32 v184, v168
  v_exp_f32 v185, v169
  v_exp_f32 v186, v170
  v_mfma_f32_32x32x16_bf16 v[16:31], a[52:55], v[196:199], v[16:31]
  v_exp_f32 v187, v171
  v_exp_f32 v188, v172
  v_cvt_pk_bf16_f32 v203, v182, v183
  v_cvt_pk_bf16_f32 v204, v184, v185
  v_mfma_f32_32x32x16_bf16 v[32:47], a[60:63], v[196:199], v[32:47]
  s_waitcnt lgkmcnt(4)
  v_exp_f32 v189, v173
  v_exp_f32 v190, v174
  v_exp_f32 v191, v175
  v_cvt_pk_bf16_f32 v205, v186, v187
  v_mfma_f32_32x32x16_bf16 v[160:175], a[12:15], v[208:211], 0
  ds_read_b128 a[64:67], v3 offset:3072
  v_exp_f32 v176, v144
  v_exp_f32 v177, v145
  v_exp_f32 v178, v146
  v_mfma_f32_32x32x16_bf16 v[48:63], a[48:51], v[200:203], v[48:63]
  ds_read_b128 a[80:83], v4 offset:3072
  v_exp_f32 v179, v147
  v_exp_f32 v180, v148
  v_cvt_pk_bf16_f32 v192, v176, v177
  v_mfma_f32_32x32x16_bf16 v[160:175], a[16:19], v[212:215], v[160:175]
  ds_read_b128 a[104:107], v5 offset:5120
  v_exp_f32 v181, v149
  v_cvt_pk_bf16_f32 v206, v188, v189
  v_cvt_pk_bf16_f32 v207, v190, v191
  v_cvt_pk_bf16_f32 v193, v178, v179
  v_mfma_f32_32x32x16_bf16 v[64:79], a[56:59], v[200:203], v[64:79]
  v_exp_f32 v182, v150
  v_exp_f32 v183, v151
  v_exp_f32 v184, v152
  v_mfma_f32_32x32x16_bf16 v[160:175], a[20:23], v[216:219], v[160:175]
  v_exp_f32 v185, v153
  v_exp_f32 v186, v154
  v_cvt_pk_bf16_f32 v194, v180, v181
  v_cvt_pk_bf16_f32 v195, v182, v183
  v_mfma_f32_32x32x16_bf16 v[48:63], a[52:55], v[204:207], v[48:63]
  v_exp_f32 v187, v155
  v_exp_f32 v188, v156
  v_exp_f32 v189, v157
  v_mfma_f32_32x32x16_bf16 v[64:79], a[60:63], v[204:207], v[64:79]
  v_exp_f32 v190, v158
  v_exp_f32 v191, v159
  v_cvt_pk_bf16_f32 v196, v184, v185
  v_cvt_pk_bf16_f32 v197, v186, v187
  v_mfma_f32_32x32x16_bf16 v[144:159], a[12:15], v[220:223], 0
  ds_read_b128 a[92:95], v4 offset:6144
  v_exp_f32 v176, v160
  v_exp_f32 v177, v161
  v_exp_f32 v178, v162
  v_mfma_f32_32x32x16_bf16 v[80:95], a[48:51], v[192:195], v[80:95]
  ds_read_b128 a[44:47], v5 offset:2048
  v_exp_f32 v179, v163
  v_exp_f32 v180, v164
  v_cvt_pk_bf16_f32 v200, v176, v177
  v_mfma_f32_32x32x16_bf16 v[144:159], a[16:19], v[224:227], v[144:159]
  ds_read_b128 a[100:103], v5 offset:4096
  v_exp_f32 v181, v165
  v_cvt_pk_bf16_f32 v198, v188, v189
  v_cvt_pk_bf16_f32 v199, v190, v191
  v_cvt_pk_bf16_f32 v201, v178, v179
  v_mfma_f32_32x32x16_bf16 v[96:111], a[56:59], v[192:195], v[96:111]
  v_exp_f32 v182, v166
  v_exp_f32 v183, v167
  v_exp_f32 v184, v168
  v_mfma_f32_32x32x16_bf16 v[144:159], a[20:23], v[228:231], v[144:159]
  v_exp_f32 v185, v169
  v_exp_f32 v186, v170
  v_cvt_pk_bf16_f32 v202, v180, v181
  v_cvt_pk_bf16_f32 v203, v182, v183
  v_mfma_f32_32x32x16_bf16 v[80:95], a[52:55], v[196:199], v[80:95]
  v_exp_f32 v187, v171
  v_exp_f32 v188, v172
  v_exp_f32 v189, v173
  v_mfma_f32_32x32x16_bf16 v[96:111], a[60:63], v[196:199], v[96:111]
  v_exp_f32 v190, v174
  v_exp_f32 v191, v175
  v_cvt_pk_bf16_f32 v204, v184, v185
  v_cvt_pk_bf16_f32 v205, v186, v187
  v_mfma_f32_32x32x16_bf16 v[160:175], a[12:15], v[232:235], 0
  s_waitcnt lgkmcnt(5)
  v_exp_f32 v176, v144
  v_exp_f32 v177, v145
  v_exp_f32 v178, v146
  v_mfma_f32_32x32x16_bf16 v[16:31], a[64:67], v[200:203], v[16:31]
  ds_read_b128 a[88:91], v4 offset:5120
  v_exp_f32 v179, v147
  v_exp_f32 v180, v148
  v_cvt_pk_bf16_f32 v192, v176, v177
  v_mfma_f32_32x32x16_bf16 v[160:175], a[16:19], v[236:239], v[160:175]
  ds_read_b128 a[40:43], v5 offset:1024
  v_exp_f32 v181, v149
  v_cvt_pk_bf16_f32 v206, v188, v189
  v_cvt_pk_bf16_f32 v207, v190, v191
  v_cvt_pk_bf16_f32 v193, v178, v179
  v_mfma_f32_32x32x16_bf16 v[32:47], a[72:75], v[200:203], v[32:47]
  ds_read_b128 a[96:99], v5 offset:3072
  v_exp_f32 v182, v150
  v_exp_f32 v183, v151
  v_cvt_pk_bf16_f32 v194, v180, v181
  v_mfma_f32_32x32x16_bf16 v[160:175], a[20:23], v[240:243], v[160:175]
  v_exp_f32 v184, v152
  v_exp_f32 v185, v153
  v_exp_f32 v186, v154
  v_mfma_f32_32x32x16_bf16 v[16:31], a[68:71], v[204:207], v[16:31]
  v_exp_f32 v187, v155
  v_exp_f32 v188, v156
  v_cvt_pk_bf16_f32 v195, v182, v183
  v_cvt_pk_bf16_f32 v196, v184, v185
  v_mfma_f32_32x32x16_bf16 v[32:47], a[76:79], v[204:207], v[32:47]
  s_waitcnt lgkmcnt(0)
  v_exp_f32 v189, v157
  v_exp_f32 v190, v158
  v_exp_f32 v191, v159
  v_cvt_pk_bf16_f32 v197, v186, v187
  v_mfma_f32_32x32x16_bf16 v[144:159], a[24:27], v[208:211], 0
  v_exp_f32 v176, v160
  v_exp_f32 v177, v161
  v_mfma_f32_32x32x16_bf16 v[48:63], a[64:67], v[192:195], v[48:63]
  v_exp_f32 v178, v162
  v_exp_f32 v179, v163
  v_exp_f32 v180, v164
  v_mfma_f32_32x32x16_bf16 v[144:159], a[28:31], v[212:215], v[144:159]
  v_exp_f32 v181, v165
  v_cvt_pk_bf16_f32 v198, v188, v189
  v_cvt_pk_bf16_f32 v199, v190, v191
  v_cvt_pk_bf16_f32 v200, v176, v177
  v_cvt_pk_bf16_f32 v201, v178, v179
  v_mfma_f32_32x32x16_bf16 v[64:79], a[72:75], v[192:195], v[64:79]
  v_exp_f32 v182, v166
  v_exp_f32 v183, v167
  v_exp_f32 v184, v168
  v_mfma_f32_32x32x16_bf16 v[144:159], a[32:35], v[216:219], v[144:159]
  v_exp_f32 v185, v169
  v_exp_f32 v186, v170
  v_cvt_pk_bf16_f32 v202, v180, v181
  v_cvt_pk_bf16_f32 v203, v182, v183
  v_mfma_f32_32x32x16_bf16 v[48:63], a[68:71], v[196:199], v[48:63]
  v_exp_f32 v187, v171
  v_exp_f32 v188, v172
  v_exp_f32 v189, v173
  v_mfma_f32_32x32x16_bf16 v[64:79], a[76:79], v[196:199], v[64:79]
  v_exp_f32 v190, v174
  v_exp_f32 v191, v175
  v_cvt_pk_bf16_f32 v204, v184, v185
  v_cvt_pk_bf16_f32 v205, v186, v187
  v_mfma_f32_32x32x16_bf16 v[160:175], a[24:27], v[220:223], 0
  s_waitcnt vmcnt(0) lgkmcnt(0)
  v_exp_f32 v176, v144
  v_exp_f32 v177, v145
  v_mfma_f32_32x32x16_bf16 v[80:95], a[64:67], v[200:203], v[80:95]
  s_barrier
  v_exp_f32 v178, v146
  v_exp_f32 v179, v147
  v_exp_f32 v180, v148
  v_mfma_f32_32x32x16_bf16 v[160:175], a[28:31], v[224:227], v[160:175]
  v_exp_f32 v181, v149
  v_cvt_pk_bf16_f32 v206, v188, v189
  v_cvt_pk_bf16_f32 v207, v190, v191
  v_cvt_pk_bf16_f32 v192, v176, v177
  v_cvt_pk_bf16_f32 v193, v178, v179
  v_mfma_f32_32x32x16_bf16 v[96:111], a[72:75], v[200:203], v[96:111]
  v_exp_f32 v182, v150
  v_exp_f32 v183, v151
  v_exp_f32 v184, v152
  v_mfma_f32_32x32x16_bf16 v[160:175], a[32:35], v[228:231], v[160:175]
  v_exp_f32 v185, v153
  v_exp_f32 v186, v154
  v_cvt_pk_bf16_f32 v194, v180, v181
  v_cvt_pk_bf16_f32 v195, v182, v183
  v_mfma_f32_32x32x16_bf16 v[80:95], a[68:71], v[204:207], v[80:95]
  v_exp_f32 v187, v155
  v_exp_f32 v188, v156
  v_exp_f32 v189, v157
  v_mfma_f32_32x32x16_bf16 v[96:111], a[76:79], v[204:207], v[96:111]
  v_exp_f32 v190, v158
  v_exp_f32 v191, v159
  v_cvt_pk_bf16_f32 v196, v184, v185
  v_cvt_pk_bf16_f32 v197, v186, v187
  v_mfma_f32_32x32x16_bf16 v[144:159], a[24:27], v[232:235], 0
  s_nop 0
  v_exp_f32 v176, v160
  v_exp_f32 v177, v161
  v_exp_f32 v178, v162
  v_mfma_f32_32x32x16_bf16 v[16:31], a[80:83], v[192:195], v[16:31]
  ds_read_b128 a[8:11], v2 offset:30720
  v_exp_f32 v179, v163
  v_exp_f32 v180, v164
  v_cvt_pk_bf16_f32 v200, v176, v177
  v_mfma_f32_32x32x16_bf16 v[144:159], a[28:31], v[236:239], v[144:159]
  ds_read_b128 a[76:79], v3 offset:34816
  v_exp_f32 v181, v165
  v_cvt_pk_bf16_f32 v198, v188, v189
  v_cvt_pk_bf16_f32 v199, v190, v191
  v_cvt_pk_bf16_f32 v201, v178, v179
  v_mfma_f32_32x32x16_bf16 v[32:47], a[88:91], v[192:195], v[32:47]
  v_exp_f32 v182, v166
  v_exp_f32 v183, v167
  v_exp_f32 v184, v168
  v_mfma_f32_32x32x16_bf16 v[144:159], a[32:35], v[240:243], v[144:159]
  v_exp_f32 v185, v169
  v_exp_f32 v186, v170
  v_cvt_pk_bf16_f32 v202, v180, v181
  v_cvt_pk_bf16_f32 v203, v182, v183
  v_mfma_f32_32x32x16_bf16 v[16:31], a[84:87], v[196:199], v[16:31]
  v_exp_f32 v187, v171
  v_exp_f32 v188, v172
  v_exp_f32 v189, v173
  v_mfma_f32_32x32x16_bf16 v[32:47], a[92:95], v[196:199], v[32:47]
  s_nop 0
  v_exp_f32 v190, v174
  v_exp_f32 v191, v175
  v_cvt_pk_bf16_f32 v204, v184, v185
  v_cvt_pk_bf16_f32 v205, v186, v187
  v_mfma_f32_32x32x16_bf16 v[160:175], a[36:39], v[208:211], 0
  ds_read_b128 a[4:7], v2 offset:29696
  v_exp_f32 v176, v144
  v_exp_f32 v177, v145
  v_cvt_pk_bf16_f32 v206, v188, v189
  v_mfma_f32_32x32x16_bf16 v[48:63], a[80:83], v[200:203], v[48:63]
  ds_read_b128 a[72:75], v3 offset:33792
  v_exp_f32 v178, v146
  v_exp_f32 v179, v147
  v_cvt_pk_bf16_f32 v192, v176, v177
  v_mfma_f32_32x32x16_bf16 v[160:175], a[40:43], v[212:215], v[160:175]
  v_exp_f32 v180, v148
  v_exp_f32 v181, v149
  v_cvt_pk_bf16_f32 v207, v190, v191
  v_cvt_pk_bf16_f32 v193, v178, v179
  v_mfma_f32_32x32x16_bf16 v[64:79], a[88:91], v[200:203], v[64:79]
  v_exp_f32 v182, v150
  v_exp_f32 v183, v151
  v_exp_f32 v184, v152
  v_mfma_f32_32x32x16_bf16 v[160:175], a[44:47], v[216:219], v[160:175]
  v_exp_f32 v185, v153
  v_exp_f32 v186, v154
  v_cvt_pk_bf16_f32 v194, v180, v181
  v_cvt_pk_bf16_f32 v195, v182, v183
  v_mfma_f32_32x32x16_bf16 v[48:63], a[84:87], v[204:207], v[48:63]
  v_exp_f32 v187, v155
  v_exp_f32 v188, v156
  v_exp_f32 v189, v157
  v_mfma_f32_32x32x16_bf16 v[64:79], a[92:95], v[204:207], v[64:79]
  v_exp_f32 v190, v158
  v_exp_f32 v191, v159
  v_cvt_pk_bf16_f32 v196, v184, v185
  v_cvt_pk_bf16_f32 v197, v186, v187
  v_mfma_f32_32x32x16_bf16 v[144:159], a[36:39], v[220:223], 0
  ds_read_b128 a[0:3], v2 offset:28672
  v_exp_f32 v176, v160
  v_exp_f32 v177, v161
  v_exp_f32 v178, v162
  v_mfma_f32_32x32x16_bf16 v[80:95], a[80:83], v[192:195], v[80:95]
  ds_read_b128 a[20:23], v3 offset:30720
  v_exp_f32 v179, v163
  v_exp_f32 v180, v164
  v_cvt_pk_bf16_f32 v200, v176, v177
  v_mfma_f32_32x32x16_bf16 v[144:159], a[40:43], v[224:227], v[144:159]
  ds_read_b128 a[32:35], v4 offset:30720
  v_exp_f32 v181, v165
  v_cvt_pk_bf16_f32 v198, v188, v189
  v_cvt_pk_bf16_f32 v199, v190, v191
  v_cvt_pk_bf16_f32 v201, v178, v179
  v_mfma_f32_32x32x16_bf16 v[96:111], a[88:91], v[192:195], v[96:111]
  v_exp_f32 v182, v166
  v_exp_f32 v183, v167
  v_exp_f32 v184, v168
  v_mfma_f32_32x32x16_bf16 v[144:159], a[44:47], v[228:231], v[144:159]
  v_exp_f32 v185, v169
  v_exp_f32 v186, v170
  v_cvt_pk_bf16_f32 v202, v180, v181
  v_cvt_pk_bf16_f32 v203, v182, v183
  v_mfma_f32_32x32x16_bf16 v[80:95], a[84:87], v[196:199], v[80:95]
  v_exp_f32 v187, v171
  v_exp_f32 v188, v172
  v_exp_f32 v189, v173
  v_mfma_f32_32x32x16_bf16 v[96:111], a[92:95], v[196:199], v[96:111]
  v_exp_f32 v190, v174
  v_exp_f32 v191, v175
  v_cvt_pk_bf16_f32 v204, v184, v185
  v_cvt_pk_bf16_f32 v205, v186, v187
  v_mfma_f32_32x32x16_bf16 v[160:175], a[36:39], v[232:235], 0
  s_nop 0
  v_exp_f32 v176, v144
  v_exp_f32 v177, v145
  v_exp_f32 v178, v146
  v_mfma_f32_32x32x16_bf16 v[16:31], a[96:99], v[200:203], v[16:31]
  ds_read_b128 a[52:55], v2 offset:32768
  v_exp_f32 v179, v147
  v_exp_f32 v180, v148
  v_cvt_pk_bf16_f32 v192, v176, v177
  v_mfma_f32_32x32x16_bf16 v[160:175], a[40:43], v[236:239], v[160:175]
  ds_read_b128 a[60:63], v2 offset:34816
  v_exp_f32 v181, v149
  v_cvt_pk_bf16_f32 v206, v188, v189
  v_cvt_pk_bf16_f32 v207, v190, v191
  v_cvt_pk_bf16_f32 v193, v178, v179
  v_mfma_f32_32x32x16_bf16 v[32:47], a[104:107], v[200:203], v[32:47]
  ds_read_b128 a[28:31], v4 offset:29696
  v_exp_f32 v182, v150
  v_exp_f32 v183, v151
  v_cvt_pk_bf16_f32 v194, v180, v181
  v_mfma_f32_32x32x16_bf16 v[160:175], a[44:47], v[240:243], v[160:175]
  v_exp_f32 v184, v152
  v_exp_f32 v185, v153
  v_exp_f32 v186, v154
  v_mfma_f32_32x32x16_bf16 v[16:31], a[100:103], v[204:207], v[16:31]
  v_exp_f32 v187, v155
  v_exp_f32 v188, v156
  v_cvt_pk_bf16_f32 v195, v182, v183
  v_cvt_pk_bf16_f32 v196, v184, v185
  v_mfma_f32_32x32x16_bf16 v[32:47], a[108:111], v[204:207], v[32:47]
  s_waitcnt lgkmcnt(5)
  v_exp_f32 v189, v157
  v_exp_f32 v190, v158
  v_exp_f32 v191, v159
  v_cvt_pk_bf16_f32 v197, v186, v187
  v_mfma_f32_32x32x16_bf16 v[144:159], a[0:3], v[208:211], 0
  ds_read_b128 a[48:51], v2 offset:31744
  v_exp_f32 v176, v160
  v_exp_f32 v177, v161
  v_exp_f32 v178, v162
  v_mfma_f32_32x32x16_bf16 v[48:63], a[96:99], v[192:195], v[48:63]
  ds_read_b128 a[56:59], v2 offset:33792
  v_exp_f32 v179, v163
  v_exp_f32 v180, v164
  v_cvt_pk_bf16_f32 v200, v176, v177
  v_mfma_f32_32x32x16_bf16 v[144:159], a[4:7], v[212:215], v[144:159]
  ds_read_b128 a[24:27], v4 offset:28672
  v_exp_f32 v181, v165
  v_cvt_pk_bf16_f32 v198, v188, v189
  v_cvt_pk_bf16_f32 v199, v190, v191
  v_cvt_pk_bf16_f32 v201, v178, v179
  v_mfma_f32_32x32x16_bf16 v[64:79], a[104:107], v[192:195], v[64:79]
  v_exp_f32 v182, v166
  v_exp_f32 v183, v167
  v_exp_f32 v184, v168
  v_mfma_f32_32x32x16_bf16 v[144:159], a[8:11], v[216:219], v[144:159]
  v_exp_f32 v185, v169
  v_exp_f32 v186, v170
  v_cvt_pk_bf16_f32 v202, v180, v181
  v_cvt_pk_bf16_f32 v203, v182, v183
  v_mfma_f32_32x32x16_bf16 v[48:63], a[100:103], v[196:199], v[48:63]
  v_exp_f32 v187, v171
  v_exp_f32 v188, v172
  v_exp_f32 v189, v173
  v_mfma_f32_32x32x16_bf16 v[64:79], a[108:111], v[196:199], v[64:79]
  v_exp_f32 v190, v174
  v_exp_f32 v191, v175
  v_cvt_pk_bf16_f32 v204, v184, v185
  v_cvt_pk_bf16_f32 v205, v186, v187
  v_mfma_f32_32x32x16_bf16 v[160:175], a[0:3], v[220:223], 0
  ds_read_b128 a[12:15], v3 offset:28672
  v_exp_f32 v176, v144
  v_exp_f32 v177, v145
  v_exp_f32 v178, v146
  v_mfma_f32_32x32x16_bf16 v[80:95], a[96:99], v[200:203], v[80:95]
  ds_read_b128 a[16:19], v3 offset:29696
  v_exp_f32 v179, v147
  v_exp_f32 v180, v148
  v_cvt_pk_bf16_f32 v192, v176, v177
  v_mfma_f32_32x32x16_bf16 v[160:175], a[4:7], v[224:227], v[160:175]
  ds_read_b128 a[36:39], v5 offset:28672
  v_exp_f32 v181, v149
  v_cvt_pk_bf16_f32 v206, v188, v189
  v_cvt_pk_bf16_f32 v207, v190, v191
  v_cvt_pk_bf16_f32 v193, v178, v179
  v_mfma_f32_32x32x16_bf16 v[96:111], a[104:107], v[200:203], v[96:111]
  v_exp_f32 v182, v150
  v_exp_f32 v183, v151
  v_exp_f32 v184, v152
  v_mfma_f32_32x32x16_bf16 v[160:175], a[8:11], v[228:231], v[160:175]
  v_exp_f32 v185, v153
  v_exp_f32 v186, v154
  v_cvt_pk_bf16_f32 v194, v180, v181
  v_cvt_pk_bf16_f32 v195, v182, v183
  v_mfma_f32_32x32x16_bf16 v[80:95], a[100:103], v[204:207], v[80:95]
  v_exp_f32 v187, v155
  v_exp_f32 v188, v156
  v_exp_f32 v189, v157
  v_mfma_f32_32x32x16_bf16 v[96:111], a[108:111], v[204:207], v[96:111]
  v_exp_f32 v190, v158
  v_exp_f32 v191, v159
  v_cvt_pk_bf16_f32 v196, v184, v185
  v_cvt_pk_bf16_f32 v197, v186, v187
  v_mfma_f32_32x32x16_bf16 v[144:159], a[0:3], v[232:235], 0
  s_waitcnt lgkmcnt(4)
  v_exp_f32 v176, v160
  v_exp_f32 v177, v161
  v_exp_f32 v178, v162
  v_mfma_f32_32x32x16_bf16 v[16:31], a[48:51], v[192:195], v[16:31]
  ds_read_b128 a[68:71], v3 offset:32768
  v_exp_f32 v179, v163
  v_exp_f32 v180, v164
  v_cvt_pk_bf16_f32 v200, v176, v177
  v_mfma_f32_32x32x16_bf16 v[144:159], a[4:7], v[236:239], v[144:159]
  ds_read_b128 a[84:87], v4 offset:32768
  v_exp_f32 v181, v165
  v_cvt_pk_bf16_f32 v198, v188, v189
  v_cvt_pk_bf16_f32 v199, v190, v191
  v_cvt_pk_bf16_f32 v201, v178, v179
  v_mfma_f32_32x32x16_bf16 v[32:47], a[56:59], v[192:195], v[32:47]
  ds_read_b128 a[108:111], v5 offset:34816
  v_exp_f32 v182, v166
  v_exp_f32 v183, v167
  v_cvt_pk_bf16_f32 v202, v180, v181
  v_mfma_f32_32x32x16_bf16 v[144:159], a[8:11], v[240:243], v[144:159]
  v_exp_f32 v184, v168
  v_exp_f32 v185, v169
  v_exp_f32 v186, v170
  v_mfma_f32_32x32x16_bf16 v[16:31], a[52:55], v[196:199], v[16:31]
  v_exp_f32 v187, v171
  v_exp_f32 v188, v172
  v_cvt_pk_bf16_f32 v203, v182, v183
  v_cvt_pk_bf16_f32 v204, v184, v185
  v_mfma_f32_32x32x16_bf16 v[32:47], a[60:63], v[196:199], v[32:47]
  s_waitcnt lgkmcnt(4)
  v_exp_f32 v189, v173
  v_exp_f32 v190, v174
  v_exp_f32 v191, v175
  v_cvt_pk_bf16_f32 v205, v186, v187
  v_mfma_f32_32x32x16_bf16 v[160:175], a[12:15], v[208:211], 0
  ds_read_b128 a[64:67], v3 offset:31744
  v_exp_f32 v176, v144
  v_exp_f32 v177, v145
  v_exp_f32 v178, v146
  v_mfma_f32_32x32x16_bf16 v[48:63], a[48:51], v[200:203], v[48:63]
  ds_read_b128 a[80:83], v4 offset:31744
  v_exp_f32 v179, v147
  v_exp_f32 v180, v148
  v_cvt_pk_bf16_f32 v192, v176, v177
  v_mfma_f32_32x32x16_bf16 v[160:175], a[16:19], v[212:215], v[160:175]
  ds_read_b128 a[104:107], v5 offset:33792
  v_exp_f32 v181, v149
  v_cvt_pk_bf16_f32 v206, v188, v189
  v_cvt_pk_bf16_f32 v207, v190, v191
  v_cvt_pk_bf16_f32 v193, v178, v179
  v_mfma_f32_32x32x16_bf16 v[64:79], a[56:59], v[200:203], v[64:79]
  v_exp_f32 v182, v150
  v_exp_f32 v183, v151
  v_exp_f32 v184, v152
  v_mfma_f32_32x32x16_bf16 v[160:175], a[20:23], v[216:219], v[160:175]
  v_exp_f32 v185, v153
  v_exp_f32 v186, v154
  v_cvt_pk_bf16_f32 v194, v180, v181
  v_cvt_pk_bf16_f32 v195, v182, v183
  v_mfma_f32_32x32x16_bf16 v[48:63], a[52:55], v[204:207], v[48:63]
  v_exp_f32 v187, v155
  v_exp_f32 v188, v156
  v_exp_f32 v189, v157
  v_mfma_f32_32x32x16_bf16 v[64:79], a[60:63], v[204:207], v[64:79]
  v_exp_f32 v190, v158
  v_exp_f32 v191, v159
  v_cvt_pk_bf16_f32 v196, v184, v185
  v_cvt_pk_bf16_f32 v197, v186, v187
  v_mfma_f32_32x32x16_bf16 v[144:159], a[12:15], v[220:223], 0
  ds_read_b128 a[92:95], v4 offset:34816
  v_exp_f32 v176, v160
  v_exp_f32 v177, v161
  v_exp_f32 v178, v162
  v_mfma_f32_32x32x16_bf16 v[80:95], a[48:51], v[192:195], v[80:95]
  ds_read_b128 a[44:47], v5 offset:30720
  v_exp_f32 v179, v163
  v_exp_f32 v180, v164
  v_cvt_pk_bf16_f32 v200, v176, v177
  v_mfma_f32_32x32x16_bf16 v[144:159], a[16:19], v[224:227], v[144:159]
  ds_read_b128 a[100:103], v5 offset:32768
  v_exp_f32 v181, v165
  v_cvt_pk_bf16_f32 v198, v188, v189
  v_cvt_pk_bf16_f32 v199, v190, v191
  v_cvt_pk_bf16_f32 v201, v178, v179
  v_mfma_f32_32x32x16_bf16 v[96:111], a[56:59], v[192:195], v[96:111]
  v_exp_f32 v182, v166
  v_exp_f32 v183, v167
  v_exp_f32 v184, v168
  v_mfma_f32_32x32x16_bf16 v[144:159], a[20:23], v[228:231], v[144:159]
  v_exp_f32 v185, v169
  v_exp_f32 v186, v170
  v_cvt_pk_bf16_f32 v202, v180, v181
  v_cvt_pk_bf16_f32 v203, v182, v183
  v_mfma_f32_32x32x16_bf16 v[80:95], a[52:55], v[196:199], v[80:95]
  v_exp_f32 v187, v171
  v_exp_f32 v188, v172
  v_exp_f32 v189, v173
  v_mfma_f32_32x32x16_bf16 v[96:111], a[60:63], v[196:199], v[96:111]
  v_exp_f32 v190, v174
  v_exp_f32 v191, v175
  v_cvt_pk_bf16_f32 v204, v184, v185
  v_cvt_pk_bf16_f32 v205, v186, v187
  v_mfma_f32_32x32x16_bf16 v[160:175], a[12:15], v[232:235], 0
  s_waitcnt lgkmcnt(5)
  v_exp_f32 v176, v144
  v_exp_f32 v177, v145
  v_exp_f32 v178, v146
  v_mfma_f32_32x32x16_bf16 v[16:31], a[64:67], v[200:203], v[16:31]
  ds_read_b128 a[88:91], v4 offset:33792
  v_exp_f32 v179, v147
  v_exp_f32 v180, v148
  v_cvt_pk_bf16_f32 v192, v176, v177
  v_mfma_f32_32x32x16_bf16 v[160:175], a[16:19], v[236:239], v[160:175]
  ds_read_b128 a[40:43], v5 offset:29696
  v_exp_f32 v181, v149
  v_cvt_pk_bf16_f32 v206, v188, v189
  v_cvt_pk_bf16_f32 v207, v190, v191
  v_cvt_pk_bf16_f32 v193, v178, v179
  v_mfma_f32_32x32x16_bf16 v[32:47], a[72:75], v[200:203], v[32:47]
  ds_read_b128 a[96:99], v5 offset:31744
  v_exp_f32 v182, v150
  v_exp_f32 v183, v151
  v_cvt_pk_bf16_f32 v194, v180, v181
  v_mfma_f32_32x32x16_bf16 v[160:175], a[20:23], v[240:243], v[160:175]
  v_exp_f32 v184, v152
  v_exp_f32 v185, v153
  v_exp_f32 v186, v154
  v_mfma_f32_32x32x16_bf16 v[16:31], a[68:71], v[204:207], v[16:31]
  v_exp_f32 v187, v155
  v_exp_f32 v188, v156
  v_cvt_pk_bf16_f32 v195, v182, v183
  v_cvt_pk_bf16_f32 v196, v184, v185
  v_mfma_f32_32x32x16_bf16 v[32:47], a[76:79], v[204:207], v[32:47]
  s_waitcnt lgkmcnt(15)
  v_exp_f32 v189, v157
  v_exp_f32 v190, v158
  v_exp_f32 v191, v159
  v_cvt_pk_bf16_f32 v197, v186, v187
  v_mfma_f32_32x32x16_bf16 v[144:159], a[24:27], v[208:211], 0
  v_exp_f32 v176, v160
  v_exp_f32 v177, v161
  v_mfma_f32_32x32x16_bf16 v[48:63], a[64:67], v[192:195], v[48:63]
  v_exp_f32 v178, v162
  v_exp_f32 v179, v163
  v_exp_f32 v180, v164
  v_mfma_f32_32x32x16_bf16 v[144:159], a[28:31], v[212:215], v[144:159]
  v_exp_f32 v181, v165
  v_cvt_pk_bf16_f32 v198, v188, v189
  v_cvt_pk_bf16_f32 v199, v190, v191
  v_cvt_pk_bf16_f32 v200, v176, v177
  v_cvt_pk_bf16_f32 v201, v178, v179
  v_mfma_f32_32x32x16_bf16 v[64:79], a[72:75], v[192:195], v[64:79]
  v_exp_f32 v182, v166
  v_exp_f32 v183, v167
  v_exp_f32 v184, v168
  v_mfma_f32_32x32x16_bf16 v[144:159], a[32:35], v[216:219], v[144:159]
  v_exp_f32 v185, v169
  v_exp_f32 v186, v170
  v_cvt_pk_bf16_f32 v202, v180, v181
  v_cvt_pk_bf16_f32 v203, v182, v183
  v_mfma_f32_32x32x16_bf16 v[48:63], a[68:71], v[196:199], v[48:63]
  v_exp_f32 v187, v171
  v_exp_f32 v188, v172
  v_exp_f32 v189, v173
  v_mfma_f32_32x32x16_bf16 v[64:79], a[76:79], v[196:199], v[64:79]
  v_exp_f32 v190, v174
  v_exp_f32 v191, v175
  v_cvt_pk_bf16_f32 v204, v184, v185
  v_cvt_pk_bf16_f32 v205, v186, v187
  v_mfma_f32_32x32x16_bf16 v[160:175], a[24:27], v[220:223], 0
  v_exp_f32 v176, v144
  v_exp_f32 v177, v145
  v_mfma_f32_32x32x16_bf16 v[80:95], a[64:67], v[200:203], v[80:95]
  v_exp_f32 v178, v146
  v_exp_f32 v179, v147
  v_exp_f32 v180, v148
  v_mfma_f32_32x32x16_bf16 v[160:175], a[28:31], v[224:227], v[160:175]
  v_exp_f32 v181, v149
  v_cvt_pk_bf16_f32 v206, v188, v189
  v_cvt_pk_bf16_f32 v207, v190, v191
  v_cvt_pk_bf16_f32 v192, v176, v177
  v_cvt_pk_bf16_f32 v193, v178, v179
  v_mfma_f32_32x32x16_bf16 v[96:111], a[72:75], v[200:203], v[96:111]
  v_exp_f32 v182, v150
  v_exp_f32 v183, v151
  v_exp_f32 v184, v152
  v_mfma_f32_32x32x16_bf16 v[160:175], a[32:35], v[228:231], v[160:175]
  v_exp_f32 v185, v153
  v_exp_f32 v186, v154
  v_cvt_pk_bf16_f32 v194, v180, v181
  v_cvt_pk_bf16_f32 v195, v182, v183
  v_mfma_f32_32x32x16_bf16 v[80:95], a[68:71], v[204:207], v[80:95]
  v_exp_f32 v187, v155
  v_exp_f32 v188, v156
  v_exp_f32 v189, v157
  v_mfma_f32_32x32x16_bf16 v[96:111], a[76:79], v[204:207], v[96:111]
  v_exp_f32 v190, v158
  v_exp_f32 v191, v159
  v_cvt_pk_bf16_f32 v196, v184, v185
  v_cvt_pk_bf16_f32 v197, v186, v187
  v_mfma_f32_32x32x16_bf16 v[144:159], a[24:27], v[232:235], 0
  s_waitcnt lgkmcnt(2)
  v_exp_f32 v176, v160
  v_exp_f32 v177, v161
  v_mfma_f32_32x32x16_bf16 v[16:31], a[80:83], v[192:195], v[16:31]
  v_exp_f32 v178, v162
  v_exp_f32 v179, v163
  v_exp_f32 v180, v164
  v_mfma_f32_32x32x16_bf16 v[144:159], a[28:31], v[236:239], v[144:159]
  v_exp_f32 v181, v165
  v_cvt_pk_bf16_f32 v198, v188, v189
  v_cvt_pk_bf16_f32 v199, v190, v191
  v_cvt_pk_bf16_f32 v200, v176, v177
  v_cvt_pk_bf16_f32 v201, v178, v179
  v_mfma_f32_32x32x16_bf16 v[32:47], a[88:91], v[192:195], v[32:47]
  v_exp_f32 v182, v166
  v_exp_f32 v183, v167
  v_exp_f32 v184, v168
  v_mfma_f32_32x32x16_bf16 v[144:159], a[32:35], v[240:243], v[144:159]
  v_exp_f32 v185, v169
  v_exp_f32 v186, v170
  v_cvt_pk_bf16_f32 v202, v180, v181
  v_cvt_pk_bf16_f32 v203, v182, v183
  v_mfma_f32_32x32x16_bf16 v[16:31], a[84:87], v[196:199], v[16:31]
  v_exp_f32 v187, v171
  v_exp_f32 v188, v172
  v_exp_f32 v189, v173
  v_mfma_f32_32x32x16_bf16 v[32:47], a[92:95], v[196:199], v[32:47]
  s_waitcnt lgkmcnt(1)
  v_exp_f32 v190, v174
  v_exp_f32 v191, v175
  v_cvt_pk_bf16_f32 v204, v184, v185
  v_cvt_pk_bf16_f32 v205, v186, v187
  v_mfma_f32_32x32x16_bf16 v[160:175], a[36:39], v[208:211], 0
  v_exp_f32 v176, v144
  v_exp_f32 v177, v145
  v_mfma_f32_32x32x16_bf16 v[48:63], a[80:83], v[200:203], v[48:63]
  v_exp_f32 v178, v146
  v_exp_f32 v179, v147
  v_exp_f32 v180, v148
  v_mfma_f32_32x32x16_bf16 v[160:175], a[40:43], v[212:215], v[160:175]
  v_exp_f32 v181, v149
  v_cvt_pk_bf16_f32 v206, v188, v189
  v_cvt_pk_bf16_f32 v207, v190, v191
  v_cvt_pk_bf16_f32 v192, v176, v177
  v_cvt_pk_bf16_f32 v193, v178, v179
  v_mfma_f32_32x32x16_bf16 v[64:79], a[88:91], v[200:203], v[64:79]
  v_exp_f32 v182, v150
  v_exp_f32 v183, v151
  v_exp_f32 v184, v152
  v_mfma_f32_32x32x16_bf16 v[160:175], a[44:47], v[216:219], v[160:175]
  v_exp_f32 v185, v153
  v_exp_f32 v186, v154
  v_cvt_pk_bf16_f32 v194, v180, v181
  v_cvt_pk_bf16_f32 v195, v182, v183
  v_mfma_f32_32x32x16_bf16 v[48:63], a[84:87], v[204:207], v[48:63]
  v_exp_f32 v187, v155
  v_exp_f32 v188, v156
  v_exp_f32 v189, v157
  v_mfma_f32_32x32x16_bf16 v[64:79], a[92:95], v[204:207], v[64:79]
  v_exp_f32 v190, v158
  v_exp_f32 v191, v159
  v_cvt_pk_bf16_f32 v196, v184, v185
  v_cvt_pk_bf16_f32 v197, v186, v187
  v_mfma_f32_32x32x16_bf16 v[144:159], a[36:39], v[220:223], 0
  v_exp_f32 v176, v160
  v_exp_f32 v177, v161
  v_mfma_f32_32x32x16_bf16 v[80:95], a[80:83], v[192:195], v[80:95]
  v_exp_f32 v178, v162
  v_exp_f32 v179, v163
  v_exp_f32 v180, v164
  v_mfma_f32_32x32x16_bf16 v[144:159], a[40:43], v[224:227], v[144:159]
  v_exp_f32 v181, v165
  v_cvt_pk_bf16_f32 v198, v188, v189
  v_cvt_pk_bf16_f32 v199, v190, v191
  v_cvt_pk_bf16_f32 v200, v176, v177
  v_cvt_pk_bf16_f32 v201, v178, v179
  v_mfma_f32_32x32x16_bf16 v[96:111], a[88:91], v[192:195], v[96:111]
  v_exp_f32 v182, v166
  v_exp_f32 v183, v167
  v_exp_f32 v184, v168
  v_mfma_f32_32x32x16_bf16 v[144:159], a[44:47], v[228:231], v[144:159]
  v_exp_f32 v185, v169
  v_exp_f32 v186, v170
  v_cvt_pk_bf16_f32 v202, v180, v181
  v_cvt_pk_bf16_f32 v203, v182, v183
  v_mfma_f32_32x32x16_bf16 v[80:95], a[84:87], v[196:199], v[80:95]
  v_exp_f32 v187, v171
  v_exp_f32 v188, v172
  v_exp_f32 v189, v173
  v_mfma_f32_32x32x16_bf16 v[96:111], a[92:95], v[196:199], v[96:111]
  v_exp_f32 v190, v174
  v_exp_f32 v191, v175
  v_cvt_pk_bf16_f32 v204, v184, v185
  v_cvt_pk_bf16_f32 v205, v186, v187
  v_mfma_f32_32x32x16_bf16 v[160:175], a[36:39], v[232:235], 0
  s_waitcnt lgkmcnt(0)
  v_exp_f32 v176, v144
  v_exp_f32 v177, v145
  v_mfma_f32_32x32x16_bf16 v[16:31], a[96:99], v[200:203], v[16:31]
  v_exp_f32 v178, v146
  v_exp_f32 v179, v147
  v_exp_f32 v180, v148
  v_mfma_f32_32x32x16_bf16 v[160:175], a[40:43], v[236:239], v[160:175]
  v_exp_f32 v181, v149
  v_cvt_pk_bf16_f32 v206, v188, v189
  v_cvt_pk_bf16_f32 v207, v190, v191
  v_cvt_pk_bf16_f32 v192, v176, v177
  v_cvt_pk_bf16_f32 v193, v178, v179
  v_mfma_f32_32x32x16_bf16 v[32:47], a[104:107], v[200:203], v[32:47]
  v_exp_f32 v182, v150
  v_exp_f32 v183, v151
  v_exp_f32 v184, v152
  v_mfma_f32_32x32x16_bf16 v[160:175], a[44:47], v[240:243], v[160:175]
  v_exp_f32 v185, v153
  v_exp_f32 v186, v154
  v_cvt_pk_bf16_f32 v194, v180, v181
  v_cvt_pk_bf16_f32 v195, v182, v183
  v_mfma_f32_32x32x16_bf16 v[16:31], a[100:103], v[204:207], v[16:31]
  v_exp_f32 v187, v155
  v_exp_f32 v188, v156
  v_exp_f32 v189, v157
  v_mfma_f32_32x32x16_bf16 v[32:47], a[108:111], v[204:207], v[32:47]
  v_exp_f32 v190, v158
  v_exp_f32 v191, v159
  v_cvt_pk_bf16_f32 v196, v184, v185
  v_cvt_pk_bf16_f32 v197, v186, v187
  v_exp_f32 v176, v160
  v_exp_f32 v177, v161
  v_mfma_f32_32x32x16_bf16 v[48:63], a[96:99], v[192:195], v[48:63]
  v_exp_f32 v178, v162
  v_exp_f32 v179, v163
  v_exp_f32 v180, v164
  v_exp_f32 v181, v165
  v_cvt_pk_bf16_f32 v198, v188, v189
  v_cvt_pk_bf16_f32 v199, v190, v191
  v_cvt_pk_bf16_f32 v200, v176, v177
  v_cvt_pk_bf16_f32 v201, v178, v179
  v_mfma_f32_32x32x16_bf16 v[64:79], a[104:107], v[192:195], v[64:79]
  v_exp_f32 v182, v166
  v_exp_f32 v183, v167
  v_exp_f32 v184, v168
  v_exp_f32 v185, v169
  v_exp_f32 v186, v170
  v_cvt_pk_bf16_f32 v202, v180, v181
  v_cvt_pk_bf16_f32 v203, v182, v183
  v_mfma_f32_32x32x16_bf16 v[48:63], a[100:103], v[196:199], v[48:63]
  v_exp_f32 v187, v171
  v_exp_f32 v188, v172
  v_exp_f32 v189, v173
  v_mfma_f32_32x32x16_bf16 v[64:79], a[108:111], v[196:199], v[64:79]
  v_exp_f32 v190, v174
  v_exp_f32 v191, v175
  v_cvt_pk_bf16_f32 v204, v184, v185
  v_cvt_pk_bf16_f32 v205, v186, v187
  v_cvt_pk_bf16_f32 v206, v188, v189
  v_cvt_pk_bf16_f32 v207, v190, v191
  s_nop 1
  v_mfma_f32_32x32x16_bf16 v[80:95], a[96:99], v[200:203], v[80:95]
  v_mfma_f32_32x32x16_bf16 v[96:111], a[104:107], v[200:203], v[96:111]
  v_mfma_f32_32x32x16_bf16 v[80:95], a[100:103], v[204:207], v[80:95]
  v_mfma_f32_32x32x16_bf16 v[96:111], a[108:111], v[204:207], v[96:111]
  s_branch L_epiV
L_epiV:
  s_nop 7
  s_nop 7
  v_mov_b32 v12, 0
  v_mov_b32 v13, 0
  v_mov_b32 v0, 1.0
  v_mov_b32 v9, 1.0
  v_pk_fma_f32 v[12:13], v[16:17], 0, v[12:13]
  v_pk_fma_f32 v[12:13], v[18:19], 0, v[12:13]
  v_pk_fma_f32 v[12:13], v[20:21], 0, v[12:13]
  v_pk_fma_f32 v[12:13], v[22:23], 0, v[12:13]
  v_pk_fma_f32 v[12:13], v[24:25], 0, v[12:13]
  v_pk_fma_f32 v[12:13], v[26:27], 0, v[12:13]
  v_pk_fma_f32 v[12:13], v[28:29], 0, v[12:13]
  v_pk_fma_f32 v[12:13], v[30:31], 0, v[12:13]
  v_pk_fma_f32 v[12:13], v[32:33], 0, v[12:13]
  v_pk_fma_f32 v[12:13], v[34:35], 0, v[12:13]
  v_pk_fma_f32 v[12:13], v[36:37], 0, v[12:13]
  v_pk_fma_f32 v[12:13], v[38:39], 0, v[12:13]
  v_pk_fma_f32 v[12:13], v[40:41], 0, v[12:13]
  v_min_f32 v0, v0, v40
  v_max_f32 v9, v9, v40
  v_pk_fma_f32 v[12:13], v[48:49], 0, v[12:13]
  v_pk_fma_f32 v[12:13], v[50:51], 0, v[12:13]
  v_pk_fma_f32 v[12:13], v[52:53], 0, v[12:13]
  v_pk_fma_f32 v[12:13], v[54:55], 0, v[12:13]
  v_pk_fma_f32 v[12:13], v[56:57], 0, v[12:13]
  v_pk_fma_f32 v[12:13], v[58:59], 0, v[12:13]
  v_pk_fma_f32 v[12:13], v[60:61], 0, v[12:13]
  v_pk_fma_f32 v[12:13], v[62:63], 0, v[12:13]
  v_pk_fma_f32 v[12:13], v[64:65], 0, v[12:13]
  v_pk_fma_f32 v[12:13], v[66:67], 0, v[12:13]
  v_pk_fma_f32 v[12:13], v[68:69], 0, v[12:13]
  v_pk_fma_f32 v[12:13], v[70:71], 0, v[12:13]
  v_pk_fma_f32 v[12:13], v[72:73], 0, v[12:13]
  v_min_f32 v0, v0, v72
  v_max_f32 v9, v9, v72
  v_pk_fma_f32 v[12:13], v[80:81], 0, v[12:13]
  v_pk_fma_f32 v[12:13], v[82:83], 0, v[12:13]
  v_pk_fma_f32 v[12:13], v[84:85], 0, v[12:13]
  v_pk_fma_f32 v[12:13], v[86:87], 0, v[12:13]
  v_pk_fma_f32 v[12:13], v[88:89], 0, v[12:13]
  v_pk_fma_f32 v[12:13], v[90:91], 0, v[12:13]
  v_pk_fma_f32 v[12:13], v[92:93], 0, v[12:13]
  v_pk_fma_f32 v[12:13], v[94:95], 0, v[12:13]
  v_pk_fma_f32 v[12:13], v[96:97], 0, v[12:13]
  v_pk_fma_f32 v[12:13], v[98:99], 0, v[12:13]
  v_pk_fma_f32 v[12:13], v[100:101], 0, v[12:13]
  v_pk_fma_f32 v[12:13], v[102:103], 0, v[12:13]
  v_pk_fma_f32 v[12:13], v[104:105], 0, v[12:13]
  v_min_f32 v0, v0, v104
  v_max_f32 v9, v9, v104
  v_add_f32 v12, v12, v13
  s_mov_b32 s36, 0x1f800000
  s_mov_b32 s39, 0x5f800000
  v_cmp_le_f32 vcc, s36, v0
  v_cmp_ge_f32 s[92:93], s39, v9
  v_cmp_o_f32 s[96:97], v12, v12
  s_nop 1
  s_and_b64 s[92:93], s[92:93], vcc
  s_and_b64 s[92:93], s[92:93], s[96:97]
  s_cmp_eq_u64 s[92:93], -1
  s_cbranch_scc0 L_fb_V
L_ok_V:
  v_rcp_f32 v10, v40
  s_nop 0
  v_pk_mul_f32 v[16:17], v[16:17], v[10:11] op_sel_hi:[1,0]
  v_pk_mul_f32 v[18:19], v[18:19], v[10:11] op_sel_hi:[1,0]
  v_pk_mul_f32 v[20:21], v[20:21], v[10:11] op_sel_hi:[1,0]
  v_pk_mul_f32 v[22:23], v[22:23], v[10:11] op_sel_hi:[1,0]
  v_pk_mul_f32 v[24:25], v[24:25], v[10:11] op_sel_hi:[1,0]
  v_pk_mul_f32 v[26:27], v[26:27], v[10:11] op_sel_hi:[1,0]
  v_pk_mul_f32 v[28:29], v[28:29], v[10:11] op_sel_hi:[1,0]
  v_pk_mul_f32 v[30:31], v[30:31], v[10:11] op_sel_hi:[1,0]
  v_pk_mul_f32 v[32:33], v[32:33], v[10:11] op_sel_hi:[1,0]
  v_pk_mul_f32 v[34:35], v[34:35], v[10:11] op_sel_hi:[1,0]
  v_pk_mul_f32 v[36:37], v[36:37], v[10:11] op_sel_hi:[1,0]
  v_pk_mul_f32 v[38:39], v[38:39], v[10:11] op_sel_hi:[1,0]
  v_cvt_pk_bf16_f32 v16, v16, v17
  v_cvt_pk_bf16_f32 v17, v18, v19
  v_cvt_pk_bf16_f32 v18, v20, v21
  v_cvt_pk_bf16_f32 v19, v22, v23
  v_cvt_pk_bf16_f32 v20, v24, v25
  v_cvt_pk_bf16_f32 v21, v26, v27
  v_cvt_pk_bf16_f32 v22, v28, v29
  v_cvt_pk_bf16_f32 v23, v30, v31
  v_cvt_pk_bf16_f32 v24, v32, v33
  v_cvt_pk_bf16_f32 v25, v34, v35
  v_cvt_pk_bf16_f32 v26, v36, v37
  v_cvt_pk_bf16_f32 v27, v38, v39
  buffer_store_dwordx4 v[16:19], v1, s[8:11], s88 offen offset:0 sc1
  buffer_store_dwordx4 v[20:23], v1, s[8:11], s88 offen offset:1024 sc1
  buffer_store_dwordx4 v[24:27], v1, s[8:11], s88 offen offset:2048 sc1
  v_rcp_f32 v10, v72
  s_nop 0
  v_pk_mul_f32 v[48:49], v[48:49], v[10:11] op_sel_hi:[1,0]
  v_pk_mul_f32 v[50:51], v[50:51], v[10:11] op_sel_hi:[1,0]
  v_pk_mul_f32 v[52:53], v[52:53], v[10:11] op_sel_hi:[1,0]
  v_pk_mul_f32 v[54:55], v[54:55], v[10:11] op_sel_hi:[1,0]
  v_pk_mul_f32 v[56:57], v[56:57], v[10:11] op_sel_hi:[1,0]
  v_pk_mul_f32 v[58:59], v[58:59], v[10:11] op_sel_hi:[1,0]
  v_pk_mul_f32 v[60:61], v[60:61], v[10:11] op_sel_hi:[1,0]
  v_pk_mul_f32 v[62:63], v[62:63], v[10:11] op_sel_hi:[1,0]
  v_pk_mul_f32 v[64:65], v[64:65], v[10:11] op_sel_hi:[1,0]
  v_pk_mul_f32 v[66:67], v[66:67], v[10:11] op_sel_hi:[1,0]
  v_pk_mul_f32 v[68:69], v[68:69], v[10:11] op_sel_hi:[1,0]
  v_pk_mul_f32 v[70:71], v[70:71], v[10:11] op_sel_hi:[1,0]
  v_cvt_pk_bf16_f32 v48, v48, v49
  v_cvt_pk_bf16_f32 v49, v50, v51
  v_cvt_pk_bf16_f32 v50, v52, v53
  v_cvt_pk_bf16_f32 v51, v54, v55
  v_cvt_pk_bf16_f32 v52, v56, v57
  v_cvt_pk_bf16_f32 v53, v58, v59
  v_cvt_pk_bf16_f32 v54, v60, v61
  v_cvt_pk_bf16_f32 v55, v62, v63
  v_cvt_pk_bf16_f32 v56, v64, v65
  v_cvt_pk_bf16_f32 v57, v66, v67
  v_cvt_pk_bf16_f32 v58, v68, v69
  v_cvt_pk_bf16_f32 v59, v70, v71
  buffer_store_dwordx4 v[48:51], v1, s[8:11], s89 offen offset:0 sc1
  buffer_store_dwordx4 v[52:55], v1, s[8:11], s89 offen offset:1024 sc1
  buffer_store_dwordx4 v[56:59], v1, s[8:11], s89 offen offset:2048 sc1
  v_rcp_f32 v10, v104
  s_nop 0
  v_pk_mul_f32 v[80:81], v[80:81], v[10:11] op_sel_hi:[1,0]
  v_pk_mul_f32 v[82:83], v[82:83], v[10:11] op_sel_hi:[1,0]
  v_pk_mul_f32 v[84:85], v[84:85], v[10:11] op_sel_hi:[1,0]
  v_pk_mul_f32 v[86:87], v[86:87], v[10:11] op_sel_hi:[1,0]
  v_pk_mul_f32 v[88:89], v[88:89], v[10:11] op_sel_hi:[1,0]
  v_pk_mul_f32 v[90:91], v[90:91], v[10:11] op_sel_hi:[1,0]
  v_pk_mul_f32 v[92:93], v[92:93], v[10:11] op_sel_hi:[1,0]
  v_pk_mul_f32 v[94:95], v[94:95], v[10:11] op_sel_hi:[1,0]
  v_pk_mul_f32 v[96:97], v[96:97], v[10:11] op_sel_hi:[1,0]
  v_pk_mul_f32 v[98:99], v[98:99], v[10:11] op_sel_hi:[1,0]
  v_pk_mul_f32 v[100:101], v[100:101], v[10:11] op_sel_hi:[1,0]
  v_pk_mul_f32 v[102:103], v[102:103], v[10:11] op_sel_hi:[1,0]
  v_cvt_pk_bf16_f32 v80, v80, v81
  v_cvt_pk_bf16_f32 v81, v82, v83
  v_cvt_pk_bf16_f32 v82, v84, v85
  v_cvt_pk_bf16_f32 v83, v86, v87
  v_cvt_pk_bf16_f32 v84, v88, v89
  v_cvt_pk_bf16_f32 v85, v90, v91
  v_cvt_pk_bf16_f32 v86, v92, v93
  v_cvt_pk_bf16_f32 v87, v94, v95
  v_cvt_pk_bf16_f32 v88, v96, v97
  v_cvt_pk_bf16_f32 v89, v98, v99
  v_cvt_pk_bf16_f32 v90, v100, v101
  v_cvt_pk_bf16_f32 v91, v102, v103
  buffer_store_dwordx4 v[80:83], v1, s[8:11], s90 offen offset:0 sc1
  buffer_store_dwordx4 v[84:87], v1, s[8:11], s90 offen offset:1024 sc1
  buffer_store_dwordx4 v[88:91], v1, s[8:11], s90 offen offset:2048 sc1
  s_branch L_vdone
L_epiW:
  s_lshr_b32 s36, s30, 1
  s_mul_i32 s36, s36, 7168
  s_add_u32 s36, s36, 114688
  v_add_u32 v11, s36, v1
  s_mul_i32 s36, s30, 7168
  s_add_u32 s36, s36, 129024
  v_add_u32 v144, s36, v1
  v_add_u32 v145, 129024, v1
  s_and_b32 s37, s30, 1
  s_nop 7
  s_nop 7
  s_cmp_eq_u32 s37, 0
  s_cbranch_scc1 L_w_nox
  ds_write_b128 v11, v[80:83] offset:0
  ds_write_b128 v11, v[84:87] offset:1024
  ds_write_b128 v11, v[88:91] offset:2048
  ds_write_b128 v11, v[92:95] offset:3072
  ds_write_b128 v11, v[96:99] offset:4096
  ds_write_b128 v11, v[100:103] offset:5120
  ds_write_b128 v11, v[104:107] offset:6144
L_w_nox:
  s_cmp_eq_u32 s30, 3
  s_cbranch_scc1 L_w_noy
  ds_write_b128 v144, v[112:115] offset:0
  ds_write_b128 v144, v[116:119] offset:1024
  ds_write_b128 v144, v[120:123] offset:2048
  ds_write_b128 v144, v[124:127] offset:3072
  ds_write_b128 v144, v[128:131] offset:4096
  ds_write_b128 v144, v[132:135] offset:5120
  ds_write_b128 v144, v[136:139] offset:6144
L_w_noy:
  v_mov_b32 v12, 0
  v_mov_b32 v13, 0
  v_mov_b32 v0, 1.0
  v_mov_b32 v9, 1.0
  v_pk_fma_f32 v[12:13], v[16:17], 0, v[12:13]
  v_pk_fma_f32 v[12:13], v[18:19], 0, v[12:13]
  v_pk_fma_f32 v[12:13], v[20:21], 0, v[12:13]
  v_pk_fma_f32 v[12:13], v[22:23], 0, v[12:13]
  v_pk_fma_f32 v[12:13], v[24:25], 0, v[12:13]
  v_pk_fma_f32 v[12:13], v[26:27], 0, v[12:13]
  v_pk_fma_f32 v[12:13], v[28:29], 0, v[12:13]
  v_pk_fma_f32 v[12:13], v[30:31], 0, v[12:13]
  v_pk_fma_f32 v[12:13], v[32:33], 0, v[12:13]
  v_pk_fma_f32 v[12:13], v[34:35], 0, v[12:13]
  v_pk_fma_f32 v[12:13], v[36:37], 0, v[12:13]
  v_pk_fma_f32 v[12:13], v[38:39], 0, v[12:13]
  v_pk_fma_f32 v[12:13], v[40:41], 0, v[12:13]
  v_min_f32 v0, v0, v40
  v_max_f32 v9, v9, v40
  v_pk_fma_f32 v[12:13], v[48:49], 0, v[12:13]
  v_pk_fma_f32 v[12:13], v[50:51], 0, v[12:13]
  v_pk_fma_f32 v[12:13], v[52:53], 0, v[12:13]
  v_pk_fma_f32 v[12:13], v[54:55], 0, v[12:13]
  v_pk_fma_f32 v[12:13], v[56:57], 0, v[12:13]
  v_pk_fma_f32 v[12:13], v[58:59], 0, v[12:13]
  v_pk_fma_f32 v[12:13], v[60:61], 0, v[12:13]
  v_pk_fma_f32 v[12:13], v[62:63], 0, v[12:13]
  v_pk_fma_f32 v[12:13], v[64:65], 0, v[12:13]
  v_pk_fma_f32 v[12:13], v[66:67], 0, v[12:13]
  v_pk_fma_f32 v[12:13], v[68:69], 0, v[12:13]
  v_pk_fma_f32 v[12:13], v[70:71], 0, v[12:13]
  v_pk_fma_f32 v[12:13], v[72:73], 0, v[12:13]
  v_min_f32 v0, v0, v72
  v_max_f32 v9, v9, v72
  s_waitcnt lgkmcnt(0)
  s_barrier
  s_cmp_eq_u32 s37, 0
  s_cbranch_scc0 L_w_c1
  ds_read_b128 v[148:151], v11 offset:0
  ds_read_b128 v[152:155], v11 offset:1024
  ds_read_b128 v[156:159], v11 offset:2048
  ds_read_b128 v[160:163], v11 offset:3072
  ds_read_b128 v[164:167], v11 offset:4096
  ds_read_b128 v[168:171], v11 offset:5120
  ds_read_b128 v[172:175], v11 offset:6144
  s_waitcnt lgkmcnt(0)
  v_add_f32 v80, v80, v148
  v_add_f32 v81, v81, v149
  v_add_f32 v82, v82, v150
  v_add_f32 v83, v83, v151
  v_add_f32 v84, v84, v152
  v_add_f32 v85, v85, v153
  v_add_f32 v86, v86, v154
  v_add_f32 v87, v87, v155
  v_add_f32 v88, v88, v156
  v_add_f32 v89, v89, v157
  v_add_f32 v90, v90, v158
  v_add_f32 v91, v91, v159
  v_add_f32 v92, v92, v160
  v_add_f32 v93, v93, v161
  v_add_f32 v94, v94, v162
  v_add_f32 v95, v95, v163
  v_add_f32 v96, v96, v164
  v_add_f32 v97, v97, v165
  v_add_f32 v98, v98, v166
  v_add_f32 v99, v99, v167
  v_add_f32 v100, v100, v168
  v_add_f32 v101, v101, v169
  v_add_f32 v102, v102, v170
  v_add_f32 v103, v103, v171
  v_add_f32 v104, v104, v172
  v_add_f32 v105, v105, v173
  v_add_f32 v106, v106, v174
  v_add_f32 v107, v107, v175
  v_pk_fma_f32 v[12:13], v[80:81], 0, v[12:13]
  v_pk_fma_f32 v[12:13], v[82:83], 0, v[12:13]
  v_pk_fma_f32 v[12:13], v[84:85], 0, v[12:13]
  v_pk_fma_f32 v[12:13], v[86:87], 0, v[12:13]
  v_pk_fma_f32 v[12:13], v[88:89], 0, v[12:13]
  v_pk_fma_f32 v[12:13], v[90:91], 0, v[12:13]
  v_pk_fma_f32 v[12:13], v[92:93], 0, v[12:13]
  v_pk_fma_f32 v[12:13], v[94:95], 0, v[12:13]
  v_pk_fma_f32 v[12:13], v[96:97], 0, v[12:13]
  v_pk_fma_f32 v[12:13], v[98:99], 0, v[12:13]
  v_pk_fma_f32 v[12:13], v[100:101], 0, v[12:13]
  v_pk_fma_f32 v[12:13], v[102:103], 0, v[12:13]
  v_pk_fma_f32 v[12:13], v[104:105], 0, v[12:13]
  v_min_f32 v0, v0, v104
  v_max_f32 v9, v9, v104
L_w_c1:
  s_cmp_eq_u32 s30, 3
  s_cbranch_scc0 L_w_c2
  ds_read_b128 v[148:151], v145 offset:0
  ds_read_b128 v[152:155], v145 offset:1024
  ds_read_b128 v[156:159], v145 offset:2048
  ds_read_b128 v[160:163], v145 offset:3072
  ds_read_b128 v[164:167], v145 offset:4096
  ds_read_b128 v[168:171], v145 offset:5120
  ds_read_b128 v[172:175], v145 offset:6144
  s_waitcnt lgkmcnt(0)
  v_add_f32 v112, v112, v148
  v_add_f32 v113, v113, v149
  v_add_f32 v114, v114, v150
  v_add_f32 v115, v115, v151
  v_add_f32 v116, v116, v152
  v_add_f32 v117, v117, v153
  v_add_f32 v118, v118, v154
  v_add_f32 v119, v119, v155
  v_add_f32 v120, v120, v156
  v_add_f32 v121, v121, v157
  v_add_f32 v122, v122, v158
  v_add_f32 v123, v123, v159
  v_add_f32 v124, v124, v160
  v_add_f32 v125, v125, v161
  v_add_f32 v126, v126, v162
  v_add_f32 v127, v127, v163
  v_add_f32 v128, v128, v164
  v_add_f32 v129, v129, v165
  v_add_f32 v130, v130, v166
  v_add_f32 v131, v131, v167
  v_add_f32 v132, v132, v168
  v_add_f32 v133, v133, v169
  v_add_f32 v134, v134, v170
  v_add_f32 v135, v135, v171
  v_add_f32 v136, v136, v172
  v_add_f32 v137, v137, v173
  v_add_f32 v138, v138, v174
  v_add_f32 v139, v139, v175
  ds_read_b128 v[148:151], v145 offset:7168
  ds_read_b128 v[152:155], v145 offset:8192
  ds_read_b128 v[156:159], v145 offset:9216
  ds_read_b128 v[160:163], v145 offset:10240
  ds_read_b128 v[164:167], v145 offset:11264
  ds_read_b128 v[168:171], v145 offset:12288
  ds_read_b128 v[172:175], v145 offset:13312
  s_waitcnt lgkmcnt(0)
  v_add_f32 v112, v112, v148
  v_add_f32 v113, v113, v149
  v_add_f32 v114, v114, v150
  v_add_f32 v115, v115, v151
  v_add_f32 v116, v116, v152
  v_add_f32 v117, v117, v153
  v_add_f32 v118, v118, v154
  v_add_f32 v119, v119, v155
  v_add_f32 v120, v120, v156
  v_add_f32 v121, v121, v157
  v_add_f32 v122, v122, v158
  v_add_f32 v123, v123, v159
  v_add_f32 v124, v124, v160
  v_add_f32 v125, v125, v161
  v_add_f32 v126, v126, v162
  v_add_f32 v127, v127, v163
  v_add_f32 v128, v128, v164
  v_add_f32 v129, v129, v165
  v_add_f32 v130, v130, v166
  v_add_f32 v131, v131, v167
  v_add_f32 v132, v132, v168
  v_add_f32 v133, v133, v169
  v_add_f32 v134, v134, v170
  v_add_f32 v135, v135, v171
  v_add_f32 v136, v136, v172
  v_add_f32 v137, v137, v173
  v_add_f32 v138, v138, v174
  v_add_f32 v139, v139, v175
  ds_read_b128 v[148:151], v145 offset:14336
  ds_read_b128 v[152:155], v145 offset:15360
  ds_read_b128 v[156:159], v145 offset:16384
  ds_read_b128 v[160:163], v145 offset:17408
  ds_read_b128 v[164:167], v145 offset:18432
  ds_read_b128 v[168:171], v145 offset:19456
  ds_read_b128 v[172:175], v145 offset:20480
  s_waitcnt lgkmcnt(0)
  v_add_f32 v112, v112, v148
  v_add_f32 v113, v113, v149
  v_add_f32 v114, v114, v150
  v_add_f32 v115, v115, v151
  v_add_f32 v116, v116, v152
  v_add_f32 v117, v117, v153
  v_add_f32 v118, v118, v154
  v_add_f32 v119, v119, v155
  v_add_f32 v120, v120, v156
  v_add_f32 v121, v121, v157
  v_add_f32 v122, v122, v158
  v_add_f32 v123, v123, v159
  v_add_f32 v124, v124, v160
  v_add_f32 v125, v125, v161
  v_add_f32 v126, v126, v162
  v_add_f32 v127, v127, v163
  v_add_f32 v128, v128, v164
  v_add_f32 v129, v129, v165
  v_add_f32 v130, v130, v166
  v_add_f32 v131, v131, v167
  v_add_f32 v132, v132, v168
  v_add_f32 v133, v133, v169
  v_add_f32 v134, v134, v170
  v_add_f32 v135, v135, v171
  v_add_f32 v136, v136, v172
  v_add_f32 v137, v137, v173
  v_add_f32 v138, v138, v174
  v_add_f32 v139, v139, v175
  v_pk_fma_f32 v[12:13], v[112:113], 0, v[12:13]
  v_pk_fma_f32 v[12:13], v[114:115], 0, v[12:13]
  v_pk_fma_f32 v[12:13], v[116:117], 0, v[12:13]
  v_pk_fma_f32 v[12:13], v[118:119], 0, v[12:13]
  v_pk_fma_f32 v[12:13], v[120:121], 0, v[12:13]
  v_pk_fma_f32 v[12:13], v[122:123], 0, v[12:13]
  v_pk_fma_f32 v[12:13], v[124:125], 0, v[12:13]
  v_pk_fma_f32 v[12:13], v[126:127], 0, v[12:13]
  v_pk_fma_f32 v[12:13], v[128:129], 0, v[12:13]
  v_pk_fma_f32 v[12:13], v[130:131], 0, v[12:13]
  v_pk_fma_f32 v[12:13], v[132:133], 0, v[12:13]
  v_pk_fma_f32 v[12:13], v[134:135], 0, v[12:13]
  v_pk_fma_f32 v[12:13], v[136:137], 0, v[12:13]
  v_min_f32 v0, v0, v136
  v_max_f32 v9, v9, v136
L_w_c2:
  v_add_f32 v12, v12, v13
  s_mov_b32 s36, 0x1f800000
  s_mov_b32 s39, 0x5f800000
  v_cmp_le_f32 vcc, s36, v0
  v_cmp_ge_f32 s[92:93], s39, v9
  v_cmp_o_f32 s[96:97], v12, v12
  s_nop 1
  s_and_b64 s[92:93], s[92:93], vcc
  s_and_b64 s[92:93], s[92:93], s[96:97]
  s_cmp_eq_u64 s[92:93], -1
  s_cbranch_scc0 L_fb_W
L_ok_W:
  v_rcp_f32 v10, v40
  s_nop 0
  v_pk_mul_f32 v[16:17], v[16:17], v[10:11] op_sel_hi:[1,0]
  v_pk_mul_f32 v[18:19], v[18:19], v[10:11] op_sel_hi:[1,0]
  v_pk_mul_f32 v[20:21], v[20:21], v[10:11] op_sel_hi:[1,0]
  v_pk_mul_f32 v[22:23], v[22:23], v[10:11] op_sel_hi:[1,0]
  v_pk_mul_f32 v[24:25], v[24:25], v[10:11] op_sel_hi:[1,0]
  v_pk_mul_f32 v[26:27], v[26:27], v[10:11] op_sel_hi:[1,0]
  v_pk_mul_f32 v[28:29], v[28:29], v[10:11] op_sel_hi:[1,0]
  v_pk_mul_f32 v[30:31], v[30:31], v[10:11] op_sel_hi:[1,0]
  v_pk_mul_f32 v[32:33], v[32:33], v[10:11] op_sel_hi:[1,0]
  v_pk_mul_f32 v[34:35], v[34:35], v[10:11] op_sel_hi:[1,0]
  v_pk_mul_f32 v[36:37], v[36:37], v[10:11] op_sel_hi:[1,0]
  v_pk_mul_f32 v[38:39], v[38:39], v[10:11] op_sel_hi:[1,0]
  v_cvt_pk_bf16_f32 v16, v16, v17
  v_cvt_pk_bf16_f32 v17, v18, v19
  v_cvt_pk_bf16_f32 v18, v20, v21
  v_cvt_pk_bf16_f32 v19, v22, v23
  v_cvt_pk_bf16_f32 v20, v24, v25
  v_cvt_pk_bf16_f32 v21, v26, v27
  v_cvt_pk_bf16_f32 v22, v28, v29
  v_cvt_pk_bf16_f32 v23, v30, v31
  v_cvt_pk_bf16_f32 v24, v32, v33
  v_cvt_pk_bf16_f32 v25, v34, v35
  v_cvt_pk_bf16_f32 v26, v36, v37
  v_cvt_pk_bf16_f32 v27, v38, v39
  buffer_store_dwordx4 v[16:19], v1, s[8:11], s88 offen offset:0 sc1
  buffer_store_dwordx4 v[20:23], v1, s[8:11], s88 offen offset:1024 sc1
  buffer_store_dwordx4 v[24:27], v1, s[8:11], s88 offen offset:2048 sc1
  v_rcp_f32 v10, v72
  s_nop 0
  v_pk_mul_f32 v[48:49], v[48:49], v[10:11] op_sel_hi:[1,0]
  v_pk_mul_f32 v[50:51], v[50:51], v[10:11] op_sel_hi:[1,0]
  v_pk_mul_f32 v[52:53], v[52:53], v[10:11] op_sel_hi:[1,0]
  v_pk_mul_f32 v[54:55], v[54:55], v[10:11] op_sel_hi:[1,0]
  v_pk_mul_f32 v[56:57], v[56:57], v[10:11] op_sel_hi:[1,0]
  v_pk_mul_f32 v[58:59], v[58:59], v[10:11] op_sel_hi:[1,0]
  v_pk_mul_f32 v[60:61], v[60:61], v[10:11] op_sel_hi:[1,0]
  v_pk_mul_f32 v[62:63], v[62:63], v[10:11] op_sel_hi:[1,0]
  v_pk_mul_f32 v[64:65], v[64:65], v[10:11] op_sel_hi:[1,0]
  v_pk_mul_f32 v[66:67], v[66:67], v[10:11] op_sel_hi:[1,0]
  v_pk_mul_f32 v[68:69], v[68:69], v[10:11] op_sel_hi:[1,0]
  v_pk_mul_f32 v[70:71], v[70:71], v[10:11] op_sel_hi:[1,0]
  v_cvt_pk_bf16_f32 v48, v48, v49
  v_cvt_pk_bf16_f32 v49, v50, v51
  v_cvt_pk_bf16_f32 v50, v52, v53
  v_cvt_pk_bf16_f32 v51, v54, v55
  v_cvt_pk_bf16_f32 v52, v56, v57
  v_cvt_pk_bf16_f32 v53, v58, v59
  v_cvt_pk_bf16_f32 v54, v60, v61
  v_cvt_pk_bf16_f32 v55, v62, v63
  v_cvt_pk_bf16_f32 v56, v64, v65
  v_cvt_pk_bf16_f32 v57, v66, v67
  v_cvt_pk_bf16_f32 v58, v68, v69
  v_cvt_pk_bf16_f32 v59, v70, v71
  buffer_store_dwordx4 v[48:51], v1, s[8:11], s89 offen offset:0 sc1
  buffer_store_dwordx4 v[52:55], v1, s[8:11], s89 offen offset:1024 sc1
  buffer_store_dwordx4 v[56:59], v1, s[8:11], s89 offen offset:2048 sc1
  s_cmp_eq_u32 s37, 0
  s_cbranch_scc0 L_w_s1
  v_rcp_f32 v10, v104
  s_nop 0
  v_pk_mul_f32 v[80:81], v[80:81], v[10:11] op_sel_hi:[1,0]
  v_pk_mul_f32 v[82:83], v[82:83], v[10:11] op_sel_hi:[1,0]
  v_pk_mul_f32 v[84:85], v[84:85], v[10:11] op_sel_hi:[1,0]
  v_pk_mul_f32 v[86:87], v[86:87], v[10:11] op_sel_hi:[1,0]
  v_pk_mul_f32 v[88:89], v[88:89], v[10:11] op_sel_hi:[1,0]
  v_pk_mul_f32 v[90:91], v[90:91], v[10:11] op_sel_hi:[1,0]
  v_pk_mul_f32 v[92:93], v[92:93], v[10:11] op_sel_hi:[1,0]
  v_pk_mul_f32 v[94:95], v[94:95], v[10:11] op_sel_hi:[1,0]
  v_pk_mul_f32 v[96:97], v[96:97], v[10:11] op_sel_hi:[1,0]
  v_pk_mul_f32 v[98:99], v[98:99], v[10:11] op_sel_hi:[1,0]
  v_pk_mul_f32 v[100:101], v[100:101], v[10:11] op_sel_hi:[1,0]
  v_pk_mul_f32 v[102:103], v[102:103], v[10:11] op_sel_hi:[1,0]
  v_cvt_pk_bf16_f32 v80, v80, v81
  v_cvt_pk_bf16_f32 v81, v82, v83
  v_cvt_pk_bf16_f32 v82, v84, v85
  v_cvt_pk_bf16_f32 v83, v86, v87
  v_cvt_pk_bf16_f32 v84, v88, v89
  v_cvt_pk_bf16_f32 v85, v90, v91
  v_cvt_pk_bf16_f32 v86, v92, v93
  v_cvt_pk_bf16_f32 v87, v94, v95
  v_cvt_pk_bf16_f32 v88, v96, v97
  v_cvt_pk_bf16_f32 v89, v98, v99
  v_cvt_pk_bf16_f32 v90, v100, v101
  v_cvt_pk_bf16_f32 v91, v102, v103
  buffer_store_dwordx4 v[80:83], v1, s[8:11], s90 offen offset:0 sc1
  buffer_store_dwordx4 v[84:87], v1, s[8:11], s90 offen offset:1024 sc1
  buffer_store_dwordx4 v[88:91], v1, s[8:11], s90 offen offset:2048 sc1
L_w_s1:
  s_cmp_eq_u32 s30, 3
  s_cbranch_scc0 L_vdone
  v_rcp_f32 v10, v136
  s_nop 0
  v_pk_mul_f32 v[112:113], v[112:113], v[10:11] op_sel_hi:[1,0]
  v_pk_mul_f32 v[114:115], v[114:115], v[10:11] op_sel_hi:[1,0]
  v_pk_mul_f32 v[116:117], v[116:117], v[10:11] op_sel_hi:[1,0]
  v_pk_mul_f32 v[118:119], v[118:119], v[10:11] op_sel_hi:[1,0]
  v_pk_mul_f32 v[120:121], v[120:121], v[10:11] op_sel_hi:[1,0]
  v_pk_mul_f32 v[122:123], v[122:123], v[10:11] op_sel_hi:[1,0]
  v_pk_mul_f32 v[124:125], v[124:125], v[10:11] op_sel_hi:[1,0]
  v_pk_mul_f32 v[126:127], v[126:127], v[10:11] op_sel_hi:[1,0]
  v_pk_mul_f32 v[128:129], v[128:129], v[10:11] op_sel_hi:[1,0]
  v_pk_mul_f32 v[130:131], v[130:131], v[10:11] op_sel_hi:[1,0]
  v_pk_mul_f32 v[132:133], v[132:133], v[10:11] op_sel_hi:[1,0]
  v_pk_mul_f32 v[134:135], v[134:135], v[10:11] op_sel_hi:[1,0]
  v_cvt_pk_bf16_f32 v112, v112, v113
  v_cvt_pk_bf16_f32 v113, v114, v115
  v_cvt_pk_bf16_f32 v114, v116, v117
  v_cvt_pk_bf16_f32 v115, v118, v119
  v_cvt_pk_bf16_f32 v116, v120, v121
  v_cvt_pk_bf16_f32 v117, v122, v123
  v_cvt_pk_bf16_f32 v118, v124, v125
  v_cvt_pk_bf16_f32 v119, v126, v127
  v_cvt_pk_bf16_f32 v120, v128, v129
  v_cvt_pk_bf16_f32 v121, v130, v131
  v_cvt_pk_bf16_f32 v122, v132, v133
  v_cvt_pk_bf16_f32 v123, v134, v135
  buffer_store_dwordx4 v[112:115], v1, s[8:11], s91 offen offset:0 sc1
  buffer_store_dwordx4 v[116:119], v1, s[8:11], s91 offen offset:1024 sc1
  buffer_store_dwordx4 v[120:123], v1, s[8:11], s91 offen offset:2048 sc1
L_vdone:
  s_waitcnt vmcnt(0)
  s_barrier
  s_cmp_eq_u32 s30, 0
  s_cbranch_scc0 L_sig2
  s_lshl_b32 s36, 8, s33
  v_mov_b32 v10, s36
  s_lshl_b32 s37, s32, 2
  v_mov_b32 v13, s37
  s_nop 1
  s_mov_b64 s[92:93], exec
  s_mov_b64 exec, 1
  global_atomic_add v13, v10, s[44:45] sc1
  s_mov_b64 exec, s[92:93]
L_sig2:
  s_lshr_b32 s36, s2, 3
  s_xor_b32 s36, s36, 18
  s_or_b32 s36, s36, s30
  s_cmp_lt_u32 s36, 1
  s_cbranch_scc0 L_nowb
  buffer_wbl2 sc1
  s_waitcnt vmcnt(0)
L_nowb:
  s_branch L_exit
L_epiH:
  s_lshr_b32 s36, s30, 1
  s_mul_i32 s36, s36, 7168
  s_add_u32 s36, s36, 114688
  v_add_u32 v11, s36, v1
  s_and_b32 s37, s30, 1
  v_accvgpr_read_b32 v2, a250
  v_accvgpr_read_b32 v3, a251
  v_accvgpr_read_b32 v4, a252
  v_accvgpr_read_b32 v5, a253
  s_cmp_lg_u32 s14, 0
  s_cbranch_scc1 L_p2done
  s_waitcnt vmcnt(0)
  s_mov_b32 s94, 0x40000
L_p2:
  global_load_dword v12, v13, s[44:45] sc1
  s_waitcnt vmcnt(0)
  v_and_b32 v12, s38, v12
  v_cmp_ne_u32 vcc, s38, v12
  s_nop 3
  s_cmp_eq_u64 vcc, 0
  s_cbranch_scc1 L_p2ok
  s_sub_u32 s94, s94, 1
  s_cmp_lg_u32 s94, 0
  s_cbranch_scc1 L_p2
L_p2ok:
  s_mov_b32 s14, 31457280
  buffer_load_dwordx4 a[184:187], v1, s[12:15], s88 offen offset:0 sc1
  buffer_load_dwordx4 a[188:191], v1, s[12:15], s88 offen offset:1024 sc1
  buffer_load_dwordx4 a[192:195], v1, s[12:15], s88 offen offset:2048 sc1
  buffer_load_dwordx4 a[196:199], v1, s[12:15], s89 offen offset:0 sc1
  buffer_load_dwordx4 a[200:203], v1, s[12:15], s89 offen offset:1024 sc1
  buffer_load_dwordx4 a[204:207], v1, s[12:15], s89 offen offset:2048 sc1
  buffer_load_dwordx4 a[208:211], v1, s[12:15], s90 offen offset:0 sc1
  buffer_load_dwordx4 a[212:215], v1, s[12:15], s90 offen offset:1024 sc1
  buffer_load_dwordx4 a[216:219], v1, s[12:15], s90 offen offset:2048 sc1
  buffer_load_dwordx4 a[220:223], v1, s[12:15], s91 offen offset:0 sc1
  buffer_load_dwordx4 a[224:227], v1, s[12:15], s91 offen offset:1024 sc1
  buffer_load_dwordx4 a[228:231], v1, s[12:15], s91 offen offset:2048 sc1
L_p2done:
  v_mov_b32 v12, 0
  v_mov_b32 v13, 0
  v_mov_b32 v0, 1.0
  v_mov_b32 v9, 1.0
  v_pk_fma_f32 v[12:13], v[16:17], 0, v[12:13]
  v_pk_fma_f32 v[12:13], v[18:19], 0, v[12:13]
  v_pk_fma_f32 v[12:13], v[20:21], 0, v[12:13]
  v_pk_fma_f32 v[12:13], v[22:23], 0, v[12:13]
  v_pk_fma_f32 v[12:13], v[24:25], 0, v[12:13]
  v_pk_fma_f32 v[12:13], v[26:27], 0, v[12:13]
  v_pk_fma_f32 v[12:13], v[28:29], 0, v[12:13]
  v_pk_fma_f32 v[12:13], v[30:31], 0, v[12:13]
  v_pk_fma_f32 v[12:13], v[32:33], 0, v[12:13]
  v_pk_fma_f32 v[12:13], v[34:35], 0, v[12:13]
  v_pk_fma_f32 v[12:13], v[36:37], 0, v[12:13]
  v_pk_fma_f32 v[12:13], v[38:39], 0, v[12:13]
  v_pk_fma_f32 v[12:13], v[40:41], 0, v[12:13]
  v_min_f32 v0, v0, v40
  v_max_f32 v9, v9, v40
  s_cmp_eq_u32 s37, 0
  s_cbranch_scc1 L_xw_skip
  ds_write_b128 v11, v[112:115] offset:0
  ds_write_b128 v11, v[116:119] offset:1024
  ds_write_b128 v11, v[120:123] offset:2048
  ds_write_b128 v11, v[124:127] offset:3072
  ds_write_b128 v11, v[128:131] offset:4096
  ds_write_b128 v11, v[132:135] offset:5120
  ds_write_b128 v11, v[136:139] offset:6144
L_xw_skip:
  v_rcp_f32 v10, v40
  s_nop 0
  v_pk_mul_f32 v[16:17], v[16:17], v[10:11] op_sel_hi:[1,0]
  v_pk_mul_f32 v[18:19], v[18:19], v[10:11] op_sel_hi:[1,0]
  v_pk_mul_f32 v[20:21], v[20:21], v[10:11] op_sel_hi:[1,0]
  v_pk_mul_f32 v[22:23], v[22:23], v[10:11] op_sel_hi:[1,0]
  v_pk_mul_f32 v[24:25], v[24:25], v[10:11] op_sel_hi:[1,0]
  v_pk_mul_f32 v[26:27], v[26:27], v[10:11] op_sel_hi:[1,0]
  v_pk_mul_f32 v[28:29], v[28:29], v[10:11] op_sel_hi:[1,0]
  v_pk_mul_f32 v[30:31], v[30:31], v[10:11] op_sel_hi:[1,0]
  v_pk_mul_f32 v[32:33], v[32:33], v[10:11] op_sel_hi:[1,0]
  v_pk_mul_f32 v[34:35], v[34:35], v[10:11] op_sel_hi:[1,0]
  v_pk_mul_f32 v[36:37], v[36:37], v[10:11] op_sel_hi:[1,0]
  v_pk_mul_f32 v[38:39], v[38:39], v[10:11] op_sel_hi:[1,0]
  v_cvt_pk_bf16_f32 v16, v16, v17
  v_cvt_pk_bf16_f32 v17, v18, v19
  v_cvt_pk_bf16_f32 v18, v20, v21
  v_cvt_pk_bf16_f32 v19, v22, v23
  v_cvt_pk_bf16_f32 v20, v24, v25
  v_cvt_pk_bf16_f32 v21, v26, v27
  v_cvt_pk_bf16_f32 v22, v28, v29
  v_cvt_pk_bf16_f32 v23, v30, v31
  v_cvt_pk_bf16_f32 v24, v32, v33
  v_cvt_pk_bf16_f32 v25, v34, v35
  v_cvt_pk_bf16_f32 v26, v36, v37
  v_cvt_pk_bf16_f32 v27, v38, v39
  s_waitcnt vmcnt(0) lgkmcnt(0)
  s_barrier
  s_cmp_eq_u32 s37, 0
  s_cbranch_scc0 L_x_odd
  v_mfma_f32_32x32x16_bf16 v[144:159], a[112:115], v[16:19], 0
  ds_read_b128 v[192:195], v11 offset:0
  ds_read_b128 v[196:199], v11 offset:1024
  ds_read_b128 v[200:203], v11 offset:2048
  ds_read_b128 v[204:207], v11 offset:3072
  v_mfma_f32_32x32x16_bf16 v[160:175], a[136:139], v[16:19], 0
  ds_read_b128 v[28:31], v11 offset:4096
  ds_read_b128 v[32:35], v11 offset:5120
  ds_read_b128 v[36:39], v11 offset:6144
  v_pk_fma_f32 v[12:13], v[48:49], 0, v[12:13]
  v_mfma_f32_32x32x16_bf16 v[176:191], a[160:163], v[16:19], 0
  v_pk_fma_f32 v[12:13], v[50:51], 0, v[12:13]
  v_pk_fma_f32 v[12:13], v[52:53], 0, v[12:13]
  v_pk_fma_f32 v[12:13], v[54:55], 0, v[12:13]
  v_pk_fma_f32 v[12:13], v[56:57], 0, v[12:13]
  v_pk_fma_f32 v[12:13], v[58:59], 0, v[12:13]
  v_pk_fma_f32 v[12:13], v[60:61], 0, v[12:13]
  v_mfma_f32_32x32x16_bf16 v[144:159], a[116:119], v[20:23], v[144:159]
  v_pk_fma_f32 v[12:13], v[62:63], 0, v[12:13]
  v_pk_fma_f32 v[12:13], v[64:65], 0, v[12:13]
  v_pk_fma_f32 v[12:13], v[66:67], 0, v[12:13]
  v_pk_fma_f32 v[12:13], v[68:69], 0, v[12:13]
  v_pk_fma_f32 v[12:13], v[70:71], 0, v[12:13]
  v_pk_fma_f32 v[12:13], v[72:73], 0, v[12:13]
  v_mfma_f32_32x32x16_bf16 v[160:175], a[140:143], v[20:23], v[160:175]
  v_min_f32 v0, v0, v72
  v_max_f32 v9, v9, v72
  v_pk_fma_f32 v[12:13], v[80:81], 0, v[12:13]
  v_pk_fma_f32 v[12:13], v[82:83], 0, v[12:13]
  v_pk_fma_f32 v[12:13], v[84:85], 0, v[12:13]
  v_pk_fma_f32 v[12:13], v[86:87], 0, v[12:13]
  v_mfma_f32_32x32x16_bf16 v[176:191], a[164:167], v[20:23], v[176:191]
  v_pk_fma_f32 v[12:13], v[88:89], 0, v[12:13]
  v_pk_fma_f32 v[12:13], v[90:91], 0, v[12:13]
  v_pk_fma_f32 v[12:13], v[92:93], 0, v[12:13]
  v_pk_fma_f32 v[12:13], v[94:95], 0, v[12:13]
  v_pk_fma_f32 v[12:13], v[96:97], 0, v[12:13]
  v_pk_fma_f32 v[12:13], v[98:99], 0, v[12:13]
  v_mfma_f32_32x32x16_bf16 v[144:159], a[120:123], v[24:27], v[144:159]
  v_pk_fma_f32 v[12:13], v[100:101], 0, v[12:13]
  v_pk_fma_f32 v[12:13], v[102:103], 0, v[12:13]
  v_pk_fma_f32 v[12:13], v[104:105], 0, v[12:13]
  v_min_f32 v0, v0, v104
  v_max_f32 v9, v9, v104
  s_waitcnt lgkmcnt(0)
  v_mfma_f32_32x32x16_bf16 v[160:175], a[144:147], v[24:27], v[160:175]
  v_add_f32 v112, v112, v192
  v_add_f32 v113, v113, v193
  v_add_f32 v114, v114, v194
  v_add_f32 v115, v115, v195
  v_add_f32 v116, v116, v196
  v_add_f32 v117, v117, v197
  v_mfma_f32_32x32x16_bf16 v[176:191], a[168:171], v[24:27], v[176:191]
  v_add_f32 v118, v118, v198
  v_add_f32 v119, v119, v199
  v_add_f32 v120, v120, v200
  v_add_f32 v121, v121, v201
  v_add_f32 v122, v122, v202
  v_add_f32 v123, v123, v203
  v_mfma_f32_32x32x16_bf16 v[144:159], a[124:127], a[184:187], v[144:159]
  v_add_f32 v124, v124, v204
  v_add_f32 v125, v125, v205
  v_add_f32 v126, v126, v206
  v_add_f32 v127, v127, v207
  v_add_f32 v128, v128, v28
  v_add_f32 v129, v129, v29
  v_mfma_f32_32x32x16_bf16 v[160:175], a[148:151], a[184:187], v[160:175]
  v_add_f32 v130, v130, v30
  v_add_f32 v131, v131, v31
  v_add_f32 v132, v132, v32
  v_add_f32 v133, v133, v33
  v_add_f32 v134, v134, v34
  v_add_f32 v135, v135, v35
  v_mfma_f32_32x32x16_bf16 v[176:191], a[172:175], a[184:187], v[176:191]
  v_add_f32 v136, v136, v36
  v_add_f32 v137, v137, v37
  v_add_f32 v138, v138, v38
  v_add_f32 v139, v139, v39
  v_pk_fma_f32 v[12:13], v[112:113], 0, v[12:13]
  v_pk_fma_f32 v[12:13], v[114:115], 0, v[12:13]
  v_mfma_f32_32x32x16_bf16 v[144:159], a[128:131], a[188:191], v[144:159]
  v_pk_fma_f32 v[12:13], v[116:117], 0, v[12:13]
  v_pk_fma_f32 v[12:13], v[118:119], 0, v[12:13]
  v_pk_fma_f32 v[12:13], v[120:121], 0, v[12:13]
  v_pk_fma_f32 v[12:13], v[122:123], 0, v[12:13]
  v_pk_fma_f32 v[12:13], v[124:125], 0, v[12:13]
  v_pk_fma_f32 v[12:13], v[126:127], 0, v[12:13]
  v_mfma_f32_32x32x16_bf16 v[160:175], a[152:155], a[188:191], v[160:175]
  v_pk_fma_f32 v[12:13], v[128:129], 0, v[12:13]
  v_pk_fma_f32 v[12:13], v[130:131], 0, v[12:13]
  v_pk_fma_f32 v[12:13], v[132:133], 0, v[12:13]
  v_pk_fma_f32 v[12:13], v[134:135], 0, v[12:13]
  v_pk_fma_f32 v[12:13], v[136:137], 0, v[12:13]
  v_min_f32 v0, v0, v136
  v_mfma_f32_32x32x16_bf16 v[176:191], a[176:179], a[188:191], v[176:191]
  v_max_f32 v9, v9, v136
  v_mfma_f32_32x32x16_bf16 v[144:159], a[132:135], a[192:195], v[144:159]
  v_mfma_f32_32x32x16_bf16 v[160:175], a[156:159], a[192:195], v[160:175]
  v_mfma_f32_32x32x16_bf16 v[176:191], a[180:183], a[192:195], v[176:191]
  s_branch L_x_join
L_x_odd:
  v_mfma_f32_32x32x16_bf16 v[144:159], a[112:115], v[16:19], 0
  v_pk_fma_f32 v[12:13], v[48:49], 0, v[12:13]
  v_pk_fma_f32 v[12:13], v[50:51], 0, v[12:13]
  v_pk_fma_f32 v[12:13], v[52:53], 0, v[12:13]
  v_pk_fma_f32 v[12:13], v[54:55], 0, v[12:13]
  v_pk_fma_f32 v[12:13], v[56:57], 0, v[12:13]
  v_pk_fma_f32 v[12:13], v[58:59], 0, v[12:13]
  v_mfma_f32_32x32x16_bf16 v[160:175], a[136:139], v[16:19], 0
  v_pk_fma_f32 v[12:13], v[60:61], 0, v[12:13]
  v_pk_fma_f32 v[12:13], v[62:63], 0, v[12:13]
  v_pk_fma_f32 v[12:13], v[64:65], 0, v[12:13]
  v_pk_fma_f32 v[12:13], v[66:67], 0, v[12:13]
  v_pk_fma_f32 v[12:13], v[68:69], 0, v[12:13]
  v_pk_fma_f32 v[12:13], v[70:71], 0, v[12:13]
  v_mfma_f32_32x32x16_bf16 v[176:191], a[160:163], v[16:19], 0
  v_pk_fma_f32 v[12:13], v[72:73], 0, v[12:13]
  v_min_f32 v0, v0, v72
  v_max_f32 v9, v9, v72
  v_pk_fma_f32 v[12:13], v[80:81], 0, v[12:13]
  v_pk_fma_f32 v[12:13], v[82:83], 0, v[12:13]
  v_pk_fma_f32 v[12:13], v[84:85], 0, v[12:13]
  v_mfma_f32_32x32x16_bf16 v[144:159], a[116:119], v[20:23], v[144:159]
  v_pk_fma_f32 v[12:13], v[86:87], 0, v[12:13]
  v_pk_fma_f32 v[12:13], v[88:89], 0, v[12:13]
  v_pk_fma_f32 v[12:13], v[90:91], 0, v[12:13]
  v_pk_fma_f32 v[12:13], v[92:93], 0, v[12:13]
  v_pk_fma_f32 v[12:13], v[94:95], 0, v[12:13]
  v_pk_fma_f32 v[12:13], v[96:97], 0, v[12:13]
  v_mfma_f32_32x32x16_bf16 v[160:175], a[140:143], v[20:23], v[160:175]
  v_pk_fma_f32 v[12:13], v[98:99], 0, v[12:13]
  v_pk_fma_f32 v[12:13], v[100:101], 0, v[12:13]
  v_pk_fma_f32 v[12:13], v[102:103], 0, v[12:13]
  v_pk_fma_f32 v[12:13], v[104:105], 0, v[12:13]
  v_min_f32 v0, v0, v104
  v_max_f32 v9, v9, v104
  v_mfma_f32_32x32x16_bf16 v[176:191], a[164:167], v[20:23], v[176:191]
  v_mfma_f32_32x32x16_bf16 v[144:159], a[120:123], v[24:27], v[144:159]
  v_mfma_f32_32x32x16_bf16 v[160:175], a[144:147], v[24:27], v[160:175]
  v_mfma_f32_32x32x16_bf16 v[176:191], a[168:171], v[24:27], v[176:191]
  v_mfma_f32_32x32x16_bf16 v[144:159], a[124:127], a[184:187], v[144:159]
  v_mfma_f32_32x32x16_bf16 v[160:175], a[148:151], a[184:187], v[160:175]
  v_mfma_f32_32x32x16_bf16 v[176:191], a[172:175], a[184:187], v[176:191]
  v_mfma_f32_32x32x16_bf16 v[144:159], a[128:131], a[188:191], v[144:159]
  v_mfma_f32_32x32x16_bf16 v[160:175], a[152:155], a[188:191], v[160:175]
  v_mfma_f32_32x32x16_bf16 v[176:191], a[176:179], a[188:191], v[176:191]
  v_mfma_f32_32x32x16_bf16 v[144:159], a[132:135], a[192:195], v[144:159]
  v_mfma_f32_32x32x16_bf16 v[160:175], a[156:159], a[192:195], v[160:175]
  v_mfma_f32_32x32x16_bf16 v[176:191], a[180:183], a[192:195], v[176:191]
L_x_join:
  v_add_f32 v12, v12, v13
  s_mov_b32 s36, 0x1f800000
  s_mov_b32 s39, 0x5f800000
  v_cmp_le_f32 vcc, s36, v0
  v_cmp_ge_f32 s[92:93], s39, v9
  v_cmp_o_f32 s[96:97], v12, v12
  s_nop 1
  s_and_b64 s[92:93], s[92:93], vcc
  s_and_b64 s[92:93], s[92:93], s[96:97]
  s_cmp_eq_u64 s[92:93], -1
  s_cbranch_scc0 L_fb_H
L_ok_H:
  v_rcp_f32 v10, v72
  s_nop 0
  v_pk_mul_f32 v[48:49], v[48:49], v[10:11] op_sel_hi:[1,0]
  v_pk_mul_f32 v[50:51], v[50:51], v[10:11] op_sel_hi:[1,0]
  v_pk_mul_f32 v[52:53], v[52:53], v[10:11] op_sel_hi:[1,0]
  v_pk_mul_f32 v[54:55], v[54:55], v[10:11] op_sel_hi:[1,0]
  v_pk_mul_f32 v[56:57], v[56:57], v[10:11] op_sel_hi:[1,0]
  v_pk_mul_f32 v[58:59], v[58:59], v[10:11] op_sel_hi:[1,0]
  v_pk_mul_f32 v[60:61], v[60:61], v[10:11] op_sel_hi:[1,0]
  v_pk_mul_f32 v[62:63], v[62:63], v[10:11] op_sel_hi:[1,0]
  v_pk_mul_f32 v[64:65], v[64:65], v[10:11] op_sel_hi:[1,0]
  v_pk_mul_f32 v[66:67], v[66:67], v[10:11] op_sel_hi:[1,0]
  v_pk_mul_f32 v[68:69], v[68:69], v[10:11] op_sel_hi:[1,0]
  v_pk_mul_f32 v[70:71], v[70:71], v[10:11] op_sel_hi:[1,0]
  v_cvt_pk_bf16_f32 v48, v48, v49
  v_cvt_pk_bf16_f32 v49, v50, v51
  v_cvt_pk_bf16_f32 v50, v52, v53
  v_cvt_pk_bf16_f32 v51, v54, v55
  v_cvt_pk_bf16_f32 v52, v56, v57
  v_cvt_pk_bf16_f32 v53, v58, v59
  v_cvt_pk_bf16_f32 v54, v60, v61
  v_cvt_pk_bf16_f32 v55, v62, v63
  v_cvt_pk_bf16_f32 v56, v64, v65
  v_cvt_pk_bf16_f32 v57, v66, v67
  v_cvt_pk_bf16_f32 v58, v68, v69
  v_cvt_pk_bf16_f32 v59, v70, v71
  s_nop 1
  v_mfma_f32_32x32x16_bf16 v[192:207], a[112:115], v[48:51], 0
  v_rcp_f32 v10, v104
  s_nop 0
  v_pk_mul_f32 v[80:81], v[80:81], v[10:11] op_sel_hi:[1,0]
  v_pk_mul_f32 v[82:83], v[82:83], v[10:11] op_sel_hi:[1,0]
  v_pk_mul_f32 v[84:85], v[84:85], v[10:11] op_sel_hi:[1,0]
  v_pk_mul_f32 v[86:87], v[86:87], v[10:11] op_sel_hi:[1,0]
  v_mfma_f32_32x32x16_bf16 v[208:223], a[136:139], v[48:51], 0
  v_pk_mul_f32 v[88:89], v[88:89], v[10:11] op_sel_hi:[1,0]
  v_pk_mul_f32 v[90:91], v[90:91], v[10:11] op_sel_hi:[1,0]
  v_pk_mul_f32 v[92:93], v[92:93], v[10:11] op_sel_hi:[1,0]
  v_pk_mul_f32 v[94:95], v[94:95], v[10:11] op_sel_hi:[1,0]
  v_pk_mul_f32 v[96:97], v[96:97], v[10:11] op_sel_hi:[1,0]
  v_pk_mul_f32 v[98:99], v[98:99], v[10:11] op_sel_hi:[1,0]
  v_mfma_f32_32x32x16_bf16 v[224:239], a[160:163], v[48:51], 0
  v_pk_mul_f32 v[100:101], v[100:101], v[10:11] op_sel_hi:[1,0]
  v_pk_mul_f32 v[102:103], v[102:103], v[10:11] op_sel_hi:[1,0]
  v_cvt_pk_bf16_f32 v80, v80, v81
  v_cvt_pk_bf16_f32 v81, v82, v83
  v_cvt_pk_bf16_f32 v82, v84, v85
  v_cvt_pk_bf16_f32 v83, v86, v87
  v_mfma_f32_32x32x16_bf16 v[192:207], a[116:119], v[52:55], v[192:207]
  v_cvt_pk_bf16_f32 v84, v88, v89
  v_cvt_pk_bf16_f32 v85, v90, v91
  v_cvt_pk_bf16_f32 v86, v92, v93
  v_cvt_pk_bf16_f32 v87, v94, v95
  v_cvt_pk_bf16_f32 v88, v96, v97
  v_cvt_pk_bf16_f32 v89, v98, v99
  v_mfma_f32_32x32x16_bf16 v[208:223], a[140:143], v[52:55], v[208:223]
  v_cvt_pk_bf16_f32 v90, v100, v101
  v_cvt_pk_bf16_f32 v91, v102, v103
  v_cvt_pk_bf16_f32 v144, v144, v145
  v_cvt_pk_bf16_f32 v145, v146, v147
  v_cvt_pk_bf16_f32 v146, v148, v149
  v_cvt_pk_bf16_f32 v147, v150, v151
  v_mfma_f32_32x32x16_bf16 v[224:239], a[164:167], v[52:55], v[224:239]
  v_cvt_pk_bf16_f32 v148, v152, v153
  v_cvt_pk_bf16_f32 v149, v154, v155
  v_cvt_pk_bf16_f32 v150, v156, v157
  v_cvt_pk_bf16_f32 v151, v158, v159
  v_mfma_f32_32x32x16_bf16 v[192:207], a[120:123], v[56:59], v[192:207]
  ds_write_b64 v2, v[144:145] offset:0
  ds_write_b64 v2, v[146:147] offset:16
  v_mfma_f32_32x32x16_bf16 v[208:223], a[144:147], v[56:59], v[208:223]
  ds_write_b64 v2, v[148:149] offset:32
  ds_write_b64 v2, v[150:151] offset:48
  v_mfma_f32_32x32x16_bf16 v[224:239], a[168:171], v[56:59], v[224:239]
  v_cvt_pk_bf16_f32 v160, v160, v161
  v_cvt_pk_bf16_f32 v161, v162, v163
  v_cvt_pk_bf16_f32 v162, v164, v165
  v_cvt_pk_bf16_f32 v163, v166, v167
  v_cvt_pk_bf16_f32 v164, v168, v169
  v_cvt_pk_bf16_f32 v165, v170, v171
  v_mfma_f32_32x32x16_bf16 v[192:207], a[124:127], a[196:199], v[192:207]
  v_cvt_pk_bf16_f32 v166, v172, v173
  v_cvt_pk_bf16_f32 v167, v174, v175
  ds_write_b64 v2, v[160:161] offset:64
  v_mfma_f32_32x32x16_bf16 v[208:223], a[148:151], a[196:199], v[208:223]
  ds_write_b64 v2, v[162:163] offset:80
  ds_write_b64 v2, v[164:165] offset:96
  v_mfma_f32_32x32x16_bf16 v[224:239], a[172:175], a[196:199], v[224:239]
  ds_write_b64 v2, v[166:167] offset:112
  v_cvt_pk_bf16_f32 v176, v176, v177
  v_cvt_pk_bf16_f32 v177, v178, v179
  v_cvt_pk_bf16_f32 v178, v180, v181
  v_mfma_f32_32x32x16_bf16 v[192:207], a[128:131], a[200:203], v[192:207]
  v_cvt_pk_bf16_f32 v179, v182, v183
  v_cvt_pk_bf16_f32 v180, v184, v185
  v_cvt_pk_bf16_f32 v181, v186, v187
  v_cvt_pk_bf16_f32 v182, v188, v189
  v_cvt_pk_bf16_f32 v183, v190, v191
  v_mfma_f32_32x32x16_bf16 v[208:223], a[152:155], a[200:203], v[208:223]
  ds_write_b64 v2, v[176:177] offset:128
  ds_write_b64 v2, v[178:179] offset:144
  v_mfma_f32_32x32x16_bf16 v[224:239], a[176:179], a[200:203], v[224:239]
  ds_write_b64 v2, v[180:181] offset:160
  ds_write_b64 v2, v[182:183] offset:176
  v_mfma_f32_32x32x16_bf16 v[192:207], a[132:135], a[204:207], v[192:207]
  s_waitcnt lgkmcnt(0)
  ds_read_b128 v[16:19], v3 offset:0
  ds_read_b128 v[20:23], v4 offset:0
  ds_read_b128 v[24:27], v5 offset:0
  v_mfma_f32_32x32x16_bf16 v[208:223], a[156:159], a[204:207], v[208:223]
  ds_read_b128 v[28:31], v3 offset:3328
  ds_read_b128 v[32:35], v4 offset:3328
  ds_read_b128 v[36:39], v5 offset:3328
  v_mfma_f32_32x32x16_bf16 v[224:239], a[180:183], a[204:207], v[224:239]
  s_cmp_eq_u32 s37, 0
  s_cbranch_scc0 L_epi_odd
  s_nop 1
  v_mfma_f32_32x32x16_bf16 v[144:159], a[112:115], v[80:83], 0
  v_rcp_f32 v10, v136
  s_nop 0
  v_pk_mul_f32 v[112:113], v[112:113], v[10:11] op_sel_hi:[1,0]
  v_pk_mul_f32 v[114:115], v[114:115], v[10:11] op_sel_hi:[1,0]
  v_pk_mul_f32 v[116:117], v[116:117], v[10:11] op_sel_hi:[1,0]
  v_pk_mul_f32 v[118:119], v[118:119], v[10:11] op_sel_hi:[1,0]
  v_mfma_f32_32x32x16_bf16 v[160:175], a[136:139], v[80:83], 0
  v_pk_mul_f32 v[120:121], v[120:121], v[10:11] op_sel_hi:[1,0]
  v_pk_mul_f32 v[122:123], v[122:123], v[10:11] op_sel_hi:[1,0]
  v_pk_mul_f32 v[124:125], v[124:125], v[10:11] op_sel_hi:[1,0]
  v_pk_mul_f32 v[126:127], v[126:127], v[10:11] op_sel_hi:[1,0]
  v_pk_mul_f32 v[128:129], v[128:129], v[10:11] op_sel_hi:[1,0]
  v_pk_mul_f32 v[130:131], v[130:131], v[10:11] op_sel_hi:[1,0]
  v_mfma_f32_32x32x16_bf16 v[176:191], a[160:163], v[80:83], 0
  v_pk_mul_f32 v[132:133], v[132:133], v[10:11] op_sel_hi:[1,0]
  v_pk_mul_f32 v[134:135], v[134:135], v[10:11] op_sel_hi:[1,0]
  v_cvt_pk_bf16_f32 v112, v112, v113
  v_cvt_pk_bf16_f32 v113, v114, v115
  v_cvt_pk_bf16_f32 v114, v116, v117
  v_cvt_pk_bf16_f32 v115, v118, v119
  v_mfma_f32_32x32x16_bf16 v[144:159], a[116:119], v[84:87], v[144:159]
  v_cvt_pk_bf16_f32 v116, v120, v121
  v_cvt_pk_bf16_f32 v117, v122, v123
  v_cvt_pk_bf16_f32 v118, v124, v125
  v_cvt_pk_bf16_f32 v119, v126, v127
  v_cvt_pk_bf16_f32 v120, v128, v129
  v_cvt_pk_bf16_f32 v121, v130, v131
  v_mfma_f32_32x32x16_bf16 v[160:175], a[140:143], v[84:87], v[160:175]
  v_cvt_pk_bf16_f32 v122, v132, v133
  v_cvt_pk_bf16_f32 v123, v134, v135
  s_waitcnt lgkmcnt(0)
  s_add_u32 s99, s68, 86016
  v_mfma_f32_32x32x16_bf16 v[176:191], a[164:167], v[84:87], v[176:191]
  buffer_store_dwordx4 v[16:19], v6, s[40:43], s68 offen sc1
  v_mfma_f32_32x32x16_bf16 v[144:159], a[120:123], v[88:91], v[144:159]
  buffer_store_dwordx4 v[20:23], v7, s[40:43], s68 offen sc1
  v_mfma_f32_32x32x16_bf16 v[160:175], a[144:147], v[88:91], v[160:175]
  buffer_store_dwordx4 v[24:27], v8, s[40:43], s68 offen sc1
  v_mfma_f32_32x32x16_bf16 v[176:191], a[168:171], v[88:91], v[176:191]
  buffer_store_dwordx4 v[28:31], v6, s[40:43], s99 offen sc1
  v_mfma_f32_32x32x16_bf16 v[144:159], a[124:127], a[208:211], v[144:159]
  buffer_store_dwordx4 v[32:35], v7, s[40:43], s99 offen sc1
  v_mfma_f32_32x32x16_bf16 v[160:175], a[148:151], a[208:211], v[160:175]
  buffer_store_dwordx4 v[36:39], v8, s[40:43], s99 offen sc1
  v_cvt_pk_bf16_f32 v192, v192, v193
  v_mfma_f32_32x32x16_bf16 v[176:191], a[172:175], a[208:211], v[176:191]
  v_cvt_pk_bf16_f32 v193, v194, v195
  v_cvt_pk_bf16_f32 v194, v196, v197
  v_cvt_pk_bf16_f32 v195, v198, v199
  v_cvt_pk_bf16_f32 v196, v200, v201
  v_cvt_pk_bf16_f32 v197, v202, v203
  v_cvt_pk_bf16_f32 v198, v204, v205
  v_mfma_f32_32x32x16_bf16 v[144:159], a[128:131], a[212:215], v[144:159]
  v_cvt_pk_bf16_f32 v199, v206, v207
  ds_write_b64 v2, v[192:193] offset:6656
  v_mfma_f32_32x32x16_bf16 v[160:175], a[152:155], a[212:215], v[160:175]
  ds_write_b64 v2, v[194:195] offset:6672
  ds_write_b64 v2, v[196:197] offset:6688
  v_mfma_f32_32x32x16_bf16 v[176:191], a[176:179], a[212:215], v[176:191]
  ds_write_b64 v2, v[198:199] offset:6704
  v_cvt_pk_bf16_f32 v208, v208, v209
  v_cvt_pk_bf16_f32 v209, v210, v211
  v_cvt_pk_bf16_f32 v210, v212, v213
  v_mfma_f32_32x32x16_bf16 v[144:159], a[132:135], a[216:219], v[144:159]
  v_cvt_pk_bf16_f32 v211, v214, v215
  v_cvt_pk_bf16_f32 v212, v216, v217
  v_cvt_pk_bf16_f32 v213, v218, v219
  v_cvt_pk_bf16_f32 v214, v220, v221
  v_cvt_pk_bf16_f32 v215, v222, v223
  v_mfma_f32_32x32x16_bf16 v[160:175], a[156:159], a[216:219], v[160:175]
  ds_write_b64 v2, v[208:209] offset:6720
  ds_write_b64 v2, v[210:211] offset:6736
  v_mfma_f32_32x32x16_bf16 v[176:191], a[180:183], a[216:219], v[176:191]
  ds_write_b64 v2, v[212:213] offset:6752
  ds_write_b64 v2, v[214:215] offset:6768
  v_cvt_pk_bf16_f32 v224, v224, v225
  v_cvt_pk_bf16_f32 v225, v226, v227
  v_cvt_pk_bf16_f32 v226, v228, v229
  v_cvt_pk_bf16_f32 v227, v230, v231
  v_cvt_pk_bf16_f32 v228, v232, v233
  v_cvt_pk_bf16_f32 v229, v234, v235
  v_cvt_pk_bf16_f32 v230, v236, v237
  v_cvt_pk_bf16_f32 v231, v238, v239
  ds_write_b64 v2, v[224:225] offset:6784
  ds_write_b64 v2, v[226:227] offset:6800
  ds_write_b64 v2, v[228:229] offset:6816
  ds_write_b64 v2, v[230:231] offset:6832
  s_waitcnt lgkmcnt(0)
  ds_read_b128 v[48:51], v3 offset:6656
  ds_read_b128 v[52:55], v4 offset:6656
  ds_read_b128 v[56:59], v5 offset:6656
  ds_read_b128 v[60:63], v3 offset:9984
  ds_read_b128 v[64:67], v4 offset:9984
  ds_read_b128 v[68:71], v5 offset:9984
  s_nop 1
  v_mfma_f32_32x32x16_bf16 v[192:207], a[112:115], v[112:115], 0
  s_waitcnt lgkmcnt(0)
  s_add_u32 s99, s69, 86016
  v_mfma_f32_32x32x16_bf16 v[208:223], a[136:139], v[112:115], 0
  buffer_store_dwordx4 v[48:51], v6, s[40:43], s69 offen sc1
  v_mfma_f32_32x32x16_bf16 v[224:239], a[160:163], v[112:115], 0
  buffer_store_dwordx4 v[52:55], v7, s[40:43], s69 offen sc1
  v_mfma_f32_32x32x16_bf16 v[192:207], a[116:119], v[116:119], v[192:207]
  buffer_store_dwordx4 v[56:59], v8, s[40:43], s69 offen sc1
  v_mfma_f32_32x32x16_bf16 v[208:223], a[140:143], v[116:119], v[208:223]
  buffer_store_dwordx4 v[60:63], v6, s[40:43], s99 offen sc1
  v_mfma_f32_32x32x16_bf16 v[224:239], a[164:167], v[116:119], v[224:239]
  buffer_store_dwordx4 v[64:67], v7, s[40:43], s99 offen sc1
  v_mfma_f32_32x32x16_bf16 v[192:207], a[120:123], v[120:123], v[192:207]
  buffer_store_dwordx4 v[68:71], v8, s[40:43], s99 offen sc1
  v_mfma_f32_32x32x16_bf16 v[208:223], a[144:147], v[120:123], v[208:223]
  s_nop 3
  v_cvt_pk_bf16_f32 v144, v144, v145
  v_cvt_pk_bf16_f32 v145, v146, v147
  v_mfma_f32_32x32x16_bf16 v[224:239], a[168:171], v[120:123], v[224:239]
  v_cvt_pk_bf16_f32 v146, v148, v149
  v_cvt_pk_bf16_f32 v147, v150, v151
  v_cvt_pk_bf16_f32 v148, v152, v153
  v_cvt_pk_bf16_f32 v149, v154, v155
  v_cvt_pk_bf16_f32 v150, v156, v157
  v_cvt_pk_bf16_f32 v151, v158, v159
  v_mfma_f32_32x32x16_bf16 v[192:207], a[124:127], a[220:223], v[192:207]
  ds_write_b64 v2, v[144:145] offset:0
  ds_write_b64 v2, v[146:147] offset:16
  v_mfma_f32_32x32x16_bf16 v[208:223], a[148:151], a[220:223], v[208:223]
  ds_write_b64 v2, v[148:149] offset:32
  ds_write_b64 v2, v[150:151] offset:48
  v_mfma_f32_32x32x16_bf16 v[224:239], a[172:175], a[220:223], v[224:239]
  v_cvt_pk_bf16_f32 v160, v160, v161
  v_cvt_pk_bf16_f32 v161, v162, v163
  v_cvt_pk_bf16_f32 v162, v164, v165
  v_cvt_pk_bf16_f32 v163, v166, v167
  v_cvt_pk_bf16_f32 v164, v168, v169
  v_cvt_pk_bf16_f32 v165, v170, v171
  v_mfma_f32_32x32x16_bf16 v[192:207], a[128:131], a[224:227], v[192:207]
  v_cvt_pk_bf16_f32 v166, v172, v173
  v_cvt_pk_bf16_f32 v167, v174, v175
  ds_write_b64 v2, v[160:161] offset:64
  v_mfma_f32_32x32x16_bf16 v[208:223], a[152:155], a[224:227], v[208:223]
  ds_write_b64 v2, v[162:163] offset:80
  ds_write_b64 v2, v[164:165] offset:96
  v_mfma_f32_32x32x16_bf16 v[224:239], a[176:179], a[224:227], v[224:239]
  ds_write_b64 v2, v[166:167] offset:112
  v_cvt_pk_bf16_f32 v176, v176, v177
  v_cvt_pk_bf16_f32 v177, v178, v179
  v_cvt_pk_bf16_f32 v178, v180, v181
  v_mfma_f32_32x32x16_bf16 v[192:207], a[132:135], a[228:231], v[192:207]
  v_cvt_pk_bf16_f32 v179, v182, v183
  v_cvt_pk_bf16_f32 v180, v184, v185
  v_cvt_pk_bf16_f32 v181, v186, v187
  v_cvt_pk_bf16_f32 v182, v188, v189
  v_cvt_pk_bf16_f32 v183, v190, v191
  v_mfma_f32_32x32x16_bf16 v[208:223], a[156:159], a[228:231], v[208:223]
  ds_write_b64 v2, v[176:177] offset:128
  ds_write_b64 v2, v[178:179] offset:144
  v_mfma_f32_32x32x16_bf16 v[224:239], a[180:183], a[228:231], v[224:239]
  ds_write_b64 v2, v[180:181] offset:160
  ds_write_b64 v2, v[182:183] offset:176
  s_waitcnt lgkmcnt(0)
  ds_read_b128 v[80:83], v3 offset:0
  ds_read_b128 v[84:87], v4 offset:0
  ds_read_b128 v[88:91], v5 offset:0
  ds_read_b128 v[92:95], v3 offset:3328
  ds_read_b128 v[96:99], v4 offset:3328
  ds_read_b128 v[100:103], v5 offset:3328
  s_waitcnt lgkmcnt(0)
  s_add_u32 s99, s70, 86016
  buffer_store_dwordx4 v[80:83], v6, s[40:43], s70 offen sc1
  buffer_store_dwordx4 v[84:87], v7, s[40:43], s70 offen sc1
  buffer_store_dwordx4 v[88:91], v8, s[40:43], s70 offen sc1
  buffer_store_dwordx4 v[92:95], v6, s[40:43], s99 offen sc1
  buffer_store_dwordx4 v[96:99], v7, s[40:43], s99 offen sc1
  buffer_store_dwordx4 v[100:103], v8, s[40:43], s99 offen sc1
  s_nop 3
  v_cvt_pk_bf16_f32 v192, v192, v193
  v_cvt_pk_bf16_f32 v193, v194, v195
  v_cvt_pk_bf16_f32 v194, v196, v197
  v_cvt_pk_bf16_f32 v195, v198, v199
  v_cvt_pk_bf16_f32 v196, v200, v201
  v_cvt_pk_bf16_f32 v197, v202, v203
  v_cvt_pk_bf16_f32 v198, v204, v205
  v_cvt_pk_bf16_f32 v199, v206, v207
  ds_write_b64 v2, v[192:193] offset:6656
  ds_write_b64 v2, v[194:195] offset:6672
  ds_write_b64 v2, v[196:197] offset:6688
  ds_write_b64 v2, v[198:199] offset:6704
  v_cvt_pk_bf16_f32 v208, v208, v209
  v_cvt_pk_bf16_f32 v209, v210, v211
  v_cvt_pk_bf16_f32 v210, v212, v213
  v_cvt_pk_bf16_f32 v211, v214, v215
  v_cvt_pk_bf16_f32 v212, v216, v217
  v_cvt_pk_bf16_f32 v213, v218, v219
  v_cvt_pk_bf16_f32 v214, v220, v221
  v_cvt_pk_bf16_f32 v215, v222, v223
  ds_write_b64 v2, v[208:209] offset:6720
  ds_write_b64 v2, v[210:211] offset:6736
  ds_write_b64 v2, v[212:213] offset:6752
  ds_write_b64 v2, v[214:215] offset:6768
  v_cvt_pk_bf16_f32 v224, v224, v225
  v_cvt_pk_bf16_f32 v225, v226, v227
  v_cvt_pk_bf16_f32 v226, v228, v229
  v_cvt_pk_bf16_f32 v227, v230, v231
  v_cvt_pk_bf16_f32 v228, v232, v233
  v_cvt_pk_bf16_f32 v229, v234, v235
  v_cvt_pk_bf16_f32 v230, v236, v237
  v_cvt_pk_bf16_f32 v231, v238, v239
  ds_write_b64 v2, v[224:225] offset:6784
  ds_write_b64 v2, v[226:227] offset:6800
  ds_write_b64 v2, v[228:229] offset:6816
  ds_write_b64 v2, v[230:231] offset:6832
  s_waitcnt lgkmcnt(0)
  ds_read_b128 v[112:115], v3 offset:6656
  ds_read_b128 v[116:119], v4 offset:6656
  ds_read_b128 v[120:123], v5 offset:6656
  ds_read_b128 v[124:127], v3 offset:9984
  ds_read_b128 v[128:131], v4 offset:9984
  ds_read_b128 v[132:135], v5 offset:9984
  s_waitcnt lgkmcnt(0)
  s_add_u32 s99, s71, 86016
  buffer_store_dwordx4 v[112:115], v6, s[40:43], s71 offen sc1
  buffer_store_dwordx4 v[116:119], v7, s[40:43], s71 offen sc1
  buffer_store_dwordx4 v[120:123], v8, s[40:43], s71 offen sc1
  buffer_store_dwordx4 v[124:127], v6, s[40:43], s99 offen sc1
  buffer_store_dwordx4 v[128:131], v7, s[40:43], s99 offen sc1
  buffer_store_dwordx4 v[132:135], v8, s[40:43], s99 offen sc1
  s_branch L_exit
L_epi_odd:
  s_nop 1
  v_mfma_f32_32x32x16_bf16 v[144:159], a[112:115], v[80:83], 0
  s_waitcnt lgkmcnt(0)
  s_add_u32 s99, s68, 86016
  v_mfma_f32_32x32x16_bf16 v[160:175], a[136:139], v[80:83], 0
  buffer_store_dwordx4 v[16:19], v6, s[40:43], s68 offen sc1
  v_mfma_f32_32x32x16_bf16 v[176:191], a[160:163], v[80:83], 0
  buffer_store_dwordx4 v[20:23], v7, s[40:43], s68 offen sc1
  v_mfma_f32_32x32x16_bf16 v[144:159], a[116:119], v[84:87], v[144:159]
  buffer_store_dwordx4 v[24:27], v8, s[40:43], s68 offen sc1
  v_mfma_f32_32x32x16_bf16 v[160:175], a[140:143], v[84:87], v[160:175]
  buffer_store_dwordx4 v[28:31], v6, s[40:43], s99 offen sc1
  v_mfma_f32_32x32x16_bf16 v[176:191], a[164:167], v[84:87], v[176:191]
  buffer_store_dwordx4 v[32:35], v7, s[40:43], s99 offen sc1
  v_mfma_f32_32x32x16_bf16 v[144:159], a[120:123], v[88:91], v[144:159]
  buffer_store_dwordx4 v[36:39], v8, s[40:43], s99 offen sc1
  v_mfma_f32_32x32x16_bf16 v[160:175], a[144:147], v[88:91], v[160:175]
  s_nop 3
  v_cvt_pk_bf16_f32 v192, v192, v193
  v_cvt_pk_bf16_f32 v193, v194, v195
  v_mfma_f32_32x32x16_bf16 v[176:191], a[168:171], v[88:91], v[176:191]
  v_cvt_pk_bf16_f32 v194, v196, v197
  v_cvt_pk_bf16_f32 v195, v198, v199
  v_cvt_pk_bf16_f32 v196, v200, v201
  v_cvt_pk_bf16_f32 v197, v202, v203
  v_cvt_pk_bf16_f32 v198, v204, v205
  v_cvt_pk_bf16_f32 v199, v206, v207
  v_mfma_f32_32x32x16_bf16 v[144:159], a[124:127], a[208:211], v[144:159]
  ds_write_b64 v2, v[192:193] offset:6656
  ds_write_b64 v2, v[194:195] offset:6672
  v_mfma_f32_32x32x16_bf16 v[160:175], a[148:151], a[208:211], v[160:175]
  ds_write_b64 v2, v[196:197] offset:6688
  ds_write_b64 v2, v[198:199] offset:6704
  v_mfma_f32_32x32x16_bf16 v[176:191], a[172:175], a[208:211], v[176:191]
  v_cvt_pk_bf16_f32 v208, v208, v209
  v_cvt_pk_bf16_f32 v209, v210, v211
  v_cvt_pk_bf16_f32 v210, v212, v213
  v_cvt_pk_bf16_f32 v211, v214, v215
  v_cvt_pk_bf16_f32 v212, v216, v217
  v_cvt_pk_bf16_f32 v213, v218, v219
  v_mfma_f32_32x32x16_bf16 v[144:159], a[128:131], a[212:215], v[144:159]
  v_cvt_pk_bf16_f32 v214, v220, v221
  v_cvt_pk_bf16_f32 v215, v222, v223
  ds_write_b64 v2, v[208:209] offset:6720
  v_mfma_f32_32x32x16_bf16 v[160:175], a[152:155], a[212:215], v[160:175]
  ds_write_b64 v2, v[210:211] offset:6736
  ds_write_b64 v2, v[212:213] offset:6752
  v_mfma_f32_32x32x16_bf16 v[176:191], a[176:179], a[212:215], v[176:191]
  ds_write_b64 v2, v[214:215] offset:6768
  v_cvt_pk_bf16_f32 v224, v224, v225
  v_cvt_pk_bf16_f32 v225, v226, v227
  v_cvt_pk_bf16_f32 v226, v228, v229
  v_mfma_f32_32x32x16_bf16 v[144:159], a[132:135], a[216:219], v[144:159]
  v_cvt_pk_bf16_f32 v227, v230, v231
  v_cvt_pk_bf16_f32 v228, v232, v233
  v_cvt_pk_bf16_f32 v229, v234, v235
  v_cvt_pk_bf16_f32 v230, v236, v237
  v_cvt_pk_bf16_f32 v231, v238, v239
  v_mfma_f32_32x32x16_bf16 v[160:175], a[156:159], a[216:219], v[160:175]
  ds_write_b64 v2, v[224:225] offset:6784
  ds_write_b64 v2, v[226:227] offset:6800
  v_mfma_f32_32x32x16_bf16 v[176:191], a[180:183], a[216:219], v[176:191]
  ds_write_b64 v2, v[228:229] offset:6816
  ds_write_b64 v2, v[230:231] offset:6832
  s_waitcnt lgkmcnt(0)
  ds_read_b128 v[48:51], v3 offset:6656
  ds_read_b128 v[52:55], v4 offset:6656
  ds_read_b128 v[56:59], v5 offset:6656
  ds_read_b128 v[60:63], v3 offset:9984
  ds_read_b128 v[64:67], v4 offset:9984
  ds_read_b128 v[68:71], v5 offset:9984
  s_waitcnt lgkmcnt(0)
  s_add_u32 s99, s69, 86016
  buffer_store_dwordx4 v[48:51], v6, s[40:43], s69 offen sc1
  buffer_store_dwordx4 v[52:55], v7, s[40:43], s69 offen sc1
  buffer_store_dwordx4 v[56:59], v8, s[40:43], s69 offen sc1
  buffer_store_dwordx4 v[60:63], v6, s[40:43], s99 offen sc1
  buffer_store_dwordx4 v[64:67], v7, s[40:43], s99 offen sc1
  buffer_store_dwordx4 v[68:71], v8, s[40:43], s99 offen sc1
  s_nop 3
  v_cvt_pk_bf16_f32 v144, v144, v145
  v_cvt_pk_bf16_f32 v145, v146, v147
  v_cvt_pk_bf16_f32 v146, v148, v149
  v_cvt_pk_bf16_f32 v147, v150, v151
  v_cvt_pk_bf16_f32 v148, v152, v153
  v_cvt_pk_bf16_f32 v149, v154, v155
  v_cvt_pk_bf16_f32 v150, v156, v157
  v_cvt_pk_bf16_f32 v151, v158, v159
  ds_write_b64 v2, v[144:145] offset:0
  ds_write_b64 v2, v[146:147] offset:16
  ds_write_b64 v2, v[148:149] offset:32
  ds_write_b64 v2, v[150:151] offset:48
  v_cvt_pk_bf16_f32 v160, v160, v161
  v_cvt_pk_bf16_f32 v161, v162, v163
  v_cvt_pk_bf16_f32 v162, v164, v165
  v_cvt_pk_bf16_f32 v163, v166, v167
  v_cvt_pk_bf16_f32 v164, v168, v169
  v_cvt_pk_bf16_f32 v165, v170, v171
  v_cvt_pk_bf16_f32 v166, v172, v173
  v_cvt_pk_bf16_f32 v167, v174, v175
  ds_write_b64 v2, v[160:161] offset:64
  ds_write_b64 v2, v[162:163] offset:80
  ds_write_b64 v2, v[164:165] offset:96
  ds_write_b64 v2, v[166:167] offset:112
  v_cvt_pk_bf16_f32 v176, v176, v177
  v_cvt_pk_bf16_f32 v177, v178, v179
  v_cvt_pk_bf16_f32 v178, v180, v181
  v_cvt_pk_bf16_f32 v179, v182, v183
  v_cvt_pk_bf16_f32 v180, v184, v185
  v_cvt_pk_bf16_f32 v181, v186, v187
  v_cvt_pk_bf16_f32 v182, v188, v189
  v_cvt_pk_bf16_f32 v183, v190, v191
  ds_write_b64 v2, v[176:177] offset:128
  ds_write_b64 v2, v[178:179] offset:144
  ds_write_b64 v2, v[180:181] offset:160
  ds_write_b64 v2, v[182:183] offset:176
  s_waitcnt lgkmcnt(0)
  ds_read_b128 v[80:83], v3 offset:0
  ds_read_b128 v[84:87], v4 offset:0
  ds_read_b128 v[88:91], v5 offset:0
  ds_read_b128 v[92:95], v3 offset:3328
  ds_read_b128 v[96:99], v4 offset:3328
  ds_read_b128 v[100:103], v5 offset:3328
  s_waitcnt lgkmcnt(0)
  s_add_u32 s99, s70, 86016
  buffer_store_dwordx4 v[80:83], v6, s[40:43], s70 offen sc1
  buffer_store_dwordx4 v[84:87], v7, s[40:43], s70 offen sc1
  buffer_store_dwordx4 v[88:91], v8, s[40:43], s70 offen sc1
  buffer_store_dwordx4 v[92:95], v6, s[40:43], s99 offen sc1
  buffer_store_dwordx4 v[96:99], v7, s[40:43], s99 offen sc1
  buffer_store_dwordx4 v[100:103], v8, s[40:43], s99 offen sc1
L_exit:
  s_endpgm
L_fb_V:
  s_call_b64 s[96:97], L_fallback
  s_branch L_ok_V
L_fb_W:
  s_call_b64 s[96:97], L_fallback
  s_branch L_ok_W
L_fb_H:
  s_call_b64 s[96:97], L_fallback
  v_rcp_f32 v10, v40
  s_nop 0
  v_pk_mul_f32 v[16:17], v[16:17], v[10:11] op_sel_hi:[1,0]
  v_pk_mul_f32 v[18:19], v[18:19], v[10:11] op_sel_hi:[1,0]
  v_pk_mul_f32 v[20:21], v[20:21], v[10:11] op_sel_hi:[1,0]
  v_pk_mul_f32 v[22:23], v[22:23], v[10:11] op_sel_hi:[1,0]
  v_pk_mul_f32 v[24:25], v[24:25], v[10:11] op_sel_hi:[1,0]
  v_pk_mul_f32 v[26:27], v[26:27], v[10:11] op_sel_hi:[1,0]
  v_pk_mul_f32 v[28:29], v[28:29], v[10:11] op_sel_hi:[1,0]
  v_pk_mul_f32 v[30:31], v[30:31], v[10:11] op_sel_hi:[1,0]
  v_pk_mul_f32 v[32:33], v[32:33], v[10:11] op_sel_hi:[1,0]
  v_pk_mul_f32 v[34:35], v[34:35], v[10:11] op_sel_hi:[1,0]
  v_pk_mul_f32 v[36:37], v[36:37], v[10:11] op_sel_hi:[1,0]
  v_pk_mul_f32 v[38:39], v[38:39], v[10:11] op_sel_hi:[1,0]
  v_cvt_pk_bf16_f32 v16, v16, v17
  v_cvt_pk_bf16_f32 v17, v18, v19
  v_cvt_pk_bf16_f32 v18, v20, v21
  v_cvt_pk_bf16_f32 v19, v22, v23
  v_cvt_pk_bf16_f32 v20, v24, v25
  v_cvt_pk_bf16_f32 v21, v26, v27
  v_cvt_pk_bf16_f32 v22, v28, v29
  v_cvt_pk_bf16_f32 v23, v30, v31
  v_cvt_pk_bf16_f32 v24, v32, v33
  v_cvt_pk_bf16_f32 v25, v34, v35
  v_cvt_pk_bf16_f32 v26, v36, v37
  v_cvt_pk_bf16_f32 v27, v38, v39
  s_nop 1
  v_mfma_f32_32x32x16_bf16 v[144:159], a[112:115], v[16:19], 0
  v_mfma_f32_32x32x16_bf16 v[160:175], a[136:139], v[16:19], 0
  v_mfma_f32_32x32x16_bf16 v[176:191], a[160:163], v[16:19], 0
  v_mfma_f32_32x32x16_bf16 v[144:159], a[116:119], v[20:23], v[144:159]
  v_mfma_f32_32x32x16_bf16 v[160:175], a[140:143], v[20:23], v[160:175]
  v_mfma_f32_32x32x16_bf16 v[176:191], a[164:167], v[20:23], v[176:191]
  v_mfma_f32_32x32x16_bf16 v[144:159], a[120:123], v[24:27], v[144:159]
  v_mfma_f32_32x32x16_bf16 v[160:175], a[144:147], v[24:27], v[160:175]
  v_mfma_f32_32x32x16_bf16 v[176:191], a[168:171], v[24:27], v[176:191]
  v_mfma_f32_32x32x16_bf16 v[144:159], a[124:127], a[184:187], v[144:159]
  v_mfma_f32_32x32x16_bf16 v[160:175], a[148:151], a[184:187], v[160:175]
  v_mfma_f32_32x32x16_bf16 v[176:191], a[172:175], a[184:187], v[176:191]
  v_mfma_f32_32x32x16_bf16 v[144:159], a[128:131], a[188:191], v[144:159]
  v_mfma_f32_32x32x16_bf16 v[160:175], a[152:155], a[188:191], v[160:175]
  v_mfma_f32_32x32x16_bf16 v[176:191], a[176:179], a[188:191], v[176:191]
  v_mfma_f32_32x32x16_bf16 v[144:159], a[132:135], a[192:195], v[144:159]
  v_mfma_f32_32x32x16_bf16 v[160:175], a[156:159], a[192:195], v[160:175]
  v_mfma_f32_32x32x16_bf16 v[176:191], a[180:183], a[192:195], v[176:191]
  s_branch L_ok_H
L_fallback:
  s_waitcnt vmcnt(0) lgkmcnt(0)
  v_mov_b32 v156, 0xff800000
  v_mov_b32 v157, 0xff800000
  v_mov_b32 v158, 0xff800000
  v_mov_b32 v159, 0xff800000
  s_mov_b32 s94, 0
  s_mov_b32 s36, s98
L_fb1:
  buffer_load_dwordx4 v[144:147], v1, s[8:11], s36 offen offset:0 sc1
  buffer_load_dwordx4 v[148:151], v1, s[8:11], s36 offen offset:1024 sc1
  buffer_load_dwordx4 v[152:155], v1, s[8:11], s36 offen offset:2048 sc1
  s_waitcnt vmcnt(0)
  v_mfma_f32_32x32x16_bf16 v[160:175], v[144:147], v[208:211], 0
  v_mfma_f32_32x32x16_bf16 v[160:175], v[148:151], v[212:215], v[160:175]
  v_mfma_f32_32x32x16_bf16 v[160:175], v[152:155], v[216:219], v[160:175]
  s_nop 7
  s_nop 7
  v_max3_f32 v156, v160, v161, v156
  v_max3_f32 v156, v162, v163, v156
  v_max3_f32 v156, v164, v165, v156
  v_max3_f32 v156, v166, v167, v156
  v_max3_f32 v156, v168, v169, v156
  v_max3_f32 v156, v170, v171, v156
  v_max3_f32 v156, v172, v173, v156
  v_max3_f32 v156, v174, v175, v156
  s_nop 7
  v_mfma_f32_32x32x16_bf16 v[160:175], v[144:147], v[220:223], 0
  v_mfma_f32_32x32x16_bf16 v[160:175], v[148:151], v[224:227], v[160:175]
  v_mfma_f32_32x32x16_bf16 v[160:175], v[152:155], v[228:231], v[160:175]
  s_nop 7
  s_nop 7
  v_max3_f32 v157, v160, v161, v157
  v_max3_f32 v157, v162, v163, v157
  v_max3_f32 v157, v164, v165, v157
  v_max3_f32 v157, v166, v167, v157
  v_max3_f32 v157, v168, v169, v157
  v_max3_f32 v157, v170, v171, v157
  v_max3_f32 v157, v172, v173, v157
  v_max3_f32 v157, v174, v175, v157
  s_nop 7
  v_mfma_f32_32x32x16_bf16 v[160:175], v[144:147], v[232:235], 0
  v_mfma_f32_32x32x16_bf16 v[160:175], v[148:151], v[236:239], v[160:175]
  v_mfma_f32_32x32x16_bf16 v[160:175], v[152:155], v[240:243], v[160:175]
  s_nop 7
  s_nop 7
  v_max3_f32 v158, v160, v161, v158
  v_max3_f32 v158, v162, v163, v158
  v_max3_f32 v158, v164, v165, v158
  v_max3_f32 v158, v166, v167, v158
  v_max3_f32 v158, v168, v169, v158
  v_max3_f32 v158, v170, v171, v158
  v_max3_f32 v158, v172, v173, v158
  v_max3_f32 v158, v174, v175, v158
  s_nop 7
  v_mfma_f32_32x32x16_bf16 v[160:175], v[144:147], v[244:247], 0
  v_mfma_f32_32x32x16_bf16 v[160:175], v[148:151], v[248:251], v[160:175]
  v_mfma_f32_32x32x16_bf16 v[160:175], v[152:155], v[252:255], v[160:175]
  s_nop 7
  s_nop 7
  v_max3_f32 v159, v160, v161, v159
  v_max3_f32 v159, v162, v163, v159
  v_max3_f32 v159, v164, v165, v159
  v_max3_f32 v159, v166, v167, v159
  v_max3_f32 v159, v168, v169, v159
  v_max3_f32 v159, v170, v171, v159
  v_max3_f32 v159, v172, v173, v159
  v_max3_f32 v159, v174, v175, v159
  s_nop 7
  s_add_u32 s36, s36, 7168
  s_add_u32 s94, s94, 1
  s_cmp_lt_u32 s94, 56
  s_cbranch_scc1 L_fb1
  v_mov_b32 v160, v156
  v_mov_b32 v161, v156
  s_nop 1
  v_permlane32_swap_b32 v160, v161
  s_nop 1
  v_max3_f32 v156, v160, v161, v156
  v_mov_b32 v160, v157
  v_mov_b32 v161, v157
  s_nop 1
  v_permlane32_swap_b32 v160, v161
  s_nop 1
  v_max3_f32 v157, v160, v161, v157
  v_mov_b32 v160, v158
  v_mov_b32 v161, v158
  s_nop 1
  v_permlane32_swap_b32 v160, v161
  s_nop 1
  v_max3_f32 v158, v160, v161, v158
  v_mov_b32 v160, v159
  v_mov_b32 v161, v159
  s_nop 1
  v_permlane32_swap_b32 v160, v161
  s_nop 1
  v_max3_f32 v159, v160, v161, v159
  v_mov_b32 v16, 0
  v_mov_b32 v17, 0
  v_mov_b32 v18, 0
  v_mov_b32 v19, 0
  v_mov_b32 v20, 0
  v_mov_b32 v21, 0
  v_mov_b32 v22, 0
  v_mov_b32 v23, 0
  v_mov_b32 v24, 0
  v_mov_b32 v25, 0
  v_mov_b32 v26, 0
  v_mov_b32 v27, 0
  v_mov_b32 v28, 0
  v_mov_b32 v29, 0
  v_mov_b32 v30, 0
  v_mov_b32 v31, 0
  v_mov_b32 v32, 0
  v_mov_b32 v33, 0
  v_mov_b32 v34, 0
  v_mov_b32 v35, 0
  v_mov_b32 v36, 0
  v_mov_b32 v37, 0
  v_mov_b32 v38, 0
  v_mov_b32 v39, 0
  v_mov_b32 v40, 0
  v_mov_b32 v41, 0
  v_mov_b32 v42, 0
  v_mov_b32 v43, 0
  v_mov_b32 v44, 0
  v_mov_b32 v45, 0
  v_mov_b32 v46, 0
  v_mov_b32 v47, 0
  v_mov_b32 v48, 0
  v_mov_b32 v49, 0
  v_mov_b32 v50, 0
  v_mov_b32 v51, 0
  v_mov_b32 v52, 0
  v_mov_b32 v53, 0
  v_mov_b32 v54, 0
  v_mov_b32 v55, 0
  v_mov_b32 v56, 0
  v_mov_b32 v57, 0
  v_mov_b32 v58, 0
  v_mov_b32 v59, 0
  v_mov_b32 v60, 0
  v_mov_b32 v61, 0
  v_mov_b32 v62, 0
  v_mov_b32 v63, 0
  v_mov_b32 v64, 0
  v_mov_b32 v65, 0
  v_mov_b32 v66, 0
  v_mov_b32 v67, 0
  v_mov_b32 v68, 0
  v_mov_b32 v69, 0
  v_mov_b32 v70, 0
  v_mov_b32 v71, 0
  v_mov_b32 v72, 0
  v_mov_b32 v73, 0
  v_mov_b32 v74, 0
  v_mov_b32 v75, 0
  v_mov_b32 v76, 0
  v_mov_b32 v77, 0
  v_mov_b32 v78, 0
  v_mov_b32 v79, 0
  v_mov_b32 v80, 0
  v_mov_b32 v81, 0
  v_mov_b32 v82, 0
  v_mov_b32 v83, 0
  v_mov_b32 v84, 0
  v_mov_b32 v85, 0
  v_mov_b32 v86, 0
  v_mov_b32 v87, 0
  v_mov_b32 v88, 0
  v_mov_b32 v89, 0
  v_mov_b32 v90, 0
  v_mov_b32 v91, 0
  v_mov_b32 v92, 0
  v_mov_b32 v93, 0
  v_mov_b32 v94, 0
  v_mov_b32 v95, 0
  v_mov_b32 v96, 0
  v_mov_b32 v97, 0
  v_mov_b32 v98, 0
  v_mov_b32 v99, 0
  v_mov_b32 v100, 0
  v_mov_b32 v101, 0
  v_mov_b32 v102, 0
  v_mov_b32 v103, 0
  v_mov_b32 v104, 0
  v_mov_b32 v105, 0
  v_mov_b32 v106, 0
  v_mov_b32 v107, 0
  v_mov_b32 v108, 0
  v_mov_b32 v109, 0
  v_mov_b32 v110, 0
  v_mov_b32 v111, 0
  v_mov_b32 v112, 0
  v_mov_b32 v113, 0
  v_mov_b32 v114, 0
  v_mov_b32 v115, 0
  v_mov_b32 v116, 0
  v_mov_b32 v117, 0
  v_mov_b32 v118, 0
  v_mov_b32 v119, 0
  v_mov_b32 v120, 0
  v_mov_b32 v121, 0
  v_mov_b32 v122, 0
  v_mov_b32 v123, 0
  v_mov_b32 v124, 0
  v_mov_b32 v125, 0
  v_mov_b32 v126, 0
  v_mov_b32 v127, 0
  v_mov_b32 v128, 0
  v_mov_b32 v129, 0
  v_mov_b32 v130, 0
  v_mov_b32 v131, 0
  v_mov_b32 v132, 0
  v_mov_b32 v133, 0
  v_mov_b32 v134, 0
  v_mov_b32 v135, 0
  v_mov_b32 v136, 0
  v_mov_b32 v137, 0
  v_mov_b32 v138, 0
  v_mov_b32 v139, 0
  v_mov_b32 v140, 0
  v_mov_b32 v141, 0
  v_mov_b32 v142, 0
  v_mov_b32 v143, 0
  s_mov_b32 s94, 0
  s_mov_b32 s36, s98
L_fb2:
  s_add_u32 s39, s36, 4096
  buffer_load_dwordx4 v[144:147], v1, s[8:11], s36 offen offset:0 sc1
  buffer_load_dwordx4 v[148:151], v1, s[8:11], s36 offen offset:1024 sc1
  buffer_load_dwordx4 v[152:155], v1, s[8:11], s36 offen offset:2048 sc1
  buffer_load_dwordx4 v[176:179], v1, s[8:11], s36 offen offset:3072 sc1
  buffer_load_dwordx4 v[180:183], v1, s[8:11], s39 offen offset:0 sc1
  buffer_load_dwordx4 v[184:187], v1, s[8:11], s39 offen offset:1024 sc1
  buffer_load_dwordx4 v[188:191], v1, s[8:11], s39 offen offset:2048 sc1
  s_waitcnt vmcnt(0)
  v_mfma_f32_32x32x16_bf16 v[160:175], v[144:147], v[208:211], 0
  v_mfma_f32_32x32x16_bf16 v[160:175], v[148:151], v[212:215], v[160:175]
  v_mfma_f32_32x32x16_bf16 v[160:175], v[152:155], v[216:219], v[160:175]
  s_nop 7
  s_nop 7
  v_sub_f32 v160, v160, v156
  v_sub_f32 v161, v161, v156
  v_sub_f32 v162, v162, v156
  v_sub_f32 v163, v163, v156
  v_sub_f32 v164, v164, v156
  v_sub_f32 v165, v165, v156
  v_sub_f32 v166, v166, v156
  v_sub_f32 v167, v167, v156
  v_sub_f32 v168, v168, v156
  v_sub_f32 v169, v169, v156
  v_sub_f32 v170, v170, v156
  v_sub_f32 v171, v171, v156
  v_sub_f32 v172, v172, v156
  v_sub_f32 v173, v173, v156
  v_sub_f32 v174, v174, v156
  v_sub_f32 v175, v175, v156
  v_exp_f32 v160, v160
  v_exp_f32 v161, v161
  v_exp_f32 v162, v162
  v_exp_f32 v163, v163
  v_exp_f32 v164, v164
  v_exp_f32 v165, v165
  v_exp_f32 v166, v166
  v_exp_f32 v167, v167
  v_exp_f32 v168, v168
  v_exp_f32 v169, v169
  v_exp_f32 v170, v170
  v_exp_f32 v171, v171
  v_exp_f32 v172, v172
  v_exp_f32 v173, v173
  v_exp_f32 v174, v174
  v_exp_f32 v175, v175
  s_nop 0
  v_cvt_pk_bf16_f32 v192, v160, v161
  v_cvt_pk_bf16_f32 v193, v162, v163
  v_cvt_pk_bf16_f32 v194, v164, v165
  v_cvt_pk_bf16_f32 v195, v166, v167
  v_cvt_pk_bf16_f32 v196, v168, v169
  v_cvt_pk_bf16_f32 v197, v170, v171
  v_cvt_pk_bf16_f32 v198, v172, v173
  v_cvt_pk_bf16_f32 v199, v174, v175
  s_nop 1
  v_mfma_f32_32x32x16_bf16 v[16:31], v[176:179], v[192:195], v[16:31]
  v_mfma_f32_32x32x16_bf16 v[32:47], v[184:187], v[192:195], v[32:47]
  v_mfma_f32_32x32x16_bf16 v[16:31], v[180:183], v[196:199], v[16:31]
  v_mfma_f32_32x32x16_bf16 v[32:47], v[188:191], v[196:199], v[32:47]
  s_nop 7
  s_nop 7
  v_mfma_f32_32x32x16_bf16 v[160:175], v[144:147], v[220:223], 0
  v_mfma_f32_32x32x16_bf16 v[160:175], v[148:151], v[224:227], v[160:175]
  v_mfma_f32_32x32x16_bf16 v[160:175], v[152:155], v[228:231], v[160:175]
  s_nop 7
  s_nop 7
  v_sub_f32 v160, v160, v157
  v_sub_f32 v161, v161, v157
  v_sub_f32 v162, v162, v157
  v_sub_f32 v163, v163, v157
  v_sub_f32 v164, v164, v157
  v_sub_f32 v165, v165, v157
  v_sub_f32 v166, v166, v157
  v_sub_f32 v167, v167, v157
  v_sub_f32 v168, v168, v157
  v_sub_f32 v169, v169, v157
  v_sub_f32 v170, v170, v157
  v_sub_f32 v171, v171, v157
  v_sub_f32 v172, v172, v157
  v_sub_f32 v173, v173, v157
  v_sub_f32 v174, v174, v157
  v_sub_f32 v175, v175, v157
  v_exp_f32 v160, v160
  v_exp_f32 v161, v161
  v_exp_f32 v162, v162
  v_exp_f32 v163, v163
  v_exp_f32 v164, v164
  v_exp_f32 v165, v165
  v_exp_f32 v166, v166
  v_exp_f32 v167, v167
  v_exp_f32 v168, v168
  v_exp_f32 v169, v169
  v_exp_f32 v170, v170
  v_exp_f32 v171, v171
  v_exp_f32 v172, v172
  v_exp_f32 v173, v173
  v_exp_f32 v174, v174
  v_exp_f32 v175, v175
  s_nop 0
  v_cvt_pk_bf16_f32 v192, v160, v161
  v_cvt_pk_bf16_f32 v193, v162, v163
  v_cvt_pk_bf16_f32 v194, v164, v165
  v_cvt_pk_bf16_f32 v195, v166, v167
  v_cvt_pk_bf16_f32 v196, v168, v169
  v_cvt_pk_bf16_f32 v197, v170, v171
  v_cvt_pk_bf16_f32 v198, v172, v173
  v_cvt_pk_bf16_f32 v199, v174, v175
  s_nop 1
  v_mfma_f32_32x32x16_bf16 v[48:63], v[176:179], v[192:195], v[48:63]
  v_mfma_f32_32x32x16_bf16 v[64:79], v[184:187], v[192:195], v[64:79]
  v_mfma_f32_32x32x16_bf16 v[48:63], v[180:183], v[196:199], v[48:63]
  v_mfma_f32_32x32x16_bf16 v[64:79], v[188:191], v[196:199], v[64:79]
  s_nop 7
  s_nop 7
  v_mfma_f32_32x32x16_bf16 v[160:175], v[144:147], v[232:235], 0
  v_mfma_f32_32x32x16_bf16 v[160:175], v[148:151], v[236:239], v[160:175]
  v_mfma_f32_32x32x16_bf16 v[160:175], v[152:155], v[240:243], v[160:175]
  s_nop 7
  s_nop 7
  v_sub_f32 v160, v160, v158
  v_sub_f32 v161, v161, v158
  v_sub_f32 v162, v162, v158
  v_sub_f32 v163, v163, v158
  v_sub_f32 v164, v164, v158
  v_sub_f32 v165, v165, v158
  v_sub_f32 v166, v166, v158
  v_sub_f32 v167, v167, v158
  v_sub_f32 v168, v168, v158
  v_sub_f32 v169, v169, v158
  v_sub_f32 v170, v170, v158
  v_sub_f32 v171, v171, v158
  v_sub_f32 v172, v172, v158
  v_sub_f32 v173, v173, v158
  v_sub_f32 v174, v174, v158
  v_sub_f32 v175, v175, v158
  v_exp_f32 v160, v160
  v_exp_f32 v161, v161
  v_exp_f32 v162, v162
  v_exp_f32 v163, v163
  v_exp_f32 v164, v164
  v_exp_f32 v165, v165
  v_exp_f32 v166, v166
  v_exp_f32 v167, v167
  v_exp_f32 v168, v168
  v_exp_f32 v169, v169
  v_exp_f32 v170, v170
  v_exp_f32 v171, v171
  v_exp_f32 v172, v172
  v_exp_f32 v173, v173
  v_exp_f32 v174, v174
  v_exp_f32 v175, v175
  s_nop 0
  v_cvt_pk_bf16_f32 v192, v160, v161
  v_cvt_pk_bf16_f32 v193, v162, v163
  v_cvt_pk_bf16_f32 v194, v164, v165
  v_cvt_pk_bf16_f32 v195, v166, v167
  v_cvt_pk_bf16_f32 v196, v168, v169
  v_cvt_pk_bf16_f32 v197, v170, v171
  v_cvt_pk_bf16_f32 v198, v172, v173
  v_cvt_pk_bf16_f32 v199, v174, v175
  s_nop 1
  v_mfma_f32_32x32x16_bf16 v[80:95], v[176:179], v[192:195], v[80:95]
  v_mfma_f32_32x32x16_bf16 v[96:111], v[184:187], v[192:195], v[96:111]
  v_mfma_f32_32x32x16_bf16 v[80:95], v[180:183], v[196:199], v[80:95]
  v_mfma_f32_32x32x16_bf16 v[96:111], v[188:191], v[196:199], v[96:111]
  s_nop 7
  s_nop 7
  v_mfma_f32_32x32x16_bf16 v[160:175], v[144:147], v[244:247], 0
  v_mfma_f32_32x32x16_bf16 v[160:175], v[148:151], v[248:251], v[160:175]
  v_mfma_f32_32x32x16_bf16 v[160:175], v[152:155], v[252:255], v[160:175]
  s_nop 7
  s_nop 7
  v_sub_f32 v160, v160, v159
  v_sub_f32 v161, v161, v159
  v_sub_f32 v162, v162, v159
  v_sub_f32 v163, v163, v159
  v_sub_f32 v164, v164, v159
  v_sub_f32 v165, v165, v159
  v_sub_f32 v166, v166, v159
  v_sub_f32 v167, v167, v159
  v_sub_f32 v168, v168, v159
  v_sub_f32 v169, v169, v159
  v_sub_f32 v170, v170, v159
  v_sub_f32 v171, v171, v159
  v_sub_f32 v172, v172, v159
  v_sub_f32 v173, v173, v159
  v_sub_f32 v174, v174, v159
  v_sub_f32 v175, v175, v159
  v_exp_f32 v160, v160
  v_exp_f32 v161, v161
  v_exp_f32 v162, v162
  v_exp_f32 v163, v163
  v_exp_f32 v164, v164
  v_exp_f32 v165, v165
  v_exp_f32 v166, v166
  v_exp_f32 v167, v167
  v_exp_f32 v168, v168
  v_exp_f32 v169, v169
  v_exp_f32 v170, v170
  v_exp_f32 v171, v171
  v_exp_f32 v172, v172
  v_exp_f32 v173, v173
  v_exp_f32 v174, v174
  v_exp_f32 v175, v175
  s_nop 0
  v_cvt_pk_bf16_f32 v192, v160, v161
  v_cvt_pk_bf16_f32 v193, v162, v163
  v_cvt_pk_bf16_f32 v194, v164, v165
  v_cvt_pk_bf16_f32 v195, v166, v167
  v_cvt_pk_bf16_f32 v196, v168, v169
  v_cvt_pk_bf16_f32 v197, v170, v171
  v_cvt_pk_bf16_f32 v198, v172, v173
  v_cvt_pk_bf16_f32 v199, v174, v175
  s_nop 1
  v_mfma_f32_32x32x16_bf16 v[112:127], v[176:179], v[192:195], v[112:127]
  v_mfma_f32_32x32x16_bf16 v[128:143], v[184:187], v[192:195], v[128:143]
  v_mfma_f32_32x32x16_bf16 v[112:127], v[180:183], v[196:199], v[112:127]
  v_mfma_f32_32x32x16_bf16 v[128:143], v[188:191], v[196:199], v[128:143]
  s_nop 7
  s_nop 7
  s_add_u32 s36, s36, 7168
  s_add_u32 s94, s94, 1
  s_cmp_lt_u32 s94, 56
  s_cbranch_scc1 L_fb2
  s_nop 7
  s_nop 7
  s_setpc_b64 s[96:97]
L_code_end:
  s_endpgm

.section .rodata,"a"
.p2align 6
.amdhsa_kernel standalone__window_attn_cswin__vision_kernel
  .amdhsa_next_free_vgpr 512
  .amdhsa_next_free_sgpr 102
  .amdhsa_accum_offset 256
  .amdhsa_group_segment_fixed_size 0
  .amdhsa_kernarg_size 48
  .amdhsa_user_sgpr_count 2
  .amdhsa_user_sgpr_kernarg_segment_ptr 1
  .amdhsa_system_sgpr_workgroup_id_x 1
.end_amdhsa_kernel
```
